```python
import torch

def _softmax(x, axis=-1):
    return torch.softmax(x, dim=axis)
def _gelu(x):
    return torch.nn.functional.gelu(x, approximate="tanh")
def _silu(x):
    return torch.nn.functional.silu(x)
def _sigmoid(x):
    return torch.sigmoid(x)
def _layernorm(x, axis=-1, eps=1e-5):
    m = x.mean(dim=axis, keepdim=True)
    v = x.var(dim=axis, keepdim=True, unbiased=False)
    return (x - m) / torch.sqrt(v + eps)
def _scatter_add(tgt, idx, src, axis=0):
    return tgt.clone().index_add_(axis, idx, src)
def _segment_sum(src, seg, n):
    out = torch.zeros((n,) + src.shape[1:], dtype=src.dtype)
    return out.index_add_(0, seg, src)
def _pad(x, pw):
    flat = tuple(v for pair in reversed(pw) for v in pair)
    return torch.nn.functional.pad(x, flat)

kernel_name = 'interleave_layers__sliding_block__dense_activation_silu__prompt'

def setup_inputs():

    _w = (lambda a: (lambda t: t.to(torch.bfloat16) if t.is_floating_point() else t)(torch.as_tensor(a)))
    def _A_setup():
        B, S, D = 1, 2048, 640
        return {
            "x": _w((lambda *s: torch.randn(*s, dtype=torch.bfloat16) * 0.05)(B, S, D)),
            "wqkv": _w((lambda *s: torch.randn(*s, dtype=torch.bfloat16) * 0.05)(D, 3 * D)),
            "wo": _w((lambda *s: torch.randn(*s, dtype=torch.bfloat16) * 0.05)(D, D)),
        }
    _A_in = _A_setup()

    def _B_setup():
        B, S, D, F = 1, 2048, 640, 1728
        return {
            "x": _w((lambda *s: torch.randn(*s, dtype=torch.bfloat16) * 0.05)(B, S, D)),
            "w1": _w((lambda *s: torch.randn(*s, dtype=torch.bfloat16) * 0.8)(D, F) * (D ** -0.5)),
            "w2": _w((lambda *s: torch.randn(*s, dtype=torch.bfloat16) * 0.8)(F, D) * (F ** -0.5)),
        }
    _B_in = _B_setup()

    return {
        "A_x": _A_in["x"],
        "A_wqkv": _A_in["wqkv"],
        "A_wo": _A_in["wo"],
        "B_x": _B_in["x"],
        "B_w1": _B_in["w1"],
        "B_w2": _B_in["w2"],
    }

def reference(A_x, A_wqkv, A_wo, B_x, B_w1, B_w2):
    def _A_ref(x, wqkv, wo):
        B, S, D = x.shape
        H = 32; Dh = D // H; W = 256
        qkv = (lambda x, *d: x.permute(*d))((x @ wqkv).reshape(B, S, 3, H, Dh), 2, 0, 3, 1, 4)
        q, k, v = qkv[0], qkv[1], qkv[2]
        scores = torch.einsum("bhqd,bhkd->bhqk", q, k) * (Dh ** -0.5)
        idx = torch.arange(S)
        mask = (idx[:, None] - idx[None, :] >= 0) & (idx[:, None] - idx[None, :] < W)
        scores = torch.where(mask[None, None], scores, -1e9)
        p = _softmax(scores, axis=-1)
        o = torch.einsum("bhqk,bhkd->bhqd", p, v)
        return (lambda x, *d: x.permute(*d))(o, 0, 2, 1, 3).reshape(B, S, D) @ wo

    def _B_ref(x, w1, w2):
        h = torch.einsum("bsd,df->bsf", x, w1)
        h = _silu(h)
        out = torch.einsum("bsf,fd->bsd", h, w2)
        return out

    x = A_x
    x = x + _A_ref(_layernorm(x, axis=-1), A_wqkv, A_wo)
    x = x + _B_ref(_layernorm(x, axis=-1), B_w1, B_w2)
    x = x + _A_ref(_layernorm(x, axis=-1), A_wqkv, A_wo)
    x = x + _B_ref(_layernorm(x, axis=-1), B_w1, B_w2)
    return x
```

```asm
; @launch grid=(256,1,1) block=(256,1,1) lds=163840
.amdgcn_target "amdgcn-amd-amdhsa--gfx950"
.text
.globl interleave_layers__sliding_block__dense_activation_silu__prompt_kernel
.p2align 8
.type interleave_layers__sliding_block__dense_activation_silu__prompt_kernel,@function
interleave_layers__sliding_block__dense_activation_silu__prompt_kernel:
    s_cmp_ge_u32 s2, 256
    s_cbranch_scc1 L_end
    s_load_dwordx16 s[32:47], s[0:1], 0
    s_load_dwordx2 s[48:49], s[0:1], 64
    s_getpc_b64 s[20:21]
L_pc:
    s_lshr_b32 s54, s2, 3
    v_lshrrev_b32 v1, 6, v0
    v_and_b32 v47, 3, v0
    v_lshl_add_u32 v47, v47, 2, v1
    v_lshl_add_u32 v47, v47, 5, s54
    v_lshlrev_b32 v47, 7, v47
    v_min_u32 v47, L_code_end-L_pc-4, v47
    s_mov_b64 exec, 15
    global_load_dword v51, v47, s[20:21]
    s_mov_b64 exec, -1
    v_and_b32 v0, 63, v0
    v_readfirstlane_b32 s3, v1
    v_lshrrev_b32 v28, 2, v0
    v_and_b32 v29, 3, v0
    s_and_b32 s53, s2, 7
    s_and_b32 s57, s54, 15
    s_lshr_b32 s14, s54, 4
    s_mul_i32 s58, s53, 2
    s_add_u32 s58, s58, s14
    s_mul_i32 s60, s3, 16
    s_add_u32 s60, s60, s58
    v_lshlrev_b32 v78, 7, v0
    s_cmp_lt_u32 s60, 40
    s_cselect_b32 s50, 0, 1073741824
    s_min_u32 s60, s60, 39
    v_mul_u32_u24 v46, 3840, v28
    v_lshl_add_u32 v46, v29, 4, v46
    v_add_u32 v46, s50, v46
    v_cmp_eq_u32 vcc, 3, v29
    v_add_u32 v52, 1280, v46
    v_add_u32 v47, 2544, v46
    v_cndmask_b32 v48, v52, v47, vcc
    v_subrev_u32 v47, 16, v46
    v_cndmask_b32 v49, v46, v47, vcc
    v_cmp_le_u32 vcc, 2, v29
    v_add_u32 v47, 2528, v46
    v_add_u32 v53, 1328, v46
    v_cndmask_b32 v52, v52, v47, vcc
    v_cndmask_b32 v53, v53, v48, vcc
    v_add_u32 v54, 2608, v46
    v_subrev_u32 v47, 32, v46
    v_cndmask_b32 v54, v54, v47, vcc
    v_add_u32 v55, 48, v46
    v_cndmask_b32 v55, v55, v49, vcc
    s_mul_i32 s61, s3, 13312
    s_add_u32 s61, s61, 110592
    s_mul_i32 s51, s60, 61440
    s_mul_i32 s59, s57, 80
    s_add_u32 s51, s51, s59
    v_mov_b32 v56, 0
    v_mov_b32 v57, 0
    v_mov_b32 v58, 0
    v_mov_b32 v59, 0
    s_mul_i32 s52, s3, 8192
    s_add_u32 s52, s52, 8052736
    s_add_u32 s59, s52, 4096
    s_mov_b32 s18, 2457600
    s_mov_b32 s19, 0x20000
    s_mov_b32 s6, 268435456
    s_mov_b32 s7, 0x20000
    v_lshlrev_b32 v1, 4, v0
    s_waitcnt lgkmcnt(0)
    s_mov_b64 s[16:17], s[34:35]
    s_mov_b64 s[4:5], s[48:49]
    s_cmp_lg_u32 s2, 0
    s_cbranch_scc1 L_zeroed
    buffer_store_dwordx4 v[56:59], v1, s[4:7], s52 offen offset:0 sc1
    buffer_store_dwordx4 v[56:59], v1, s[4:7], s52 offen offset:1024 sc1
    buffer_store_dwordx4 v[56:59], v1, s[4:7], s52 offen offset:2048 sc1
    buffer_store_dwordx4 v[56:59], v1, s[4:7], s52 offen offset:3072 sc1
    buffer_store_dwordx4 v[56:59], v1, s[4:7], s59 offen offset:0 sc1
    buffer_store_dwordx4 v[56:59], v1, s[4:7], s59 offen offset:1024 sc1
    buffer_store_dwordx4 v[56:59], v1, s[4:7], s59 offen offset:2048 sc1
    buffer_store_dwordx4 v[56:59], v1, s[4:7], s59 offen offset:3072 sc1
    s_mov_b32 s28, s46
    s_mov_b32 s29, s47
    s_mov_b32 s30, 256
    s_mov_b32 s31, 0x20000
    v_mov_b32 v48, 1
    s_lshl_b32 s59, s3, 2
    s_waitcnt vmcnt(0)
    s_mov_b64 exec, 1
    buffer_store_dword v48, v0, s[28:31], s59 offen sc1
    s_mov_b64 exec, -1
L_zeroed:
    s_add_u32 m0, s61, 0
    s_nop 0
    buffer_load_dwordx4 v52, s[16:19], s51 offen lds
    s_add_u32 m0, s61, 1024
    s_nop 0
    buffer_load_dwordx4 v53, s[16:19], s51 offen lds
    s_add_u32 m0, s61, 2048
    s_nop 0
    buffer_load_dwordx4 v54, s[16:19], s51 offen lds
    s_add_u32 m0, s61, 3072
    s_nop 0
    buffer_load_dwordx4 v55, s[16:19], s51 offen lds
    s_mul_i32 s52, s58, 163840
    s_mul_i32 s59, s57, 10240
    s_add_u32 s52, s52, s59
    s_mul_i32 s59, s3, 2560
    s_add_u32 s52, s52, s59
    v_add_u32 v47, s52, v78
    s_mov_b32 s12, s32
    s_mov_b32 s13, s33
    s_mov_b32 s14, 2621440
    s_mov_b32 s15, 0x20000
    s_mov_b64 exec, 1048575
    buffer_load_dword v51, v47, s[12:15], 0 offen
    s_mov_b64 exec, -1
    s_mov_b32 s28, s46
    s_mov_b32 s29, s47
    s_mov_b32 s30, 256
    s_mov_b32 s31, 0x20000
    s_and_b32 s62, s54, 7
    s_and_b32 s63, s54, 1
    s_lshr_b32 s32, s54, 3
    s_mul_i32 s64, s53, 4
    s_add_u32 s64, s64, s32
    s_mul_i32 s32, s54, 128
    s_mul_i32 s59, s3, 4096
    s_add_u32 s32, s32, s59
    s_add_u32 s0, s20, s32
    s_addc_u32 s1, s21, 0
    s_mov_b32 s59, L_pc+2048-L_pc
    s_load_dword s65, s[0:1], s59
    s_add_u32 s59, s59, 64
    s_load_dword s65, s[0:1], s59
    s_mov_b32 s20, s40
    s_mov_b32 s21, s41
    s_mov_b32 s22, 2211840
    s_mov_b32 s23, 0x20000
    s_add_u32 s66, s58, 48
    s_mul_i32 s59, s3, -16
    s_add_u32 s66, s66, s59
    s_cmp_lt_u32 s66, 40
    s_cselect_b32 s67, 0, 1073741824
    s_min_u32 s66, s66, 39
    s_mul_i32 s32, s66, 55296
    s_mul_i32 s59, s57, 216
    s_add_u32 s32, s32, s59
    s_add_u32 s32, s32, s67
    v_mul_u32_u24 v46, 3456, v28
    v_add_u32 v46, s32, v46
    v_lshl_add_u32 v16, v29, 4, v46
    v_min_u32 v47, 1, v29
    v_lshl_add_u32 v17, v47, 4, v46
    v_add_u32 v17, 192, v17
    s_add_u32 s32, s3, 1
    s_and_b32 s32, s32, 3
    s_lshr_b32 s33, s32, 1
    s_xor_b32 s32, s32, s33
    s_mul_i32 s68, s32, 32
    s_add_u32 s68, s68, s64
    s_cmp_lt_u32 s68, 76
    s_cselect_b32 s69, 0, 1073741824
    s_min_u32 s68, s68, 75
    s_cmp_lt_u32 s68, 56
    s_cselect_b32 s24, s42, s36
    s_cselect_b32 s25, s43, s37
    s_mov_b32 s26, 819200
    s_cselect_b32 s26, 2211840, s26
    s_mov_b32 s27, 0x20000
    s_cbranch_scc0 L_unit_wo
    s_mul_i32 s32, s68, 4682
    s_lshr_b32 s32, s32, 16
    s_mul_i32 s33, s32, -14
    s_add_u32 s33, s33, s68
    s_mul_i32 s53, s62, 286720
    s_mul_i32 s59, s68, 5120
    s_add_u32 s53, s53, s59
    s_add_u32 s53, s53, 5496832
    s_cmp_lt_u32 s33, 12
    s_cselect_b32 s36, 4, 8
    s_cselect_b32 s37, 16, 4
    s_cbranch_scc0 L_unit_w2l
    s_lshr_b32 s39, s33, 1
    s_and_b32 s40, s33, 1
    s_sub_u32 s33, s33, 8
    s_cselect_b32 s39, s39, s33
    s_cselect_b32 s40, s40, 2
    s_mul_i32 s34, s32, 432
    s_mul_i32 s59, s39, 108
    s_add_u32 s34, s34, s59
    s_mul_i32 s59, s40, 32
    s_add_u32 s34, s34, s59
    s_mov_b32 s35, 8
    s_mov_b32 s38, 0
    s_branch L_unit_done
L_unit_w2l:
    s_mul_i32 s34, s32, 432
    s_mul_i32 s59, s33, 216
    s_add_u32 s34, s34, s59
    s_add_u32 s34, s34, 4294964800
    s_mov_b32 s35, 108
    s_mov_b32 s38, 1073741824
    s_branch L_unit_done
L_unit_wo:
    s_sub_u32 s39, s68, 56
    s_mul_i32 s32, s39, 13108
    s_lshr_b32 s32, s32, 16
    s_mul_i32 s33, s32, -5
    s_add_u32 s33, s33, s39
    s_mul_i32 s53, s62, 102400
    s_mul_i32 s59, s39, 5120
    s_add_u32 s53, s53, s59
    s_add_u32 s53, s53, 4677632
    s_mul_i32 s34, s32, 160
    s_and_b32 s40, s33, 1
    s_mul_i32 s40, s40, 80
    s_lshr_b32 s38, s33, 1
    s_mul_i32 s38, s38, 24
    s_add_u32 s40, s40, s38
    s_mov_b32 s38, 0
    s_cmp_lt_u32 s33, 4
    s_cselect_b32 s40, s40, 16
    s_cselect_b32 s35, 40, 80
    s_cselect_b32 s36, 4, 40
    s_cselect_b32 s37, 8, 4
    s_add_u32 s34, s34, s40
L_unit_done:
    v_bfe_u32 v47, v0, 1, 2
    v_add_u32 v18, s34, v47
    v_lshrrev_b32 v47, 5, v0
    v_mad_u32_u24 v18, v47, s35, v18
    v_bfe_u32 v47, v0, 4, 1
    v_mad_u32_u24 v18, v47, s36, v18
    v_bfe_u32 v48, v0, 3, 1
    v_mad_u32_u24 v18, v48, s37, v18
    v_mul_u32_u24 v18, 1280, v18
    v_and_b32 v47, v47, v48
    v_mul_lo_u32 v47, v47, s38
    v_or_b32 v47, s69, v47
    v_add_u32 v18, v18, v47
    v_and_b32 v47, 1, v0
    v_lshl_add_u32 v18, v47, 4, v18
    s_mul_i32 s40, s62, 160
    v_add_u32 v18, s40, v18
    s_mov_b32 s70, 0x3f803f80
    s_mov_b32 s48, 0
    s_mov_b32 s49, -1
    s_and_b32 s37, s60, 1
    s_lshr_b32 s36, s60, 1
    v_lshrrev_b32 v47, 5, v0
    v_bfe_u32 v48, v0, 2, 2
    v_bfe_u32 v49, v0, 4, 1
    v_lshl_add_u32 v19, v49, 3, v48
    v_lshlrev_b32 v19, 6, v19
    v_lshl_add_u32 v19, v47, 5, v19
    v_add_u32 v19, s61, v19
    v_and_b32 v65, 1, v29
    v_lshl_add_u32 v65, v65, 4, v19
    v_lshrrev_b32 v46, 1, v29
    v_lshl_add_u32 v65, v46, 3, v65
    v_lshl_add_u32 v19, v29, 3, v19
    v_cndmask_b32 v65, v19, v65, s[48:49]
    v_lshl_add_u32 v22, v47, 9, v1
    v_lshlrev_b32 v23, 6, v49
    v_sub_u32 v23, v1, v23
    v_add_u32 v62, s50, v22
    v_bfe_u32 v46, v0, 3, 2
    v_lshl_add_u32 v46, v46, 2, v29
    v_lshlrev_b32 v46, 4, v46
    v_lshl_add_u32 v46, s37, 8, v46
    v_add_u32 v46, 1024, v46
    v_lshl_add_u32 v61, s37, 9, v1
    v_cndmask_b32 v61, v61, v46, s[48:49]
    v_add_u32 v61, s50, v61
    v_lshlrev_b32 v63, 3, v0
    v_add_u32 v68, 110592, v63
    v_add_u32 v63, s61, v63
    v_lshlrev_b32 v64, 2, v29
    s_mul_i32 s71, s57, 153600
    s_mul_i32 s72, s57, 8192
    s_add_u32 s72, s72, 7790592
    s_mul_i32 s73, s57, 2048
    s_mul_i32 s59, s58, 128
    s_add_u32 s73, s73, s59
    s_add_u32 s73, s73, 8085504
    s_mul_i32 s32, s58, 2048
    s_mul_i32 s59, s57, 128
    s_add_u32 s32, s32, s59
    s_add_u32 s32, s32, 8118272
    s_cmp_eq_u32 s3, 0
    s_cselect_b32 s55, s73, s32
    s_mul_i32 s32, s36, 5120
    s_mul_i32 s59, s37, 512
    s_add_u32 s32, s32, s59
    s_add_u32 s32, s32, s71
    s_mul_i32 s33, s36, 2560
    s_add_u32 s33, s33, s71
    s_add_u32 s33, s33, 103424
    s_mul_i32 s34, s58, 512
    s_add_u32 s34, s34, s72
    s_add_u32 s35, s32, 4096
    s_mul_i32 s36, s36, -2560
    s_add_u32 s36, s36, 97280
    v_mad_u32_u24 v69, v47, s36, v62
    s_mul_i32 s56, s3, 4160
    s_add_u32 s56, s56, 60672
    s_mov_b32 s8, s44
    s_mov_b32 s9, s45
    s_mov_b32 s10, 2621440
    s_mov_b32 s11, 0x20000
    v_lshrrev_b32 v46, 3, v0
    v_mul_u32_u24 v46, 5120, v46
    v_and_b32 v48, 4, v28
    v_xor_b32 v48, v48, v0
    v_and_b32 v48, 7, v48
    v_lshl_add_u32 v5, v48, 4, v46
    v_add_u32 v6, 240, v5
    v_add_u32 v7, 480, v5
    v_add_u32 v8, 720, v5
    v_mul_u32_u24 v46, 1040, v29
    v_add_u32 v46, s56, v46
    v_bfe_u32 v48, v0, 2, 2
    v_lshl_add_u32 v46, v48, 7, v46
    v_lshrrev_b32 v47, 4, v0
    v_lshl_add_u32 v46, v47, 4, v46
    v_bfe_u32 v48, v0, 3, 1
    v_lshl_add_u32 v40, v48, 6, v46
    v_xor_b32 v48, 1, v48
    v_lshl_add_u32 v41, v48, 6, v46
    v_add_u32 v9, 49920, v40
    v_add_u32 v10, 49920, v41
    v_lshlrev_b32 v14, 3, v0
    v_add_u32 v2, 0x10000, v1
    v_add_u32 v3, 0x20000, v1
    v_bfe_u32 v48, v0, 2, 2
    v_lshrrev_b32 v47, 4, v0
    v_lshl_add_u32 v47, v47, 3, v48
    v_lshlrev_b32 v47, 5, v47
    v_add_u32 v47, s61, v47
    v_lshl_add_u32 v21, v29, 3, v47
    v_lshrrev_b32 v48, 1, v29
    v_lshl_add_u32 v20, v48, 10, v47
    v_and_b32 v48, 1, v29
    v_lshl_add_u32 v20, v48, 4, v20
    v_bfe_u32 v47, v0, 2, 1
    v_lshlrev_b32 v47, 7, v47
    v_lshrrev_b32 v48, 3, v0
    s_lshl_b32 s37, s57, 3
    v_add3_u32 v47, v47, v48, s37
    v_lshl_add_u32 v66, v47, 7, v64
    v_add_u32 v66, 8052736, v66
    s_lshl_b32 s74, s3, 12
    s_getreg_b32 s54, hwreg(HW_REG_XCC_ID)
    s_and_b32 s54, s54, 15
    s_add_u32 s54, s54, 1
    v_mov_b32 v50, s54
    s_mul_i32 s75, s2, 128
    s_mul_i32 s59, s3, 4
    s_add_u32 s75, s75, s59
    s_add_u32 s75, s75, 8052736
    s_mul_i32 s76, s58, 163840
    s_mul_i32 s59, s3, 40960
    s_add_u32 s76, s76, s59
    s_mov_b32 s51, s71
    s_add_u32 s51, s51, s74
    s_waitcnt vmcnt(1)
    ds_read_b64_tr_b16 v[84:85], v19 offset:0
    ds_read_b64_tr_b16 v[86:87], v19 offset:256
    ds_read_b64_tr_b16 v[88:89], v65 offset:1024
    ds_read_b64_tr_b16 v[90:91], v65 offset:1280
    ds_read_b64_tr_b16 v[92:93], v19 offset:2048
    ds_read_b64_tr_b16 v[94:95], v19 offset:2304
    ds_read_b64_tr_b16 v[96:97], v65 offset:3072
    ds_read_b64_tr_b16 v[98:99], v65 offset:3328
    s_waitcnt lgkmcnt(0)
    buffer_store_dwordx4 v[84:87], v62, s[4:7], s32 offen offset:0 sc1
    buffer_store_dwordx4 v[88:91], v62, s[4:7], s32 offen offset:2048 sc1
    buffer_store_dwordx4 v[92:95], v69, s[4:7], s35 offen offset:0 sc1
    s_mov_b32 exec_hi, 0xf0f0f0f
    buffer_store_dwordx4 v[96:99], v61, s[4:7], s33 offen sc1
    s_cmp_lt_u32 s3, 2
    s_cselect_b32 exec_lo, 0xff, 0
    s_mov_b32 exec_hi, 0
    buffer_store_dwordx4 v[56:59], v1, s[4:7], s55 offen sc1
    s_mov_b64 exec, -1
    v_dot2_f32_bf16 v34, v84, s70, 0
    v_dot2_f32_bf16 v36, v88, s70, 0
    v_dot2_f32_bf16 v35, v92, s70, 0
    v_dot2_f32_bf16 v37, v96, s70, 0
    v_dot2_f32_bf16 v34, v85, s70, v34
    v_dot2_f32_bf16 v36, v89, s70, v36
    v_dot2_f32_bf16 v35, v93, s70, v35
    v_dot2_f32_bf16 v37, v97, s70, v37
    v_dot2_f32_bf16 v34, v86, s70, v34
    v_dot2_f32_bf16 v36, v90, s70, v36
    v_dot2_f32_bf16 v35, v94, s70, v35
    v_dot2_f32_bf16 v37, v98, s70, v37
    v_dot2_f32_bf16 v34, v87, s70, v34
    v_dot2_f32_bf16 v36, v91, s70, v36
    v_dot2_f32_bf16 v35, v95, s70, v35
    v_dot2_f32_bf16 v37, v99, s70, v37
    s_nop 0
    v_permlane16_swap_b32 v34, v36
    s_nop 0
    v_permlane16_swap_b32 v35, v37
    v_add_f32 v34, v34, v36
    v_add_f32 v35, v35, v37
    ds_write_b64 v63, v[34:35] offset:3072
    s_waitcnt lgkmcnt(0)
    s_barrier
    ds_read_b64 v[70:71], v68 offset:3072
    ds_read_b64 v[72:73], v68 offset:16384
    ds_read_b64 v[74:75], v68 offset:29696
    ds_read_b64 v[76:77], v68 offset:43008
    s_waitcnt lgkmcnt(2)
    v_pk_add_f32 v[70:71], v[70:71], v[72:73]
    s_waitcnt lgkmcnt(0)
    v_pk_add_f32 v[74:75], v[74:75], v[76:77]
    v_pk_add_f32 v[70:71], v[70:71], v[74:75]
    s_cmp_eq_u32 s3, 3
    s_cselect_b64 exec, -1, 0
    buffer_store_dwordx2 v[70:71], v14, s[4:7], s34 offen sc1
    s_mov_b64 exec, -1
    buffer_load_dword v42, v64, s[28:31], 0 offen sc1
    s_add_u32 m0, s61, 4096
    s_mov_b32 s42, 0
    buffer_load_dwordx4 v16, s[20:23], s42 offen lds
    s_add_u32 m0, s61, 5120
    s_mov_b32 s42, 64
    buffer_load_dwordx4 v16, s[20:23], s42 offen lds
    s_add_u32 m0, s61, 6144
    s_mov_b32 s42, 128
    buffer_load_dwordx4 v16, s[20:23], s42 offen lds
    s_add_u32 m0, s61, 7168
    s_mov_b32 s42, 0
    buffer_load_dwordx4 v17, s[20:23], s42 offen lds
    s_add_u32 m0, s61, 8192
    s_mul_i32 s42, s63, 32
    buffer_load_dwordx4 v18, s[24:27], s42 offen lds
    s_add_u32 m0, s61, 9216
    s_mul_i32 s42, s63, 32
    s_add_u32 s42, s42, 32
    buffer_load_dwordx4 v18, s[24:27], s42 offen lds
    s_add_u32 m0, s61, 10240
    s_mul_i32 s42, s63, 32
    s_add_u32 s42, s42, 64
    buffer_load_dwordx4 v18, s[24:27], s42 offen lds
    s_add_u32 m0, s61, 11264
    s_mul_i32 s42, s63, 32
    s_add_u32 s42, s42, 96
    buffer_load_dwordx4 v18, s[24:27], s42 offen lds
    s_add_u32 m0, s61, 12288
    s_mul_i32 s42, s63, -128
    s_add_u32 s42, s42, 128
    buffer_load_dwordx4 v18, s[24:27], s42 offen lds
    s_mov_b32 s16, s4
    s_mov_b32 s17, s5
    s_mov_b32 s77, 0xff800000
    s_lshr_b32 s35, s3, 1
    s_and_b32 s37, s3, 1
    s_lshr_b32 s38, s57, 2
    s_and_b32 s39, s57, 3
    s_and_b32 s33, s64, 1
    s_cmp_eq_u32 s69, 0
    s_cselect_b32 s18, 268435456, 0
    s_mul_i32 s78, s57, 138240
    s_add_u32 s78, s78, 2461696
    s_mul_i32 s79, s3, 3072
    s_add_u32 s79, s79, 81920
    s_mul_i32 s34, s58, 4
    s_add_u32 s34, s34, s3
    s_mul_i32 s41, s58, 2048
    s_add_u32 s41, s41, 8118272
    s_mov_b32 s52, s78
    s_add_u32 s52, s52, s74
    s_mul_i32 s80, s34, 40960
    s_add_u32 s80, s80, 8282112
    s_mul_i32 s81, s58, 8192
    s_mul_i32 s59, s35, 4096
    s_add_u32 s81, s81, s59
    s_mul_i32 s59, s37, 256
    s_add_u32 s81, s81, s59
    s_add_u32 s81, s81, 8151040
    s_mul_i32 s82, s64, 81920
    s_mul_i32 s59, s35, 40960
    s_add_u32 s82, s82, s59
    s_add_u32 s82, s82, 8282112
    s_mul_i32 s59, s62, 5120
    s_add_u32 s82, s82, s59
    s_mul_i32 s59, s63, -5120
    s_add_u32 s82, s82, s59
    s_mul_i32 s59, s37, 1024
    s_add_u32 s82, s82, s59
    s_mul_i32 s83, s64, 81920
    s_mul_i32 s59, s3, 20480
    s_add_u32 s83, s83, s59
    s_mul_i32 s59, s62, 160
    s_add_u32 s83, s83, s59
    s_mul_i32 s84, s64, 4096
    s_mul_i32 s59, s62, 512
    s_add_u32 s84, s84, s59
    s_mul_i32 s59, s3, 128
    s_add_u32 s84, s84, s59
    s_add_u32 s84, s84, 8151040
    s_mul_i32 s32, s34, 114688
    s_mul_i32 s59, s38, 14336
    s_add_u32 s32, s32, s59
    s_add_u32 s32, s32, 10903552
    s_mul_i32 s85, s39, 512
    s_add_u32 s85, s85, s32
    s_mul_i32 s86, s39, 256
    s_add_u32 s86, s86, s32
    s_add_u32 s86, s86, 4096
    s_mul_i32 s87, s39, 2048
    s_add_u32 s87, s87, s32
    s_mul_i32 s88, s39, 1024
    s_add_u32 s88, s88, s32
    s_add_u32 s88, s88, 8192
    s_mul_i32 s89, s39, 512
    s_add_u32 s89, s89, s32
    s_add_u32 s89, s89, 12288
    s_mul_i32 s90, s64, 229376
    s_mul_i32 s59, s3, 14336
    s_add_u32 s90, s90, s59
    s_add_u32 s90, s90, 10903552
    s_mul_i32 s91, s62, 102400
    s_mul_i32 s59, s3, 25600
    s_add_u32 s91, s91, s59
    s_add_u32 s91, s91, 4677632
    s_mul_i32 s92, s62, 286720
    s_mul_i32 s59, s3, 71680
    s_add_u32 s92, s92, s59
    s_add_u32 s92, s92, 5496832
    s_mul_i32 s93, s57, 360448
    s_mul_i32 s59, s34, 3072
    s_add_u32 s93, s93, s59
    s_add_u32 s93, s93, 18243584
    s_mul_i32 s94, s34, -512
    s_add_u32 s94, s94, 196608
    s_mul_i32 s95, s3, 2560
    s_add_u32 s95, s95, 133120
    s_mov_b32 s96, s93
    s_add_u32 s96, s96, s94
    s_mul_i32 s59, s3, 2560
    s_add_u32 s96, s96, s59
    s_add_u32 s97, s73, 4294967040
    s_mul_i32 s59, s3, 4
    s_add_u32 s73, s73, s59
    s_mul_i32 s98, s33, 256
    s_mul_i32 s59, s35, 128
    s_add_u32 s98, s98, s59
    s_add_u32 s98, s98, s41
    s_mul_i32 s59, s62, 8
    s_add_u32 s98, s98, s59
    s_mul_i32 s59, s37, 4
    s_add_u32 s98, s98, s59
    s_mul_i32 s99, s3, 128
    s_add_u32 s99, s99, s41
    s_mul_i32 s100, s33, 512
    s_add_u32 s100, s100, s99
    s_add_u32 s100, s100, 512
    s_mul_i32 s101, s35, 512
    s_mul_i32 s59, s38, 128
    s_add_u32 s101, s101, s59
    s_add_u32 s101, s101, s41
    s_add_u32 s101, s101, 512
    s_mul_i32 s59, s39, 8
    s_add_u32 s101, s101, s59
    s_mul_i32 s59, s37, 4
    s_add_u32 s101, s101, s59
    v_mul_u32_u24 v52, 1280, v28
    v_lshl_add_u32 v52, v29, 4, v52
    v_lshl_add_u32 v52, s63, 5, v52
    v_lshrrev_b32 v53, 1, v0
    v_mul_u32_u24 v53, 1280, v53
    v_and_b32 v47, 1, v0
    v_lshl_add_u32 v53, v47, 4, v53
    v_and_b32 v54, 15, v0
    v_lshrrev_b32 v47, 4, v0
    v_lshl_add_u32 v54, v54, 2, v47
    v_lshl_add_u32 v55, v54, 3, s61
    v_lshl_add_u32 v54, v54, 4, s61
    s_add_u32 m0, s56, 0
    s_add_u32 s42, s76, 0
    buffer_load_dwordx4 v5, s[12:15], s42 offen offset:0 lds
    buffer_load_dwordx4 v6, s[12:15], s42 offen offset:1040 lds
    buffer_load_dwordx4 v7, s[12:15], s42 offen offset:2080 lds
    buffer_load_dwordx4 v8, s[12:15], s42 offen offset:3120 lds
    s_waitcnt vmcnt(13)
    v_cmp_gt_u32 vcc, 1, v42
    s_nop 0
    s_cbranch_vccz L_booted
L_boot:
    s_mov_b32 s45, 200000
L_boot_b:
    buffer_load_dword v42, v64, s[28:31], 0 offen sc1
    s_sub_u32 s45, s45, 1
    s_cbranch_scc1 L_boot_c
    s_waitcnt vmcnt(0)
    v_cmp_gt_u32 vcc, 1, v42
    s_nop 0
    s_cbranch_vccnz L_boot_b
L_boot_c:
    s_waitcnt vmcnt(0)
    s_branch L_booted
L_booted:
    s_mov_b64 exec, 1
    buffer_store_dword v50, v0, s[4:7], s75 offen offset:0 sc1
    s_mov_b64 exec, -1
    s_mov_b64 s[28:29], s[4:5]
    s_cmp_eq_u32 s67, 0
    s_cselect_b32 s30, 268435456, 0
    s_add_u32 m0, s56, 16640
    s_add_u32 s42, s76, 128
    buffer_load_dwordx4 v5, s[12:15], s42 offen offset:0 lds
    buffer_load_dwordx4 v6, s[12:15], s42 offen offset:1040 lds
    buffer_load_dwordx4 v7, s[12:15], s42 offen offset:2080 lds
    buffer_load_dwordx4 v8, s[12:15], s42 offen offset:3120 lds
    s_waitcnt vmcnt(9)
    ds_read_b64_tr_b16 v[100:101], v19 offset:4096
    ds_read_b64_tr_b16 v[102:103], v19 offset:4352
    ds_read_b64_tr_b16 v[104:105], v19 offset:5120
    ds_read_b64_tr_b16 v[106:107], v19 offset:5376
    ds_read_b64_tr_b16 v[108:109], v19 offset:6144
    ds_read_b64_tr_b16 v[110:111], v19 offset:6400
    ds_read_b64_tr_b16 v[112:113], v19 offset:7168
    ds_read_b64_tr_b16 v[114:115], v19 offset:7424
    ds_read_b64_tr_b16 a[40:41], v20 offset:8192
    ds_read_b64_tr_b16 a[42:43], v20 offset:8320
    ds_read_b64_tr_b16 a[44:45], v20 offset:8200
    ds_read_b64_tr_b16 a[46:47], v20 offset:8328
    ds_read_b64_tr_b16 a[48:49], v20 offset:10240
    ds_read_b64_tr_b16 a[50:51], v20 offset:10368
    ds_read_b64_tr_b16 a[52:53], v20 offset:10248
    ds_read_b64_tr_b16 a[54:55], v20 offset:10376
    ds_read_b64_tr_b16 a[56:57], v21 offset:12288
    ds_read_b64_tr_b16 a[58:59], v21 offset:12416
    s_add_u32 m0, s56, 33280
    s_add_u32 s42, s76, 256
    buffer_load_dwordx4 v5, s[12:15], s42 offen offset:0 lds
    s_waitcnt lgkmcnt(15)
    v_dot2_f32_bf16 v76, v100, s70, 0
    v_dot2_f32_bf16 v78, v104, s70, 0
    s_waitcnt lgkmcnt(13)
    v_dot2_f32_bf16 v77, v108, s70, 0
    s_waitcnt lgkmcnt(11)
    v_dot2_f32_bf16 v79, v112, s70, 0
    v_dot2_f32_bf16 v76, v101, s70, v76
    v_dot2_f32_bf16 v78, v105, s70, v78
    buffer_load_dwordx4 v6, s[12:15], s42 offen offset:1040 lds
    v_dot2_f32_bf16 v77, v109, s70, v77
    v_dot2_f32_bf16 v79, v113, s70, v79
    v_dot2_f32_bf16 v76, v102, s70, v76
    v_dot2_f32_bf16 v78, v106, s70, v78
    v_dot2_f32_bf16 v77, v110, s70, v77
    s_waitcnt lgkmcnt(10)
    v_dot2_f32_bf16 v79, v114, s70, v79
    buffer_load_dwordx4 v7, s[12:15], s42 offen offset:2080 lds
    v_dot2_f32_bf16 v76, v103, s70, v76
    v_dot2_f32_bf16 v78, v107, s70, v78
    v_dot2_f32_bf16 v77, v111, s70, v77
    v_dot2_f32_bf16 v79, v115, s70, v79
    s_nop 0
    v_permlane16_swap_b32 v76, v78
    s_nop 0
    v_permlane16_swap_b32 v77, v79
    buffer_load_dwordx4 v8, s[12:15], s42 offen offset:3120 lds
    v_add_f32 v76, v76, v78
    v_add_f32 v77, v77, v79
    ds_write_b64 v63, v[76:77] offset:3584
    s_waitcnt vmcnt(9)
    ds_read_b128 a[204:207], v40 offset:0
    ds_read_b128 v[80:83], v40 offset:0
    ds_read_b128 a[208:211], v40 offset:512
    ds_read_b128 v[84:87], v40 offset:512
    ds_read_b128 a[212:215], v41 offset:0
    ds_read_b128 v[88:91], v41 offset:0
    ds_read_b128 a[216:219], v41 offset:512
    ds_read_b128 v[92:95], v41 offset:512
    s_waitcnt lgkmcnt(0)
    s_add_u32 m0, s56, 0
    s_add_u32 s42, s76, 384
    buffer_load_dwordx4 v5, s[12:15], s42 offen offset:0 lds
    v_dot2_f32_bf16 v34, v80, s70, 0
    v_dot2_f32_bf16 v35, v80, v80, 0
    v_dot2_f32_bf16 v34, v81, s70, v34
    v_dot2_f32_bf16 v35, v81, v81, v35
    v_dot2_f32_bf16 v34, v82, s70, v34
    v_dot2_f32_bf16 v35, v82, v82, v35
    v_dot2_f32_bf16 v34, v83, s70, v34
    v_dot2_f32_bf16 v35, v83, v83, v35
    buffer_load_dwordx4 v6, s[12:15], s42 offen offset:1040 lds
    v_dot2_f32_bf16 v36, v84, s70, 0
    v_dot2_f32_bf16 v37, v84, v84, 0
    v_dot2_f32_bf16 v36, v85, s70, v36
    v_dot2_f32_bf16 v37, v85, v85, v37
    v_dot2_f32_bf16 v36, v86, s70, v36
    v_dot2_f32_bf16 v37, v86, v86, v37
    v_dot2_f32_bf16 v36, v87, s70, v36
    v_dot2_f32_bf16 v37, v87, v87, v37
    buffer_load_dwordx4 v7, s[12:15], s42 offen offset:2080 lds
    v_dot2_f32_bf16 v34, v88, s70, v34
    v_dot2_f32_bf16 v35, v88, v88, v35
    v_dot2_f32_bf16 v34, v89, s70, v34
    v_dot2_f32_bf16 v35, v89, v89, v35
    v_dot2_f32_bf16 v34, v90, s70, v34
    v_dot2_f32_bf16 v35, v90, v90, v35
    v_dot2_f32_bf16 v34, v91, s70, v34
    v_dot2_f32_bf16 v35, v91, v91, v35
    buffer_load_dwordx4 v8, s[12:15], s42 offen offset:3120 lds
    v_dot2_f32_bf16 v36, v92, s70, v36
    v_dot2_f32_bf16 v37, v92, v92, v37
    v_dot2_f32_bf16 v36, v93, s70, v36
    v_dot2_f32_bf16 v37, v93, v93, v37
    v_dot2_f32_bf16 v36, v94, s70, v36
    v_dot2_f32_bf16 v37, v94, v94, v37
    v_dot2_f32_bf16 v36, v95, s70, v36
    v_dot2_f32_bf16 v37, v95, v95, v37
    buffer_store_dwordx4 a[40:43], v1, s[16:19], s53 offen offset:0 sc1
    buffer_store_dwordx4 a[44:47], v1, s[16:19], s53 offen offset:1024 sc1
    s_waitcnt vmcnt(10)
    ds_read_b128 a[220:223], v40 offset:16640
    ds_read_b128 v[96:99], v40 offset:16640
    ds_read_b128 v[116:119], v40 offset:17152
    ds_read_b128 v[120:123], v41 offset:16640
    ds_read_b128 v[124:127], v41 offset:17152
    s_waitcnt lgkmcnt(0)
    s_add_u32 m0, s56, 16640
    s_add_u32 s42, s76, 512
    buffer_load_dwordx4 v5, s[12:15], s42 offen offset:0 lds
    v_dot2_f32_bf16 v34, v96, s70, v34
    v_dot2_f32_bf16 v35, v96, v96, v35
    v_dot2_f32_bf16 v34, v97, s70, v34
    v_dot2_f32_bf16 v35, v97, v97, v35
    v_dot2_f32_bf16 v34, v98, s70, v34
    v_dot2_f32_bf16 v35, v98, v98, v35
    v_dot2_f32_bf16 v34, v99, s70, v34
    v_dot2_f32_bf16 v35, v99, v99, v35
    buffer_load_dwordx4 v6, s[12:15], s42 offen offset:1040 lds
    v_dot2_f32_bf16 v36, v116, s70, v36
    v_dot2_f32_bf16 v37, v116, v116, v37
    v_dot2_f32_bf16 v36, v117, s70, v36
    v_dot2_f32_bf16 v37, v117, v117, v37
    v_dot2_f32_bf16 v36, v118, s70, v36
    v_dot2_f32_bf16 v37, v118, v118, v37
    v_dot2_f32_bf16 v36, v119, s70, v36
    v_dot2_f32_bf16 v37, v119, v119, v37
    buffer_load_dwordx4 v7, s[12:15], s42 offen offset:2080 lds
    v_dot2_f32_bf16 v34, v120, s70, v34
    v_dot2_f32_bf16 v35, v120, v120, v35
    v_dot2_f32_bf16 v34, v121, s70, v34
    v_dot2_f32_bf16 v35, v121, v121, v35
    v_dot2_f32_bf16 v34, v122, s70, v34
    v_dot2_f32_bf16 v35, v122, v122, v35
    v_dot2_f32_bf16 v34, v123, s70, v34
    v_dot2_f32_bf16 v35, v123, v123, v35
    buffer_load_dwordx4 v8, s[12:15], s42 offen offset:3120 lds
    v_dot2_f32_bf16 v36, v124, s70, v36
    v_dot2_f32_bf16 v37, v124, v124, v37
    v_dot2_f32_bf16 v36, v125, s70, v36
    v_dot2_f32_bf16 v37, v125, v125, v37
    v_dot2_f32_bf16 v36, v126, s70, v36
    v_dot2_f32_bf16 v37, v126, v126, v37
    v_dot2_f32_bf16 v36, v127, s70, v36
    v_dot2_f32_bf16 v37, v127, v127, v37
    buffer_store_dwordx4 a[48:51], v1, s[16:19], s53 offen offset:2048 sc1
    buffer_store_dwordx4 a[52:55], v1, s[16:19], s53 offen offset:3072 sc1
    s_waitcnt vmcnt(12)
    ds_read_b128 v[128:131], v40 offset:33280
    ds_read_b128 v[132:135], v40 offset:33792
    ds_read_b128 v[136:139], v41 offset:33280
    ds_read_b128 v[140:143], v41 offset:33792
    s_waitcnt lgkmcnt(0)
    s_add_u32 m0, s56, 33280
    s_add_u32 s42, s76, 640
    buffer_load_dwordx4 v5, s[12:15], s42 offen offset:0 lds
    v_dot2_f32_bf16 v34, v128, s70, v34
    v_dot2_f32_bf16 v35, v128, v128, v35
    v_dot2_f32_bf16 v34, v129, s70, v34
    v_dot2_f32_bf16 v35, v129, v129, v35
    v_dot2_f32_bf16 v34, v130, s70, v34
    v_dot2_f32_bf16 v35, v130, v130, v35
    v_dot2_f32_bf16 v34, v131, s70, v34
    v_dot2_f32_bf16 v35, v131, v131, v35
    buffer_load_dwordx4 v6, s[12:15], s42 offen offset:1040 lds
    v_dot2_f32_bf16 v36, v132, s70, v36
    v_dot2_f32_bf16 v37, v132, v132, v37
    v_dot2_f32_bf16 v36, v133, s70, v36
    v_dot2_f32_bf16 v37, v133, v133, v37
    v_dot2_f32_bf16 v36, v134, s70, v36
    v_dot2_f32_bf16 v37, v134, v134, v37
    v_dot2_f32_bf16 v36, v135, s70, v36
    v_dot2_f32_bf16 v37, v135, v135, v37
    buffer_load_dwordx4 v7, s[12:15], s42 offen offset:2080 lds
    v_dot2_f32_bf16 v34, v136, s70, v34
    v_dot2_f32_bf16 v35, v136, v136, v35
    v_dot2_f32_bf16 v34, v137, s70, v34
    v_dot2_f32_bf16 v35, v137, v137, v35
    v_dot2_f32_bf16 v34, v138, s70, v34
    v_dot2_f32_bf16 v35, v138, v138, v35
    v_dot2_f32_bf16 v34, v139, s70, v34
    v_dot2_f32_bf16 v35, v139, v139, v35
    buffer_load_dwordx4 v8, s[12:15], s42 offen offset:3120 lds
    v_dot2_f32_bf16 v36, v140, s70, v36
    v_dot2_f32_bf16 v37, v140, v140, v37
    v_dot2_f32_bf16 v36, v141, s70, v36
    v_dot2_f32_bf16 v37, v141, v141, v37
    v_dot2_f32_bf16 v36, v142, s70, v36
    v_dot2_f32_bf16 v37, v142, v142, v37
    v_dot2_f32_bf16 v36, v143, s70, v36
    v_dot2_f32_bf16 v37, v143, v143, v37
    s_add_u32 s32, s53, 4096
    buffer_store_dwordx4 a[56:59], v1, s[16:19], s32 offen sc1
    s_and_b32 s33, s66, 1
    s_mul_i32 s32, s66, 2048
    s_mul_i32 s59, s33, -1536
    s_add_u32 s32, s32, s59
    s_add_u32 s32, s32, s78
    buffer_store_dwordx4 v[100:103], v22, s[28:31], s32 offen sc1
    s_waitcnt vmcnt(14)
    ds_read_b128 v[144:147], v40 offset:0
    ds_read_b128 v[148:151], v40 offset:512
    ds_read_b128 v[152:155], v41 offset:0
    ds_read_b128 v[156:159], v41 offset:512
    s_waitcnt lgkmcnt(0)
    s_add_u32 m0, s56, 0
    s_add_u32 s42, s76, 768
    buffer_load_dwordx4 v5, s[12:15], s42 offen offset:0 lds
    v_dot2_f32_bf16 v34, v144, s70, v34
    v_dot2_f32_bf16 v35, v144, v144, v35
    v_dot2_f32_bf16 v34, v145, s70, v34
    v_dot2_f32_bf16 v35, v145, v145, v35
    v_dot2_f32_bf16 v34, v146, s70, v34
    v_dot2_f32_bf16 v35, v146, v146, v35
    v_dot2_f32_bf16 v34, v147, s70, v34
    v_dot2_f32_bf16 v35, v147, v147, v35
    buffer_load_dwordx4 v6, s[12:15], s42 offen offset:1040 lds
    v_dot2_f32_bf16 v36, v148, s70, v36
    v_dot2_f32_bf16 v37, v148, v148, v37
    v_dot2_f32_bf16 v36, v149, s70, v36
    v_dot2_f32_bf16 v37, v149, v149, v37
    v_dot2_f32_bf16 v36, v150, s70, v36
    v_dot2_f32_bf16 v37, v150, v150, v37
    v_dot2_f32_bf16 v36, v151, s70, v36
    v_dot2_f32_bf16 v37, v151, v151, v37
    buffer_load_dwordx4 v7, s[12:15], s42 offen offset:2080 lds
    v_dot2_f32_bf16 v34, v152, s70, v34
    v_dot2_f32_bf16 v35, v152, v152, v35
    v_dot2_f32_bf16 v34, v153, s70, v34
    v_dot2_f32_bf16 v35, v153, v153, v35
    v_dot2_f32_bf16 v34, v154, s70, v34
    v_dot2_f32_bf16 v35, v154, v154, v35
    v_dot2_f32_bf16 v34, v155, s70, v34
    v_dot2_f32_bf16 v35, v155, v155, v35
    buffer_load_dwordx4 v8, s[12:15], s42 offen offset:3120 lds
    v_dot2_f32_bf16 v36, v156, s70, v36
    v_dot2_f32_bf16 v37, v156, v156, v37
    v_dot2_f32_bf16 v36, v157, s70, v36
    v_dot2_f32_bf16 v37, v157, v157, v37
    v_dot2_f32_bf16 v36, v158, s70, v36
    v_dot2_f32_bf16 v37, v158, v158, v37
    v_dot2_f32_bf16 v36, v159, s70, v36
    v_dot2_f32_bf16 v37, v159, v159, v37
    buffer_store_dwordx4 v[104:107], v22, s[28:31], s32 offen offset:2048 sc1
    s_and_b32 s33, s66, 1
    s_mul_i32 s32, s66, 1408
    s_mul_i32 s59, s33, -896
    s_add_u32 s32, s32, s59
    s_add_u32 s32, s32, s78
    s_add_u32 s32, s32, 81920
    buffer_store_dwordx4 v[108:111], v22, s[28:31], s32 offen sc1
    s_waitcnt vmcnt(14)
    ds_read_b128 v[160:163], v40 offset:16640
    ds_read_b128 v[164:167], v40 offset:17152
    ds_read_b128 v[168:171], v41 offset:16640
    ds_read_b128 v[172:175], v41 offset:17152
    s_waitcnt lgkmcnt(0)
    s_add_u32 m0, s56, 16640
    s_add_u32 s42, s76, 896
    buffer_load_dwordx4 v5, s[12:15], s42 offen offset:0 lds
    v_dot2_f32_bf16 v34, v160, s70, v34
    v_dot2_f32_bf16 v35, v160, v160, v35
    v_dot2_f32_bf16 v34, v161, s70, v34
    v_dot2_f32_bf16 v35, v161, v161, v35
    v_dot2_f32_bf16 v34, v162, s70, v34
    v_dot2_f32_bf16 v35, v162, v162, v35
    v_dot2_f32_bf16 v34, v163, s70, v34
    v_dot2_f32_bf16 v35, v163, v163, v35
    buffer_load_dwordx4 v6, s[12:15], s42 offen offset:1040 lds
    v_dot2_f32_bf16 v36, v164, s70, v36
    v_dot2_f32_bf16 v37, v164, v164, v37
    v_dot2_f32_bf16 v36, v165, s70, v36
    v_dot2_f32_bf16 v37, v165, v165, v37
    v_dot2_f32_bf16 v36, v166, s70, v36
    v_dot2_f32_bf16 v37, v166, v166, v37
    v_dot2_f32_bf16 v36, v167, s70, v36
    v_dot2_f32_bf16 v37, v167, v167, v37
    buffer_load_dwordx4 v7, s[12:15], s42 offen offset:2080 lds
    v_dot2_f32_bf16 v34, v168, s70, v34
    v_dot2_f32_bf16 v35, v168, v168, v35
    v_dot2_f32_bf16 v34, v169, s70, v34
    v_dot2_f32_bf16 v35, v169, v169, v35
    v_dot2_f32_bf16 v34, v170, s70, v34
    v_dot2_f32_bf16 v35, v170, v170, v35
    v_dot2_f32_bf16 v34, v171, s70, v34
    v_dot2_f32_bf16 v35, v171, v171, v35
    buffer_load_dwordx4 v8, s[12:15], s42 offen offset:3120 lds
    v_dot2_f32_bf16 v36, v172, s70, v36
    v_dot2_f32_bf16 v37, v172, v172, v37
    v_dot2_f32_bf16 v36, v173, s70, v36
    v_dot2_f32_bf16 v37, v173, v173, v37
    v_dot2_f32_bf16 v36, v174, s70, v36
    v_dot2_f32_bf16 v37, v174, v174, v37
    v_dot2_f32_bf16 v36, v175, s70, v36
    v_dot2_f32_bf16 v37, v175, v175, v37
    s_mul_i32 s59, s33, -128
    s_add_u32 s32, s32, s59
    s_mov_b64 exec, 0xfff0fff
    buffer_store_dwordx4 v[112:115], v23, s[28:31], s32 offen offset:2048 sc1
    s_mov_b64 exec, -1
    buffer_load_dword v48, v66, s[4:7], 0 offen sc1
    s_waitcnt vmcnt(14)
    ds_read_b128 v[176:179], v40 offset:33280
    ds_read_b128 v[180:183], v40 offset:33792
    ds_read_b128 v[184:187], v41 offset:33280
    ds_read_b128 v[188:191], v41 offset:33792
    s_waitcnt lgkmcnt(0)
    s_add_u32 m0, s56, 33280
    s_add_u32 s42, s76, 1024
    buffer_load_dwordx4 v5, s[12:15], s42 offen offset:0 lds
    v_dot2_f32_bf16 v34, v176, s70, v34
    v_dot2_f32_bf16 v35, v176, v176, v35
    v_dot2_f32_bf16 v34, v177, s70, v34
    v_dot2_f32_bf16 v35, v177, v177, v35
    v_dot2_f32_bf16 v34, v178, s70, v34
    v_dot2_f32_bf16 v35, v178, v178, v35
    v_dot2_f32_bf16 v34, v179, s70, v34
    v_dot2_f32_bf16 v35, v179, v179, v35
    buffer_load_dwordx4 v6, s[12:15], s42 offen offset:1040 lds
    v_dot2_f32_bf16 v36, v180, s70, v36
    v_dot2_f32_bf16 v37, v180, v180, v37
    v_dot2_f32_bf16 v36, v181, s70, v36
    v_dot2_f32_bf16 v37, v181, v181, v37
    v_dot2_f32_bf16 v36, v182, s70, v36
    v_dot2_f32_bf16 v37, v182, v182, v37
    v_dot2_f32_bf16 v36, v183, s70, v36
    v_dot2_f32_bf16 v37, v183, v183, v37
    buffer_load_dwordx4 v7, s[12:15], s42 offen offset:2080 lds
    v_dot2_f32_bf16 v34, v184, s70, v34
    v_dot2_f32_bf16 v35, v184, v184, v35
    v_dot2_f32_bf16 v34, v185, s70, v34
    v_dot2_f32_bf16 v35, v185, v185, v35
    v_dot2_f32_bf16 v34, v186, s70, v34
    v_dot2_f32_bf16 v35, v186, v186, v35
    v_dot2_f32_bf16 v34, v187, s70, v34
    v_dot2_f32_bf16 v35, v187, v187, v35
    buffer_load_dwordx4 v8, s[12:15], s42 offen offset:3120 lds
    v_dot2_f32_bf16 v36, v188, s70, v36
    v_dot2_f32_bf16 v37, v188, v188, v37
    v_dot2_f32_bf16 v36, v189, s70, v36
    v_dot2_f32_bf16 v37, v189, v189, v37
    v_dot2_f32_bf16 v36, v190, s70, v36
    v_dot2_f32_bf16 v37, v190, v190, v37
    v_dot2_f32_bf16 v36, v191, s70, v36
    v_dot2_f32_bf16 v37, v191, v191, v37
    s_waitcnt vmcnt(12)
    ds_read_b128 v[192:195], v40 offset:0
    ds_read_b128 v[196:199], v40 offset:512
    ds_read_b128 v[200:203], v41 offset:0
    ds_read_b128 v[204:207], v41 offset:512
    s_waitcnt lgkmcnt(0)
    s_add_u32 m0, s56, 0
    s_add_u32 s42, s76, 1152
    buffer_load_dwordx4 v5, s[12:15], s42 offen offset:0 lds
    v_dot2_f32_bf16 v34, v192, s70, v34
    v_dot2_f32_bf16 v35, v192, v192, v35
    v_dot2_f32_bf16 v34, v193, s70, v34
    v_dot2_f32_bf16 v35, v193, v193, v35
    v_dot2_f32_bf16 v34, v194, s70, v34
    v_dot2_f32_bf16 v35, v194, v194, v35
    v_dot2_f32_bf16 v34, v195, s70, v34
    v_dot2_f32_bf16 v35, v195, v195, v35
    buffer_load_dwordx4 v6, s[12:15], s42 offen offset:1040 lds
    v_dot2_f32_bf16 v36, v196, s70, v36
    v_dot2_f32_bf16 v37, v196, v196, v37
    v_dot2_f32_bf16 v36, v197, s70, v36
    v_dot2_f32_bf16 v37, v197, v197, v37
    v_dot2_f32_bf16 v36, v198, s70, v36
    v_dot2_f32_bf16 v37, v198, v198, v37
    v_dot2_f32_bf16 v36, v199, s70, v36
    v_dot2_f32_bf16 v37, v199, v199, v37
    buffer_load_dwordx4 v7, s[12:15], s42 offen offset:2080 lds
    v_dot2_f32_bf16 v34, v200, s70, v34
    v_dot2_f32_bf16 v35, v200, v200, v35
    v_dot2_f32_bf16 v34, v201, s70, v34
    v_dot2_f32_bf16 v35, v201, v201, v35
    v_dot2_f32_bf16 v34, v202, s70, v34
    v_dot2_f32_bf16 v35, v202, v202, v35
    v_dot2_f32_bf16 v34, v203, s70, v34
    v_dot2_f32_bf16 v35, v203, v203, v35
    buffer_load_dwordx4 v8, s[12:15], s42 offen offset:3120 lds
    v_dot2_f32_bf16 v36, v204, s70, v36
    v_dot2_f32_bf16 v37, v204, v204, v37
    v_dot2_f32_bf16 v36, v205, s70, v36
    v_dot2_f32_bf16 v37, v205, v205, v37
    v_dot2_f32_bf16 v36, v206, s70, v36
    v_dot2_f32_bf16 v37, v206, v206, v37
    v_dot2_f32_bf16 v36, v207, s70, v36
    v_dot2_f32_bf16 v37, v207, v207, v37
    s_mov_b32 m0, s61
    s_add_u32 s42, s83, 64
    buffer_load_dwordx4 v52, s[12:15], s83 offen lds
    s_add_u32 m0, s61, 1024
    s_nop 0
    buffer_load_dwordx4 v52, s[12:15], s42 offen lds
    s_add_u32 m0, s61, 2048
    s_mul_i32 s42, s63, -128
    s_add_u32 s42, s42, s83
    s_add_u32 s42, s42, 128
    s_mov_b32 exec_hi, 0
    buffer_load_dwordx4 v53, s[12:15], s42 offen lds
    s_mov_b64 exec, -1
    s_waitcnt lgkmcnt(0)
    s_barrier
    s_mul_i32 s34, s58, 512
    s_add_u32 s34, s34, s72
    s_add_u32 s34, s34, 131072
    ds_read_b64 v[70:71], v68 offset:3584
    ds_read_b64 v[72:73], v68 offset:16896
    ds_read_b64 v[74:75], v68 offset:30208
    ds_read_b64 v[76:77], v68 offset:43520
    s_waitcnt lgkmcnt(2)
    v_pk_add_f32 v[70:71], v[70:71], v[72:73]
    s_waitcnt lgkmcnt(0)
    v_pk_add_f32 v[74:75], v[74:75], v[76:77]
    v_pk_add_f32 v[70:71], v[70:71], v[74:75]
    s_cmp_eq_u32 s3, 0
    s_cselect_b64 exec, -1, 0
    buffer_store_dwordx2 v[70:71], v14, s[4:7], s34 offen sc1
    s_mov_b64 exec, -1
    s_waitcnt vmcnt(14)
    ds_read_b128 v[208:211], v40 offset:16640
    ds_read_b128 v[212:215], v40 offset:17152
    ds_read_b128 v[216:219], v41 offset:16640
    ds_read_b128 v[220:223], v41 offset:17152
    s_waitcnt vmcnt(12)
    v_cmp_gt_u32 vcc, 1, v48
    s_nop 0
    s_cbranch_vccz L_gled
L_gl:
    s_mov_b32 s45, 200000
L_gl_b:
    buffer_load_dword v48, v66, s[4:7], 0 offen sc1
    s_sub_u32 s45, s45, 1
    s_cbranch_scc1 L_gl_c
    s_waitcnt vmcnt(0)
    v_cmp_gt_u32 vcc, 1, v48
    s_nop 0
    s_cbranch_vccnz L_gl_b
L_gl_c:
    s_waitcnt vmcnt(0)
    s_branch L_gled
L_gled:
    s_add_u32 m0, s74, 0
    s_add_u32 s44, s51, 0
    buffer_load_dwordx4 v1, s[4:7], s44 offen offset:0 sc1 lds
    s_add_u32 m0, s74, 0
    s_add_u32 s44, s51, 0
    buffer_load_dwordx4 v1, s[4:7], s44 offen offset:1024 sc1 lds
    s_add_u32 m0, s74, 0
    s_add_u32 s44, s51, 0
    buffer_load_dwordx4 v1, s[4:7], s44 offen offset:2048 sc1 lds
    s_add_u32 m0, s74, 0
    s_add_u32 s44, s51, 0
    buffer_load_dwordx4 v1, s[4:7], s44 offen offset:3072 sc1 lds
    s_add_u32 m0, s74, 16384
    s_add_u32 s44, s51, 16384
    buffer_load_dwordx4 v1, s[4:7], s44 offen offset:0 sc1 lds
    s_add_u32 m0, s74, 16384
    s_add_u32 s44, s51, 16384
    buffer_load_dwordx4 v1, s[4:7], s44 offen offset:1024 sc1 lds
    s_add_u32 m0, s74, 16384
    s_add_u32 s44, s51, 16384
    buffer_load_dwordx4 v1, s[4:7], s44 offen offset:2048 sc1 lds
    s_add_u32 m0, s74, 16384
    s_add_u32 s44, s51, 16384
    buffer_load_dwordx4 v1, s[4:7], s44 offen offset:3072 sc1 lds
    s_waitcnt vmcnt(16)
    ds_read_b128 v[224:227], v40 offset:33280
    ds_read_b128 v[228:231], v40 offset:33792
    ds_read_b128 v[232:235], v41 offset:33280
    ds_read_b128 v[236:239], v41 offset:33792
    s_waitcnt vmcnt(12)
    ds_read_b128 v[240:243], v40 offset:0
    ds_read_b128 v[244:247], v40 offset:512
    ds_read_b128 v[248:251], v41 offset:0
    ds_read_b128 v[252:255], v41 offset:512
    s_waitcnt lgkmcnt(11)
    v_dot2_f32_bf16 v34, v208, s70, v34
    v_dot2_f32_bf16 v35, v208, v208, v35
    v_dot2_f32_bf16 v34, v209, s70, v34
    v_dot2_f32_bf16 v35, v209, v209, v35
    v_dot2_f32_bf16 v34, v210, s70, v34
    v_dot2_f32_bf16 v35, v210, v210, v35
    v_dot2_f32_bf16 v34, v211, s70, v34
    v_dot2_f32_bf16 v35, v211, v211, v35
    s_waitcnt lgkmcnt(10)
    v_dot2_f32_bf16 v36, v212, s70, v36
    v_dot2_f32_bf16 v37, v212, v212, v37
    v_dot2_f32_bf16 v36, v213, s70, v36
    v_dot2_f32_bf16 v37, v213, v213, v37
    v_dot2_f32_bf16 v36, v214, s70, v36
    v_dot2_f32_bf16 v37, v214, v214, v37
    v_dot2_f32_bf16 v36, v215, s70, v36
    v_dot2_f32_bf16 v37, v215, v215, v37
    s_waitcnt lgkmcnt(9)
    v_dot2_f32_bf16 v34, v216, s70, v34
    v_dot2_f32_bf16 v35, v216, v216, v35
    v_dot2_f32_bf16 v34, v217, s70, v34
    v_dot2_f32_bf16 v35, v217, v217, v35
    v_dot2_f32_bf16 v34, v218, s70, v34
    v_dot2_f32_bf16 v35, v218, v218, v35
    v_dot2_f32_bf16 v34, v219, s70, v34
    v_dot2_f32_bf16 v35, v219, v219, v35
    s_waitcnt lgkmcnt(8)
    v_dot2_f32_bf16 v36, v220, s70, v36
    v_dot2_f32_bf16 v37, v220, v220, v37
    v_dot2_f32_bf16 v36, v221, s70, v36
    v_dot2_f32_bf16 v37, v221, v221, v37
    v_dot2_f32_bf16 v36, v222, s70, v36
    v_dot2_f32_bf16 v37, v222, v222, v37
    v_dot2_f32_bf16 v36, v223, s70, v36
    v_dot2_f32_bf16 v37, v223, v223, v37
    s_waitcnt lgkmcnt(0)
    s_barrier
    s_mov_b32 s59, L_p2_0+2048-L_pc
    s_load_dword s65, s[0:1], s59
    s_add_u32 s59, s59, 64
    s_load_dword s65, s[0:1], s59
    s_add_u32 m0, s74, 32768
    s_add_u32 s44, s51, 32768
    buffer_load_dwordx4 v1, s[4:7], s44 offen offset:0 sc1 lds
    v_dot2_f32_bf16 v34, v224, s70, v34
    v_dot2_f32_bf16 v35, v224, v224, v35
    v_dot2_f32_bf16 v34, v225, s70, v34
    v_dot2_f32_bf16 v35, v225, v225, v35
    v_dot2_f32_bf16 v34, v226, s70, v34
    v_dot2_f32_bf16 v35, v226, v226, v35
    v_dot2_f32_bf16 v34, v227, s70, v34
    v_dot2_f32_bf16 v35, v227, v227, v35
    v_dot2_f32_bf16 v36, v228, s70, v36
    v_dot2_f32_bf16 v37, v228, v228, v37
    v_dot2_f32_bf16 v36, v229, s70, v36
    v_dot2_f32_bf16 v37, v229, v229, v37
    v_dot2_f32_bf16 v36, v230, s70, v36
    v_dot2_f32_bf16 v37, v230, v230, v37
    v_dot2_f32_bf16 v36, v231, s70, v36
    v_dot2_f32_bf16 v37, v231, v231, v37
    v_dot2_f32_bf16 v34, v232, s70, v34
    s_add_u32 m0, s74, 32768
    s_add_u32 s44, s51, 32768
    buffer_load_dwordx4 v1, s[4:7], s44 offen offset:1024 sc1 lds
    v_dot2_f32_bf16 v35, v232, v232, v35
    v_dot2_f32_bf16 v34, v233, s70, v34
    v_dot2_f32_bf16 v35, v233, v233, v35
    v_dot2_f32_bf16 v34, v234, s70, v34
    v_dot2_f32_bf16 v35, v234, v234, v35
    v_dot2_f32_bf16 v34, v235, s70, v34
    v_dot2_f32_bf16 v35, v235, v235, v35
    v_dot2_f32_bf16 v36, v236, s70, v36
    v_dot2_f32_bf16 v37, v236, v236, v37
    v_dot2_f32_bf16 v36, v237, s70, v36
    v_dot2_f32_bf16 v37, v237, v237, v37
    v_dot2_f32_bf16 v36, v238, s70, v36
    v_dot2_f32_bf16 v37, v238, v238, v37
    v_dot2_f32_bf16 v36, v239, s70, v36
    v_dot2_f32_bf16 v37, v239, v239, v37
    v_dot2_f32_bf16 v34, v240, s70, v34
    v_dot2_f32_bf16 v35, v240, v240, v35
    s_add_u32 m0, s74, 32768
    s_add_u32 s44, s51, 32768
    buffer_load_dwordx4 v1, s[4:7], s44 offen offset:2048 sc1 lds
    v_dot2_f32_bf16 v34, v241, s70, v34
    v_dot2_f32_bf16 v35, v241, v241, v35
    v_dot2_f32_bf16 v34, v242, s70, v34
    v_dot2_f32_bf16 v35, v242, v242, v35
    v_dot2_f32_bf16 v34, v243, s70, v34
    v_dot2_f32_bf16 v35, v243, v243, v35
    v_dot2_f32_bf16 v36, v244, s70, v36
    v_dot2_f32_bf16 v37, v244, v244, v37
    v_dot2_f32_bf16 v36, v245, s70, v36
    v_dot2_f32_bf16 v37, v245, v245, v37
    v_dot2_f32_bf16 v36, v246, s70, v36
    v_dot2_f32_bf16 v37, v246, v246, v37
    v_dot2_f32_bf16 v36, v247, s70, v36
    v_dot2_f32_bf16 v37, v247, v247, v37
    v_dot2_f32_bf16 v34, v248, s70, v34
    v_dot2_f32_bf16 v35, v248, v248, v35
    v_dot2_f32_bf16 v34, v249, s70, v34
    s_add_u32 m0, s74, 32768
    s_add_u32 s44, s51, 32768
    buffer_load_dwordx4 v1, s[4:7], s44 offen offset:3072 sc1 lds
    v_dot2_f32_bf16 v35, v249, v249, v35
    v_dot2_f32_bf16 v34, v250, s70, v34
    v_dot2_f32_bf16 v35, v250, v250, v35
    v_dot2_f32_bf16 v34, v251, s70, v34
    v_dot2_f32_bf16 v35, v251, v251, v35
    v_dot2_f32_bf16 v36, v252, s70, v36
    v_dot2_f32_bf16 v37, v252, v252, v37
    v_dot2_f32_bf16 v36, v253, s70, v36
    v_dot2_f32_bf16 v37, v253, v253, v37
    v_dot2_f32_bf16 v36, v254, s70, v36
    v_dot2_f32_bf16 v37, v254, v254, v37
    v_dot2_f32_bf16 v36, v255, s70, v36
    v_dot2_f32_bf16 v37, v255, v255, v37
    s_nop 1
    v_permlane16_swap_b32 v34, v36
    v_permlane16_swap_b32 v35, v37
    v_add_f32 v26, v34, v36
    v_add_f32 v27, v35, v37
    s_waitcnt vmcnt(13)
    ds_read_b128 v[16:19], v54
    ds_read_b128 v[20:23], v54 offset:1024
    ds_read_b64 v[24:25], v55 offset:2048
    s_waitcnt lgkmcnt(0)
L_p1_0:
    s_waitcnt vmcnt(8)
    s_barrier
    ds_read_b128 a[224:227], v1 offset:0
    ds_read_b128 a[228:231], v1 offset:1024
    ds_read_b128 a[232:235], v1 offset:2048
    ds_read_b128 a[236:239], v1 offset:3072
    ds_read_b128 a[240:243], v1 offset:5120
    ds_read_b128 a[244:247], v1 offset:6144
    s_waitcnt lgkmcnt(5)
    v_mfma_f32_16x16x32_bf16 v[52:55], a[224:227], a[204:207], 0
    v_mfma_f32_16x16x32_bf16 v[56:59], a[224:227], a[208:211], 0
    s_waitcnt lgkmcnt(3)
    ds_read_b128 a[224:227], v1 offset:7168
    v_and_b32 v46, 31, v0
    v_mfma_f32_16x16x32_bf16 v[60:63], a[228:231], a[204:207], 0
    s_add_u32 m0, s74, 49152
    s_add_u32 s44, s51, 49152
    buffer_load_dwordx4 v1, s[4:7], s44 offen offset:0 sc1 lds
    v_mfma_f32_16x16x32_bf16 v[64:67], a[228:231], a[208:211], 0
    ds_read_b128 a[228:231], v1 offset:8192
    v_lshrrev_b32 v47, 5, v0
    v_mfma_f32_16x16x32_bf16 v[68:71], a[232:235], a[204:207], 0
    s_add_u32 m0, s74, 49152
    s_add_u32 s44, s51, 49152
    buffer_load_dwordx4 v1, s[4:7], s44 offen offset:1024 sc1 lds
    v_mfma_f32_16x16x32_bf16 v[72:75], a[232:235], a[208:211], 0
    s_waitcnt lgkmcnt(3)
    ds_read_b128 a[232:235], v1 offset:4096
    v_lshrrev_b32 v48, 1, v0
    v_mfma_f32_16x16x32_bf16 v[76:79], a[236:239], a[204:207], 0
    s_add_u32 m0, s74, 49152
    s_add_u32 s44, s51, 49152
    buffer_load_dwordx4 v1, s[4:7], s44 offen offset:2048 sc1 lds
    v_mfma_f32_16x16x32_bf16 v[80:83], a[236:239], a[208:211], 0
    ds_read_b128 a[236:239], v1 offset:10240
    v_and_b32 v48, 28, v48
    v_mfma_f32_16x16x32_bf16 v[52:55], a[240:243], a[212:215], v[52:55]
    s_add_u32 m0, s74, 49152
    s_add_u32 s44, s51, 49152
    buffer_load_dwordx4 v1, s[4:7], s44 offen offset:3072 sc1 lds
    v_mfma_f32_16x16x32_bf16 v[56:59], a[240:243], a[216:219], v[56:59]
    s_waitcnt lgkmcnt(3)
    ds_read_b128 a[240:243], v1 offset:11264
    v_and_or_b32 v13, v0, 3, v48
    v_mfma_f32_16x16x32_bf16 v[60:63], a[244:247], a[212:215], v[60:63]
    s_mul_i32 s40, s3, 2048
    s_add_u32 s40, s40, s72
    buffer_load_dwordx2 a[0:1], v14, s[4:7], s40 offen offset:0 sc1
    v_mfma_f32_16x16x32_bf16 v[64:67], a[244:247], a[216:219], v[64:67]
    ds_read_b128 a[244:247], v1 offset:12288
    v_lshlrev_b32 v13, 4, v13
    v_mfma_f32_16x16x32_bf16 v[68:71], a[224:227], a[212:215], v[68:71]
    buffer_load_dwordx2 a[2:3], v14, s[4:7], s40 offen offset:512 sc1
    v_mfma_f32_16x16x32_bf16 v[72:75], a[224:227], a[216:219], v[72:75]
    s_waitcnt lgkmcnt(3)
    ds_read_b128 a[224:227], v1 offset:13312
    v_add_u32 v13, 104448, v13
    v_mfma_f32_16x16x32_bf16 v[76:79], a[228:231], a[212:215], v[76:79]
    buffer_load_dwordx2 a[4:5], v14, s[4:7], s40 offen offset:1024 sc1
    v_mfma_f32_16x16x32_bf16 v[80:83], a[228:231], a[216:219], v[80:83]
    ds_read_b128 a[228:231], v1 offset:15360
    buffer_load_dwordx2 a[6:7], v14, s[4:7], s40 offen offset:1536 sc1
    v_mfma_f32_16x16x32_bf16 v[84:87], a[232:235], a[204:207], 0
    s_waitcnt vmcnt(12)
    s_barrier
    v_and_b32 v48, 4, v0
    v_mfma_f32_16x16x32_bf16 v[88:91], a[232:235], a[208:211], 0
    s_waitcnt lgkmcnt(3)
    ds_read_b128 a[232:235], v1 offset:16384
    s_add_u32 m0, s74, 65536
    s_add_u32 s44, s51, 65536
    buffer_load_dwordx4 v1, s[4:7], s44 offen offset:0 sc1 lds
    v_mfma_f32_16x16x32_bf16 v[52:55], a[236:239], a[220:223], v[52:55]
    s_mov_b64 exec, 1
    buffer_store_dword v50, v0, s[4:7], s75 offen offset:16 sc1
    s_mov_b64 exec, -1
    v_mfma_f32_16x16x32_bf16 v[56:59], a[236:239], v[116:119], v[56:59]
    ds_read_b128 a[236:239], v1 offset:17408
    v_lshl_add_u32 v13, v48, 16, v13
    v_mfma_f32_16x16x32_bf16 v[60:63], a[240:243], a[220:223], v[60:63]
    s_add_u32 m0, s74, 65536
    s_add_u32 s44, s51, 65536
    buffer_load_dwordx4 v1, s[4:7], s44 offen offset:1024 sc1 lds
    v_mfma_f32_16x16x32_bf16 v[64:67], a[240:243], v[116:119], v[64:67]
    s_waitcnt lgkmcnt(3)
    ds_read_b128 a[240:243], v1 offset:18432
    v_lshlrev_b32 v14, 3, v0
    v_mfma_f32_16x16x32_bf16 v[68:71], a[244:247], a[220:223], v[68:71]
    s_add_u32 m0, s74, 65536
    s_add_u32 s44, s51, 65536
    buffer_load_dwordx4 v1, s[4:7], s44 offen offset:2048 sc1 lds
    v_mfma_f32_16x16x32_bf16 v[72:75], a[244:247], v[116:119], v[72:75]
    ds_read_b128 a[244:247], v1 offset:9216
    v_add_u32 v5, s79, v1
    v_mfma_f32_16x16x32_bf16 v[76:79], a[224:227], a[220:223], v[76:79]
    s_add_u32 m0, s74, 65536
    s_add_u32 s44, s51, 65536
    buffer_load_dwordx4 v1, s[4:7], s44 offen offset:3072 sc1 lds
    v_mfma_f32_16x16x32_bf16 v[80:83], a[224:227], v[116:119], v[80:83]
    s_waitcnt lgkmcnt(3)
    ds_read_b128 a[224:227], v1 offset:20480
    v_add_u32 v6, s79, v14
    v_mfma_f32_16x16x32_bf16 v[52:55], a[228:231], v[120:123], v[52:55]
    v_lshlrev_b32 v7, 2, v47
    v_xor_b32 v9, v0, v7
    v_mfma_f32_16x16x32_bf16 v[56:59], a[228:231], v[124:127], v[56:59]
    ds_read_b128 a[228:231], v1 offset:21504
    v_lshlrev_b32 v9, 4, v9
    v_mfma_f32_16x16x32_bf16 v[60:63], a[232:235], v[120:123], v[60:63]
    v_add_u32 v11, s79, v9
    v_add_u32 v8, s95, v9
    v_mfma_f32_16x16x32_bf16 v[64:67], a[232:235], v[124:127], v[64:67]
    s_waitcnt lgkmcnt(3)
    ds_read_b128 a[232:235], v1 offset:22528
    v_xor_b32 v10, 8, v46
    v_mfma_f32_16x16x32_bf16 v[68:71], a[236:239], v[120:123], v[68:71]
    v_lshlrev_b32 v10, 4, v10
    v_add_u32 v12, s79, v10
    v_mfma_f32_16x16x32_bf16 v[72:75], a[236:239], v[124:127], v[72:75]
    ds_read_b128 a[236:239], v1 offset:23552
    v_add_u32 v48, s95, v10
    v_mfma_f32_16x16x32_bf16 v[76:79], a[240:243], v[120:123], v[76:79]
    v_subrev_u32 v48, 4096, v48
    v_cndmask_b32 v12, v12, v48, s[48:49]
    v_mfma_f32_16x16x32_bf16 v[80:83], a[240:243], v[124:127], v[80:83]
    s_waitcnt lgkmcnt(3)
    ds_read_b128 a[240:243], v1 offset:14336
    v_mad_u32_u24 v10, v47, s94, v10
    v_mfma_f32_16x16x32_bf16 v[84:87], a[244:247], a[212:215], v[84:87]
    v_sub_u32 v7, v46, v7
    v_and_b32 v15, 3, v0
    v_mfma_f32_16x16x32_bf16 v[88:91], a[244:247], a[216:219], v[88:91]
    ds_read_b128 a[244:247], v1 offset:25600
    v_lshlrev_b32 v15, 3, v15
    v_mfma_f32_16x16x32_bf16 v[52:55], a[224:227], v[128:131], v[52:55]
    v_add_lshl_u32 v15, v15, s62, 3
    v_bfe_u32 v48, v0, 2, 3
    v_mfma_f32_16x16x32_bf16 v[56:59], a[224:227], v[132:135], v[56:59]
    s_waitcnt lgkmcnt(3)
    ds_read_b128 a[224:227], v1 offset:26624
    v_add_u32 v15, v15, v48
    v_mfma_f32_16x16x32_bf16 v[60:63], a[228:231], v[128:131], v[60:63]
    v_and_b32 v48, 15, v0
    v_mov_b32 v46, s2
    v_mfma_f32_16x16x32_bf16 v[64:67], a[228:231], v[132:135], v[64:67]
    ds_read_b128 a[228:231], v1 offset:27648
    v_and_b32 v46, 0x87, v46
    v_mfma_f32_16x16x32_bf16 v[68:71], a[232:235], v[128:131], v[68:71]
    v_lshl_add_u32 v48, v48, 3, v46
    v_cndmask_b32 v15, v15, v48, s[48:49]
    v_mfma_f32_16x16x32_bf16 v[72:75], a[232:235], v[132:135], v[72:75]
    s_waitcnt lgkmcnt(3)
    ds_read_b128 a[232:235], v1 offset:28672
    v_lshlrev_b32 v15, 7, v15
    v_mfma_f32_16x16x32_bf16 v[76:79], a[236:239], v[128:131], v[76:79]
    v_add_u32 v15, 8052752, v15
    v_mfma_f32_16x16x32_bf16 v[80:83], a[236:239], v[132:135], v[80:83]
    ds_read_b128 a[236:239], v1 offset:30720
    v_mov_b32 v28, v26
    v_mfma_f32_16x16x32_bf16 v[84:87], a[240:243], a[220:223], v[84:87]
    v_mov_b32 v29, v27
    v_mfma_f32_16x16x32_bf16 v[88:91], a[240:243], v[116:119], v[88:91]
    s_waitcnt lgkmcnt(3)
    ds_read_b128 a[240:243], v1 offset:31744
    v_mfma_f32_16x16x32_bf16 v[52:55], a[244:247], v[136:139], v[52:55]
    s_waitcnt vmcnt(13)
    s_barrier
    v_mfma_f32_16x16x32_bf16 v[56:59], a[244:247], v[140:143], v[56:59]
    ds_read_b128 a[244:247], v1 offset:32768
    v_mfma_f32_16x16x32_bf16 v[60:63], a[224:227], v[136:139], v[60:63]
    s_add_u32 m0, s74, 81920
    s_add_u32 s44, s51, 81920
    buffer_load_dwordx4 v1, s[4:7], s44 offen offset:0 sc1 lds
    v_mfma_f32_16x16x32_bf16 v[64:67], a[224:227], v[140:143], v[64:67]
    s_waitcnt lgkmcnt(3)
    ds_read_b128 a[224:227], v1 offset:33792
    s_waitcnt vmcnt(9)
    v_accvgpr_read_b32 v92, a0
    v_mfma_f32_16x16x32_bf16 v[68:71], a[228:231], v[136:139], v[68:71]
    s_add_u32 m0, s74, 81920
    s_add_u32 s44, s51, 81920
    buffer_load_dwordx4 v1, s[4:7], s44 offen offset:1024 sc1 lds
    v_mfma_f32_16x16x32_bf16 v[72:75], a[228:231], v[140:143], v[72:75]
    ds_read_b128 a[228:231], v1 offset:19456
    v_accvgpr_read_b32 v93, a1
    v_mfma_f32_16x16x32_bf16 v[76:79], a[232:235], v[136:139], v[76:79]
    s_add_u32 m0, s74, 81920
    s_add_u32 s44, s51, 81920
    buffer_load_dwordx4 v1, s[4:7], s44 offen offset:2048 sc1 lds
    v_mfma_f32_16x16x32_bf16 v[80:83], a[232:235], v[140:143], v[80:83]
    s_waitcnt lgkmcnt(3)
    ds_read_b128 a[232:235], v1 offset:35840
    s_waitcnt vmcnt(10)
    v_accvgpr_read_b32 v94, a2
    v_mfma_f32_16x16x32_bf16 v[52:55], a[236:239], v[144:147], v[52:55]
    s_add_u32 m0, s74, 81920
    s_add_u32 s44, s51, 81920
    buffer_load_dwordx4 v1, s[4:7], s44 offen offset:3072 sc1 lds
    v_mfma_f32_16x16x32_bf16 v[56:59], a[236:239], v[148:151], v[56:59]
    ds_read_b128 a[236:239], v1 offset:36864
    v_accvgpr_read_b32 v95, a3
    v_mfma_f32_16x16x32_bf16 v[60:63], a[240:243], v[144:147], v[60:63]
    v_add_f32 v92, v92, v94
    v_add_f32 v93, v93, v95
    v_mfma_f32_16x16x32_bf16 v[64:67], a[240:243], v[148:151], v[64:67]
    s_waitcnt lgkmcnt(3)
    ds_read_b128 a[240:243], v1 offset:37888
    s_waitcnt vmcnt(10)
    v_accvgpr_read_b32 v94, a4
    v_mfma_f32_16x16x32_bf16 v[68:71], a[244:247], v[144:147], v[68:71]
    v_accvgpr_read_b32 v95, a5
    v_add_f32 v92, v92, v94
    v_mfma_f32_16x16x32_bf16 v[72:75], a[244:247], v[148:151], v[72:75]
    ds_read_b128 a[244:247], v1 offset:38912
    v_add_f32 v93, v93, v95
    v_mfma_f32_16x16x32_bf16 v[76:79], a[224:227], v[144:147], v[76:79]
    s_waitcnt vmcnt(9)
    v_accvgpr_read_b32 v94, a6
    v_accvgpr_read_b32 v95, a7
    v_mfma_f32_16x16x32_bf16 v[80:83], a[224:227], v[148:151], v[80:83]
    s_waitcnt lgkmcnt(3)
    ds_read_b128 a[224:227], v1 offset:40960
    v_add_f32 v92, v92, v94
    v_mfma_f32_16x16x32_bf16 v[84:87], a[228:231], v[120:123], v[84:87]
    v_add_f32 v93, v93, v95
    v_lshl_add_u32 v94, s3, 9, v14
    v_mfma_f32_16x16x32_bf16 v[88:91], a[228:231], v[124:127], v[88:91]
    ds_read_b128 a[228:231], v1 offset:41984
    v_add_u32 v94, 157696, v94
    v_mfma_f32_16x16x32_bf16 v[52:55], a[232:235], v[152:155], v[52:55]
    v_permlane32_swap_b32 v26, v28
    v_mfma_f32_16x16x32_bf16 v[56:59], a[232:235], v[156:159], v[56:59]
    s_waitcnt lgkmcnt(3)
    ds_read_b128 a[232:235], v1 offset:43008
    v_mfma_f32_16x16x32_bf16 v[60:63], a[236:239], v[152:155], v[60:63]
    v_permlane32_swap_b32 v27, v29
    v_mfma_f32_16x16x32_bf16 v[64:67], a[236:239], v[156:159], v[64:67]
    ds_read_b128 a[236:239], v1 offset:44032
    v_add_f32 v26, v26, v28
    v_mfma_f32_16x16x32_bf16 v[68:71], a[240:243], v[152:155], v[68:71]
    v_add_f32 v27, v27, v29
    v_mul_f32 v26, 0xbacccccd, v26
    v_mfma_f32_16x16x32_bf16 v[72:75], a[240:243], v[156:159], v[72:75]
    s_waitcnt lgkmcnt(3)
    ds_read_b128 a[240:243], v1 offset:24576
    v_mul_f32 v27, 0x3acccccd, v27
    v_mfma_f32_16x16x32_bf16 v[76:79], a[244:247], v[152:155], v[76:79]
    v_mov_b32 v28, v26
    v_fma_f32 v27, -v26, v26, v27
    v_mfma_f32_16x16x32_bf16 v[80:83], a[244:247], v[156:159], v[80:83]
    ds_read_b128 a[244:247], v1 offset:46080
    v_max_f32 v27, 0, v27
    v_mfma_f32_16x16x32_bf16 v[52:55], a[224:227], v[160:163], v[52:55]
    v_add_f32 v27, 0x3727c5ac, v27
    v_mfma_f32_16x16x32_bf16 v[56:59], a[224:227], v[164:167], v[56:59]
    s_waitcnt lgkmcnt(3)
    ds_read_b128 a[224:227], v1 offset:47104
    v_mfma_f32_16x16x32_bf16 v[60:63], a[228:231], v[160:163], v[60:63]
    v_permlane16_swap_b32 v26, v28
    v_mfma_f32_16x16x32_bf16 v[64:67], a[228:231], v[164:167], v[64:67]
    ds_read_b128 a[228:231], v1 offset:48128
    ds_write_b64 v94, v[92:93]
    v_mfma_f32_16x16x32_bf16 v[68:71], a[232:235], v[160:163], v[68:71]
    s_waitcnt lgkmcnt(0)
    s_barrier
    v_add_u32 v100, 157696, v14
    v_mfma_f32_16x16x32_bf16 v[72:75], a[232:235], v[164:167], v[72:75]
    ds_read_b128 a[232:235], v1 offset:49152
    ds_read_b64 v[92:93], v100 offset:0
    v_mfma_f32_16x16x32_bf16 v[76:79], a[236:239], v[160:163], v[76:79]
    s_add_u32 m0, s74, 98304
    s_add_u32 s44, s51, 98304
    buffer_load_dwordx4 v1, s[4:7], s44 offen offset:0 sc1 lds
    v_mfma_f32_16x16x32_bf16 v[80:83], a[236:239], v[164:167], v[80:83]
    ds_read_b128 a[236:239], v1 offset:29696
    ds_read_b64 v[94:95], v100 offset:512
    v_mfma_f32_16x16x32_bf16 v[84:87], a[240:243], v[128:131], v[84:87]
    s_add_u32 m0, s74, 98304
    s_add_u32 s44, s51, 98304
    buffer_load_dwordx4 v1, s[4:7], s44 offen offset:1024 sc1 lds
    v_mfma_f32_16x16x32_bf16 v[88:91], a[240:243], v[132:135], v[88:91]
    ds_read_b128 a[240:243], v1 offset:51200
    ds_read_b64 v[96:97], v100 offset:1024
    v_mfma_f32_16x16x32_bf16 v[52:55], a[244:247], v[168:171], v[52:55]
    s_add_u32 m0, s74, 98304
    s_add_u32 s44, s51, 98304
    buffer_load_dwordx4 v1, s[4:7], s44 offen offset:2048 sc1 lds
    v_mfma_f32_16x16x32_bf16 v[56:59], a[244:247], v[172:175], v[56:59]
    ds_read_b128 a[244:247], v1 offset:52224
    ds_read_b64 v[98:99], v100 offset:1536
    v_mfma_f32_16x16x32_bf16 v[60:63], a[224:227], v[168:171], v[60:63]
    s_add_u32 m0, s74, 98304
    s_add_u32 s44, s51, 98304
    buffer_load_dwordx4 v1, s[4:7], s44 offen offset:3072 sc1 lds
    v_mfma_f32_16x16x32_bf16 v[64:67], a[224:227], v[172:175], v[64:67]
    s_waitcnt lgkmcnt(7)
    ds_read_b128 a[224:227], v1 offset:53248
    s_waitcnt lgkmcnt(5)
    v_add_f32 v92, v92, v94
    v_mfma_f32_16x16x32_bf16 v[68:71], a[228:231], v[168:171], v[68:71]
    v_add_f32 v93, v93, v95
    s_waitcnt lgkmcnt(3)
    v_add_f32 v92, v92, v96
    v_mfma_f32_16x16x32_bf16 v[72:75], a[228:231], v[172:175], v[72:75]
    ds_read_b128 a[228:231], v1 offset:54272
    v_add_f32 v93, v93, v97
    v_mfma_f32_16x16x32_bf16 v[76:79], a[232:235], v[168:171], v[76:79]
    s_waitcnt lgkmcnt(2)
    v_add_f32 v92, v92, v98
    v_add_f32 v93, v93, v99
    v_mfma_f32_16x16x32_bf16 v[80:83], a[232:235], v[172:175], v[80:83]
    ds_read_b128 a[232:235], v1 offset:56320
    v_cvt_pk_bf16_f32 v94, v92, v92
    v_mfma_f32_16x16x32_bf16 v[84:87], a[236:239], v[136:139], v[84:87]
    v_and_b32 v94, 0xffff0000, v94
    v_sub_f32 v92, v92, v94
    v_mfma_f32_16x16x32_bf16 v[88:91], a[236:239], v[140:143], v[88:91]
    ds_read_b128 a[236:239], v1 offset:57344
    v_cvt_pk_bf16_f32 v92, v94, v92
    v_mfma_f32_16x16x32_bf16 v[52:55], a[240:243], v[176:179], v[52:55]
    v_accvgpr_write_b32 a248, v92
    v_accvgpr_write_b32 a249, v92
    v_mfma_f32_16x16x32_bf16 v[56:59], a[240:243], v[180:183], v[56:59]
    s_waitcnt lgkmcnt(3)
    ds_read_b128 a[240:243], v1 offset:58368
    v_cvt_pk_bf16_f32 v95, v93, v93
    v_mfma_f32_16x16x32_bf16 v[60:63], a[244:247], v[176:179], v[60:63]
    v_and_b32 v95, 0xffff0000, v95
    v_sub_f32 v93, v93, v95
    v_mfma_f32_16x16x32_bf16 v[64:67], a[244:247], v[180:183], v[64:67]
    ds_read_b128 a[244:247], v1 offset:59392
    v_cvt_pk_bf16_f32 v93, v95, v93
    v_mfma_f32_16x16x32_bf16 v[68:71], a[224:227], v[176:179], v[68:71]
    v_accvgpr_write_b32 a250, v93
    v_accvgpr_write_b32 a251, v93
    v_mfma_f32_16x16x32_bf16 v[72:75], a[224:227], v[180:183], v[72:75]
    s_waitcnt lgkmcnt(3)
    ds_read_b128 a[224:227], v1 offset:34816
    v_mfma_f32_16x16x32_bf16 v[76:79], a[228:231], v[176:179], v[76:79]
    v_rsq_f32 v38, v27
    v_mfma_f32_16x16x32_bf16 v[80:83], a[228:231], v[180:183], v[80:83]
    ds_read_b128 a[228:231], v1 offset:61440
    v_cvt_pk_bf16_f32 v42, v26, v26
    v_mfma_f32_16x16x32_bf16 v[52:55], a[232:235], v[184:187], v[52:55]
    v_and_b32 v43, 0xffff0000, v42
    v_sub_f32 v43, v26, v43
    v_mfma_f32_16x16x32_bf16 v[56:59], a[232:235], v[188:191], v[56:59]
    s_waitcnt lgkmcnt(3)
    ds_read_b128 a[232:235], v1 offset:62464
    v_cvt_pk_bf16_f32 v43, v43, v43
    v_mfma_f32_16x16x32_bf16 v[60:63], a[236:239], v[184:187], v[60:63]
    v_cvt_pk_bf16_f32 v44, v28, v28
    v_and_b32 v45, 0xffff0000, v44
    v_mfma_f32_16x16x32_bf16 v[64:67], a[236:239], v[188:191], v[64:67]
    ds_read_b128 a[236:239], v1 offset:63488
    v_sub_f32 v45, v28, v45
    v_mfma_f32_16x16x32_bf16 v[68:71], a[240:243], v[184:187], v[68:71]
    v_cvt_pk_bf16_f32 v45, v45, v45
    v_mov_b32 v39, v38
    v_mfma_f32_16x16x32_bf16 v[72:75], a[240:243], v[188:191], v[72:75]
    s_waitcnt lgkmcnt(3)
    ds_read_b128 a[240:243], v1 offset:64512
    v_mfma_f32_16x16x32_bf16 v[76:79], a[244:247], v[184:187], v[76:79]
    s_waitcnt vmcnt(8)
    s_barrier
    v_mfma_f32_16x16x32_bf16 v[80:83], a[244:247], v[188:191], v[80:83]
    ds_read_b128 a[244:247], v2 offset:1024
    v_mfma_f32_16x16x32_bf16 v[84:87], a[224:227], v[144:147], v[84:87]
    s_add_u32 m0, s74, 114688
    s_add_u32 s44, s51, 114688
    buffer_load_dwordx4 v1, s[4:7], s44 offen offset:0 sc1 lds
    v_mfma_f32_16x16x32_bf16 v[88:91], a[224:227], v[148:151], v[88:91]
    s_waitcnt lgkmcnt(3)
    ds_read_b128 a[224:227], v2 offset:2048
    v_mfma_f32_16x16x32_bf16 v[52:55], a[228:231], v[192:195], v[52:55]
    s_add_u32 m0, s74, 114688
    s_add_u32 s44, s51, 114688
    buffer_load_dwordx4 v1, s[4:7], s44 offen offset:1024 sc1 lds
    v_mfma_f32_16x16x32_bf16 v[56:59], a[228:231], v[196:199], v[56:59]
    ds_read_b128 a[228:231], v2 offset:3072
    v_mfma_f32_16x16x32_bf16 v[60:63], a[232:235], v[192:195], v[60:63]
    s_add_u32 m0, s74, 114688
    s_add_u32 s44, s51, 114688
    buffer_load_dwordx4 v1, s[4:7], s44 offen offset:2048 sc1 lds
    v_mfma_f32_16x16x32_bf16 v[64:67], a[232:235], v[196:199], v[64:67]
    s_waitcnt lgkmcnt(3)
    ds_read_b128 a[232:235], v2 offset:4096
    v_mfma_f32_16x16x32_bf16 v[68:71], a[236:239], v[192:195], v[68:71]
    s_add_u32 m0, s74, 114688
    s_add_u32 s44, s51, 114688
    buffer_load_dwordx4 v1, s[4:7], s44 offen offset:3072 sc1 lds
    v_mfma_f32_16x16x32_bf16 v[72:75], a[236:239], v[196:199], v[72:75]
    ds_read_b128 a[236:239], v1 offset:39936
    v_mfma_f32_16x16x32_bf16 v[76:79], a[240:243], v[192:195], v[76:79]
    v_permlane16_swap_b32 v38, v39
    v_mfma_f32_16x16x32_bf16 v[80:83], a[240:243], v[196:199], v[80:83]
    s_waitcnt lgkmcnt(3)
    ds_read_b128 a[240:243], v2 offset:6144
    v_mfma_f32_16x16x32_bf16 v[52:55], a[244:247], v[200:203], v[52:55]
    s_cmp_ge_u32 s58, 1
    s_cselect_b32 s38, 0, 1073741824
    s_cselect_b32 s36, 0, 128
    v_mfma_f32_16x16x32_bf16 v[56:59], a[244:247], v[204:207], v[56:59]
    ds_read_b128 a[244:247], v2 offset:7168
    v_mfma_f32_16x16x32_bf16 v[60:63], a[224:227], v[200:203], v[60:63]
    s_cmp_ge_u32 s58, 2
    s_cselect_b32 s39, 0, 1073741824
    s_cselect_b32 s37, 0, 256
    v_mfma_f32_16x16x32_bf16 v[64:67], a[224:227], v[204:207], v[64:67]
    s_waitcnt lgkmcnt(3)
    s_add_u32 s36, s36, 128
    ds_read_b128 a[224:227], v2 offset:8192
    v_mfma_f32_16x16x32_bf16 v[68:71], a[228:231], v[200:203], v[68:71]
    s_sub_u32 s36, s36, s37
    s_add_u32 s37, s37, s97
    v_mfma_f32_16x16x32_bf16 v[72:75], a[228:231], v[204:207], v[72:75]
    s_add_u32 s35, s93, 0
    ds_read_b128 a[228:231], v2 offset:9216
    v_mfma_f32_16x16x32_bf16 v[76:79], a[232:235], v[200:203], v[76:79]
    s_add_u32 s34, s35, s94
    v_add_u32 v40, s38, v1
    v_mfma_f32_16x16x32_bf16 v[80:83], a[232:235], v[204:207], v[80:83]
    s_waitcnt lgkmcnt(3)
    ds_read_b128 a[232:235], v1 offset:45056
    v_add_u32 v41, s39, v1
    v_mfma_f32_16x16x32_bf16 v[84:87], a[236:239], v[152:155], v[84:87]
    v_bfe_u32 v49, v0, 2, 1
    v_mul_lo_u32 v49, v49, s36
    v_mfma_f32_16x16x32_bf16 v[88:91], a[236:239], v[156:159], v[88:91]
    ds_read_b128 a[236:239], v2 offset:11264
    v_and_b32 v46, 3, v0
    v_mfma_f32_16x16x32_bf16 v[52:55], a[240:243], v[208:211], v[52:55]
    v_lshl_add_u32 v49, v46, 2, v49
    v_add_u32 v49, s37, v49
    v_mfma_f32_16x16x32_bf16 v[56:59], a[240:243], v[212:215], v[56:59]
    s_waitcnt lgkmcnt(3)
    ds_read_b128 a[240:243], v2 offset:12288
    v_mfma_f32_16x16x32_bf16 v[60:63], a[244:247], v[208:211], v[60:63]
    v_mfma_f32_16x16x32_bf16 v[64:67], a[244:247], v[212:215], v[64:67]
    ds_read_b128 a[244:247], v2 offset:13312
    v_mfma_f32_16x16x32_bf16 v[68:71], a[224:227], v[208:211], v[68:71]
    s_bfm_b64 vcc, 16, 0
    v_cndmask_b32 v30, 0, v42, vcc
    v_cndmask_b32 v31, 0, v43, vcc
    v_mfma_f32_16x16x32_bf16 v[72:75], a[224:227], v[212:215], v[72:75]
    s_waitcnt lgkmcnt(3)
    ds_read_b128 a[224:227], v2 offset:14336
    v_mov_b32 v32, 0
    v_mov_b32 v33, 0
    v_mfma_f32_16x16x32_bf16 v[76:79], a[228:231], v[208:211], v[76:79]
    s_waitcnt vmcnt(8)
    s_barrier
    s_bfm_b64 vcc, 16, 0
    v_cndmask_b32 v34, 0, v44, vcc
    v_cndmask_b32 v35, 0, v45, vcc
    v_mfma_f32_16x16x32_bf16 v[80:83], a[228:231], v[212:215], v[80:83]
    ds_read_b128 a[228:231], v2 offset:16384
    v_mov_b32 v36, 0
    v_mov_b32 v37, 0
    v_mfma_f32_16x16x32_bf16 v[84:87], a[232:235], v[160:163], v[84:87]
    s_add_u32 m0, s74, 131072
    s_add_u32 s44, s51, 131072
    buffer_load_dwordx4 v1, s[4:7], s44 offen offset:0 sc1 lds
    v_mfma_f32_16x16x32_bf16 v[88:91], a[232:235], v[164:167], v[88:91]
    s_waitcnt lgkmcnt(3)
    ds_read_b128 a[232:235], v2 offset:17408
    v_mfma_f32_16x16x32_bf16 v[52:55], a[248:251], v[30:33], v[52:55]
    s_add_u32 m0, s74, 131072
    s_add_u32 s44, s51, 131072
    buffer_load_dwordx4 v1, s[4:7], s44 offen offset:1024 sc1 lds
    v_mfma_f32_16x16x32_bf16 v[56:59], a[248:251], v[34:37], v[56:59]
    s_add_u32 m0, s74, 131072
    s_add_u32 s44, s51, 131072
    buffer_load_dwordx4 v1, s[4:7], s44 offen offset:2048 sc1 lds
    v_mfma_f32_16x16x32_bf16 v[52:55], a[236:239], v[216:219], v[52:55]
    v_mfma_f32_16x16x32_bf16 v[56:59], a[236:239], v[220:223], v[56:59]
    ds_read_b128 a[236:239], v2 offset:18432
    s_add_u32 m0, s74, 131072
    s_add_u32 s44, s51, 131072
    buffer_load_dwordx4 v1, s[4:7], s44 offen offset:3072 sc1 lds
    v_mfma_f32_16x16x32_bf16 v[60:63], a[240:243], v[216:219], v[60:63]
    s_bfm_b64 vcc, 16, 32
    v_cndmask_b32 v30, 0, v42, vcc
    v_cndmask_b32 v31, 0, v43, vcc
    v_mfma_f32_16x16x32_bf16 v[64:67], a[240:243], v[220:223], v[64:67]
    s_waitcnt lgkmcnt(3)
    ds_read_b128 a[240:243], v2 offset:19456
    v_mfma_f32_16x16x32_bf16 v[68:71], a[244:247], v[216:219], v[68:71]
    s_bfm_b64 vcc, 16, 32
    v_cndmask_b32 v34, 0, v44, vcc
    v_cndmask_b32 v35, 0, v45, vcc
    buffer_load_dwordx4 v[26:29], v15, s[4:7], 0 offen sc1
    v_mfma_f32_16x16x32_bf16 v[72:75], a[244:247], v[220:223], v[72:75]
    ds_read_b128 a[244:247], v1 offset:50176
    v_mfma_f32_16x16x32_bf16 v[76:79], a[224:227], v[216:219], v[76:79]
    v_mfma_f32_16x16x32_bf16 v[80:83], a[224:227], v[220:223], v[80:83]
    s_waitcnt lgkmcnt(3)
    ds_read_b128 a[224:227], v2 offset:21504
    v_mfma_f32_16x16x32_bf16 v[60:63], a[248:251], v[30:33], v[60:63]
    v_mfma_f32_16x16x32_bf16 v[64:67], a[248:251], v[34:37], v[64:67]
    v_mfma_f32_16x16x32_bf16 v[52:55], a[228:231], v[224:227], v[52:55]
    v_mfma_f32_16x16x32_bf16 v[56:59], a[228:231], v[228:231], v[56:59]
    ds_read_b128 a[228:231], v2 offset:22528
    v_mfma_f32_16x16x32_bf16 v[60:63], a[232:235], v[224:227], v[60:63]
    v_mfma_f32_16x16x32_bf16 v[64:67], a[232:235], v[228:231], v[64:67]
    s_waitcnt lgkmcnt(3)
    ds_read_b128 a[232:235], v2 offset:23552
    v_mfma_f32_16x16x32_bf16 v[68:71], a[236:239], v[224:227], v[68:71]
    s_bfm_b64 vcc, 16, 16
    v_cndmask_b32 v30, 0, v42, vcc
    v_cndmask_b32 v31, 0, v43, vcc
    v_mfma_f32_16x16x32_bf16 v[72:75], a[236:239], v[228:231], v[72:75]
    ds_read_b128 a[236:239], v2 offset:24576
    v_mfma_f32_16x16x32_bf16 v[76:79], a[240:243], v[224:227], v[76:79]
    s_bfm_b64 vcc, 16, 16
    v_cndmask_b32 v34, 0, v44, vcc
    v_cndmask_b32 v35, 0, v45, vcc
    v_mfma_f32_16x16x32_bf16 v[80:83], a[240:243], v[228:231], v[80:83]
    s_waitcnt lgkmcnt(3)
    ds_read_b128 a[240:243], v2 offset:26624
    v_mfma_f32_16x16x32_bf16 v[84:87], a[244:247], v[168:171], v[84:87]
    v_mfma_f32_16x16x32_bf16 v[88:91], a[244:247], v[172:175], v[88:91]
    ds_read_b128 a[244:247], v2 offset:27648
    v_mfma_f32_16x16x32_bf16 v[68:71], a[248:251], v[30:33], v[68:71]
    v_mfma_f32_16x16x32_bf16 v[72:75], a[248:251], v[34:37], v[72:75]
    v_mfma_f32_16x16x32_bf16 v[52:55], a[224:227], v[232:235], v[52:55]
    v_mfma_f32_16x16x32_bf16 v[56:59], a[224:227], v[236:239], v[56:59]
    s_waitcnt lgkmcnt(3)
    ds_read_b128 a[224:227], v2 offset:28672
    v_mfma_f32_16x16x32_bf16 v[60:63], a[228:231], v[232:235], v[60:63]
    s_bfm_b64 vcc, 16, 48
    v_cndmask_b32 v30, 0, v42, vcc
    v_cndmask_b32 v31, 0, v43, vcc
    v_mfma_f32_16x16x32_bf16 v[64:67], a[228:231], v[236:239], v[64:67]
    ds_read_b128 a[228:231], v2 offset:29696
    v_mfma_f32_16x16x32_bf16 v[68:71], a[232:235], v[232:235], v[68:71]
    s_bfm_b64 vcc, 16, 48
    v_cndmask_b32 v34, 0, v44, vcc
    v_cndmask_b32 v35, 0, v45, vcc
    v_mfma_f32_16x16x32_bf16 v[72:75], a[232:235], v[236:239], v[72:75]
    s_waitcnt lgkmcnt(3)
    ds_read_b128 a[232:235], v1 offset:55296
    v_mfma_f32_16x16x32_bf16 v[76:79], a[236:239], v[232:235], v[76:79]
    v_mfma_f32_16x16x32_bf16 v[80:83], a[236:239], v[236:239], v[80:83]
    ds_read_b128 a[236:239], v2 offset:31744
    v_mfma_f32_16x16x32_bf16 v[76:79], a[248:251], v[30:33], v[76:79]
    v_mfma_f32_16x16x32_bf16 v[80:83], a[248:251], v[34:37], v[80:83]
    v_mfma_f32_16x16x32_bf16 v[52:55], a[240:243], v[240:243], v[52:55]
    s_waitcnt vmcnt(9)
    s_barrier
    v_mfma_f32_16x16x32_bf16 v[56:59], a[240:243], v[244:247], v[56:59]
    s_waitcnt lgkmcnt(3)
    ds_read_b128 a[240:243], v2 offset:32768
    v_mfma_f32_16x16x32_bf16 v[60:63], a[244:247], v[240:243], v[60:63]
    s_add_u32 m0, s74, 147456
    s_add_u32 s44, s51, 147456
    s_mul_i32 s59, s3, 2048
    s_sub_u32 m0, m0, s59
    s_sub_u32 s44, s44, s59
    buffer_load_dwordx4 v1, s[4:7], s44 offen offset:0 sc1 lds
    v_mfma_f32_16x16x32_bf16 v[64:67], a[244:247], v[244:247], v[64:67]
    ds_read_b128 a[244:247], v2 offset:33792
    s_add_u32 m0, s74, 147456
    s_add_u32 s44, s51, 147456
    s_mul_i32 s59, s3, 2048
    s_sub_u32 m0, m0, s59
    s_sub_u32 s44, s44, s59
    buffer_load_dwordx4 v1, s[4:7], s44 offen offset:1024 sc1 lds
    v_mfma_f32_16x16x32_bf16 v[68:71], a[224:227], v[240:243], v[68:71]
    s_bfm_b64 vcc, 16, 0
    v_cndmask_b32 v32, 0, v42, vcc
    v_cndmask_b32 v33, 0, v43, vcc
    v_mfma_f32_16x16x32_bf16 v[72:75], a[224:227], v[244:247], v[72:75]
    s_waitcnt lgkmcnt(3)
    ds_read_b128 a[224:227], v2 offset:34816
    v_mov_b32 v30, 0
    v_mov_b32 v31, 0
    v_mfma_f32_16x16x32_bf16 v[76:79], a[228:231], v[240:243], v[76:79]
    s_bfm_b64 vcc, 16, 0
    v_cndmask_b32 v36, 0, v44, vcc
    v_cndmask_b32 v37, 0, v45, vcc
    v_mfma_f32_16x16x32_bf16 v[80:83], a[228:231], v[244:247], v[80:83]
    ds_read_b128 a[228:231], v1 offset:60416
    v_mov_b32 v34, 0
    v_mov_b32 v35, 0
    v_mfma_f32_16x16x32_bf16 v[84:87], a[232:235], v[176:179], v[84:87]
    s_waitcnt vmcnt(2)
    v_min3_u32 v26, v26, v27, v28
    v_min_u32 v26, v26, v29
    v_cmp_gt_u32 vcc, 1, v26
    s_nop 0
    s_cbranch_vccnz L_rest
L_rested:
    v_cmp_ne_u32 vcc, s54, v26
    s_nop 0
    s_mov_b32 s50, vcc_hi
    v_mfma_f32_16x16x32_bf16 v[88:91], a[232:235], v[180:183], v[88:91]
    s_waitcnt lgkmcnt(3)
    ds_read_b128 a[232:235], v2 offset:0
    v_mfma_f32_16x16x32_bf16 v[84:87], a[248:251], v[30:33], v[84:87]
    s_add_u32 s43, s92, 0
    buffer_load_dwordx4 a[0:3], v1, s[4:7], s43 offen offset:0 sc1
    v_mfma_f32_16x16x32_bf16 v[88:91], a[248:251], v[34:37], v[88:91]
    v_mfma_f32_16x16x32_bf16 v[52:55], a[236:239], v[248:251], v[52:55]
    v_mfma_f32_16x16x32_bf16 v[56:59], a[236:239], v[252:255], v[56:59]
    ds_read_b128 a[236:239], v2 offset:5120
    v_mfma_f32_16x16x32_bf16 v[60:63], a[240:243], v[248:251], v[60:63]
    buffer_load_dwordx4 a[4:7], v1, s[4:7], s43 offen offset:1024 sc1
    v_mfma_f32_16x16x32_bf16 v[64:67], a[240:243], v[252:255], v[64:67]
    s_waitcnt lgkmcnt(3)
    ds_read_b128 a[240:243], v2 offset:10240
    v_mfma_f32_16x16x32_bf16 v[68:71], a[244:247], v[248:251], v[68:71]
    v_mfma_f32_16x16x32_bf16 v[72:75], a[244:247], v[252:255], v[72:75]
    ds_read_b128 a[244:247], v2 offset:15360
    v_mfma_f32_16x16x32_bf16 v[76:79], a[224:227], v[248:251], v[76:79]
    v_mfma_f32_16x16x32_bf16 v[80:83], a[224:227], v[252:255], v[80:83]
    s_waitcnt lgkmcnt(3)
    ds_read_b128 a[224:227], v2 offset:20480
    v_mfma_f32_16x16x32_bf16 v[84:87], a[228:231], v[184:187], v[84:87]
    buffer_load_dwordx4 a[8:11], v1, s[4:7], s43 offen offset:2048 sc1
    v_mfma_f32_16x16x32_bf16 v[88:91], a[228:231], v[188:191], v[88:91]
    ds_read_b128 a[228:231], v2 offset:25600
    v_mfma_f32_16x16x32_bf16 v[84:87], a[232:235], v[192:195], v[84:87]
    v_mfma_f32_16x16x32_bf16 v[88:91], a[232:235], v[196:199], v[88:91]
    s_waitcnt lgkmcnt(3)
    ds_read_b128 a[232:235], v2 offset:30720
    v_mul_f32 v52, v38, v52
    v_mul_f32 v53, v38, v53
    v_mul_f32 v54, v38, v54
    v_mfma_f32_16x16x32_bf16 v[84:87], a[236:239], v[200:203], v[84:87]
    buffer_load_dwordx4 a[12:15], v1, s[4:7], s43 offen offset:3072 sc1
    v_mul_f32 v55, v38, v55
    v_cvt_pk_bf16_f32 v52, v52, v53
    v_mfma_f32_16x16x32_bf16 v[88:91], a[236:239], v[204:207], v[88:91]
    ds_read_b128 a[236:239], v2 offset:35840
    v_cvt_pk_bf16_f32 v53, v54, v55
    v_mul_f32 v56, v39, v56
    v_mul_f32 v57, v39, v57
    v_mfma_f32_16x16x32_bf16 v[84:87], a[240:243], v[208:211], v[84:87]
    v_mul_f32 v58, v39, v58
    v_mul_f32 v59, v39, v59
    v_cvt_pk_bf16_f32 v54, v56, v57
    v_cvt_pk_bf16_f32 v55, v58, v59
    v_mfma_f32_16x16x32_bf16 v[88:91], a[240:243], v[212:215], v[88:91]
    s_waitcnt lgkmcnt(3)
    ds_read_b128 a[240:243], v2 offset:36864
    v_permlane16_swap_b32 v52, v54
    v_mfma_f32_16x16x32_bf16 v[84:87], a[244:247], v[216:219], v[84:87]
    v_permlane16_swap_b32 v53, v55
    v_mfma_f32_16x16x32_bf16 v[88:91], a[244:247], v[220:223], v[88:91]
    ds_read_b128 a[244:247], v2 offset:37888
    buffer_store_dwordx4 v[52:55], v1, s[4:7], s35 offen sc1
    v_mul_f32 v60, v38, v60
    v_mfma_f32_16x16x32_bf16 v[84:87], a[224:227], v[224:227], v[84:87]
    s_add_u32 s43, s92, 4096
    buffer_load_dwordx4 a[16:19], v1, s[4:7], s43 offen offset:0 sc1
    v_mul_f32 v61, v38, v61
    v_mul_f32 v62, v38, v62
    v_mfma_f32_16x16x32_bf16 v[88:91], a[224:227], v[228:231], v[88:91]
    s_waitcnt lgkmcnt(3)
    ds_read_b128 a[224:227], v13 offset:0
    v_mul_f32 v63, v38, v63
    v_cvt_pk_bf16_f32 v60, v60, v61
    v_cvt_pk_bf16_f32 v61, v62, v63
    v_mfma_f32_16x16x32_bf16 v[84:87], a[228:231], v[232:235], v[84:87]
    v_mul_f32 v64, v39, v64
    v_mul_f32 v65, v39, v65
    v_mul_f32 v66, v39, v66
    v_mul_f32 v67, v39, v67
    v_mfma_f32_16x16x32_bf16 v[88:91], a[228:231], v[236:239], v[88:91]
    ds_read_b128 a[228:231], v2 offset:39424
    v_cvt_pk_bf16_f32 v62, v64, v65
    v_cvt_pk_bf16_f32 v63, v66, v67
    v_mfma_f32_16x16x32_bf16 v[84:87], a[232:235], v[240:243], v[84:87]
    v_permlane16_swap_b32 v60, v62
    v_permlane16_swap_b32 v61, v63
    v_mfma_f32_16x16x32_bf16 v[88:91], a[232:235], v[244:247], v[88:91]
    s_waitcnt lgkmcnt(3)
    ds_read_b128 a[232:235], v2 offset:40448
    buffer_store_dwordx4 v[60:63], v9, s[4:7], s35 offen offset:1024 sc1
    v_mul_f32 v76, v38, v76
    v_mfma_f32_16x16x32_bf16 v[84:87], a[236:239], v[248:251], v[84:87]
    buffer_load_dwordx4 a[20:23], v1, s[4:7], s43 offen offset:1024 sc1
    v_mul_f32 v77, v38, v77
    v_mul_f32 v78, v38, v78
    v_mfma_f32_16x16x32_bf16 v[88:91], a[236:239], v[252:255], v[88:91]
    ds_read_b128 a[236:239], v13 offset:2560
    v_mul_f32 v79, v38, v79
    v_cvt_pk_bf16_f32 v76, v76, v77
    v_cvt_pk_bf16_f32 v77, v78, v79
    v_mfma_f32_16x16x32_bf16 v[92:95], a[240:243], a[204:207], 0
    v_mul_f32 v80, v39, v80
    v_mul_f32 v81, v39, v81
    v_mul_f32 v82, v39, v82
    v_mul_f32 v83, v39, v83
    v_mfma_f32_16x16x32_bf16 v[96:99], a[240:243], a[208:211], 0
    s_waitcnt lgkmcnt(3)
    ds_read_b128 a[240:243], v2 offset:41984
    v_cvt_pk_bf16_f32 v78, v80, v81
    v_cvt_pk_bf16_f32 v79, v82, v83
    v_mov_b32 v80, s70
    v_mfma_f32_16x16x32_bf16 v[100:103], a[244:247], a[204:207], 0
    buffer_load_dwordx4 a[24:27], v1, s[4:7], s43 offen offset:2048 sc1
    v_mov_b32 v81, s70
    v_mfma_f32_16x16x32_bf16 v[104:107], a[244:247], a[208:211], 0
    ds_read_b128 a[244:247], v2 offset:43008
    v_permlane16_swap_b32 v76, v78
    v_mfma_f32_16x16x32_bf16 v[108:111], a[224:227], a[204:207], 0
    v_permlane16_swap_b32 v77, v79
    v_mfma_f32_16x16x32_bf16 v[112:115], a[224:227], a[208:211], 0
    s_waitcnt lgkmcnt(3)
    ds_read_b128 a[224:227], v13 offset:5120
    v_mfma_f32_16x16x32_bf16 v[92:95], a[228:231], a[212:215], v[92:95]
    buffer_store_dwordx4 v[78:81], v10, s[4:7], s35 offen offset:2048 sc1
    buffer_store_dwordx2 v[76:77], v14, s[4:7], s35 offen offset:2560 sc1
    v_mfma_f32_16x16x32_bf16 v[96:99], a[228:231], a[216:219], v[96:99]
    ds_read_b128 a[228:231], v2 offset:44544
    v_mul_f32 v68, v38, v68
    v_mfma_f32_16x16x32_bf16 v[100:103], a[232:235], a[212:215], v[100:103]
    buffer_load_dwordx4 a[28:31], v1, s[4:7], s43 offen offset:3072 sc1
    v_mfma_f32_16x16x32_bf16 v[104:107], a[232:235], a[216:219], v[104:107]
    s_waitcnt lgkmcnt(3)
    ds_read_b128 a[232:235], v2 offset:45568
    v_mul_f32 v69, v38, v69
    v_mfma_f32_16x16x32_bf16 v[108:111], a[236:239], a[212:215], v[108:111]
    v_mul_f32 v70, v38, v70
    v_mul_f32 v71, v38, v71
    v_mfma_f32_16x16x32_bf16 v[112:115], a[236:239], a[216:219], v[112:115]
    ds_read_b128 a[236:239], v13 offset:7680
    v_cvt_pk_bf16_f32 v68, v68, v69
    v_mfma_f32_16x16x32_bf16 v[92:95], a[240:243], a[220:223], v[92:95]
    s_add_u32 s43, s92, 8192
    buffer_load_dwordx4 a[32:35], v1, s[4:7], s43 offen offset:0 sc1
    v_mfma_f32_16x16x32_bf16 v[96:99], a[240:243], v[116:119], v[96:99]
    s_waitcnt lgkmcnt(3)
    ds_read_b128 a[240:243], v2 offset:47104
    v_cvt_pk_bf16_f32 v69, v70, v71
    v_mfma_f32_16x16x32_bf16 v[100:103], a[244:247], a[220:223], v[100:103]
    v_mul_f32 v72, v39, v72
    v_mul_f32 v73, v39, v73
    v_mfma_f32_16x16x32_bf16 v[104:107], a[244:247], v[116:119], v[104:107]
    ds_read_b128 a[244:247], v2 offset:48128
    v_mul_f32 v74, v39, v74
    v_mfma_f32_16x16x32_bf16 v[108:111], a[224:227], a[220:223], v[108:111]
    s_barrier
    v_mul_f32 v75, v39, v75
    v_mfma_f32_16x16x32_bf16 v[112:115], a[224:227], v[116:119], v[112:115]
    s_waitcnt lgkmcnt(3)
    ds_read_b128 a[224:227], v13 offset:10240
    v_cvt_pk_bf16_f32 v70, v72, v73
    v_mfma_f32_16x16x32_bf16 v[92:95], a[228:231], v[120:123], v[92:95]
    buffer_load_dwordx4 a[36:39], v1, s[4:7], s43 offen offset:1024 sc1
    v_mfma_f32_16x16x32_bf16 v[96:99], a[228:231], v[124:127], v[96:99]
    ds_read_b128 a[228:231], v2 offset:49664
    v_cvt_pk_bf16_f32 v71, v74, v75
    v_mfma_f32_16x16x32_bf16 v[100:103], a[232:235], v[120:123], v[100:103]
    v_permlane16_swap_b32 v68, v70
    v_mfma_f32_16x16x32_bf16 v[104:107], a[232:235], v[124:127], v[104:107]
    s_waitcnt lgkmcnt(3)
    ds_read_b128 a[232:235], v2 offset:50688
    v_mfma_f32_16x16x32_bf16 v[108:111], a[236:239], v[120:123], v[108:111]
    v_permlane16_swap_b32 v69, v71
    v_mfma_f32_16x16x32_bf16 v[112:115], a[236:239], v[124:127], v[112:115]
    ds_read_b128 a[236:239], v13 offset:12800
    v_mul_f32 v84, v38, v84
    v_mfma_f32_16x16x32_bf16 v[92:95], a[240:243], v[128:131], v[92:95]
    buffer_load_dwordx4 a[40:43], v1, s[4:7], s43 offen offset:2048 sc1
    v_mfma_f32_16x16x32_bf16 v[96:99], a[240:243], v[132:135], v[96:99]
    s_waitcnt lgkmcnt(3)
    ds_read_b128 a[240:243], v2 offset:52224
    v_mul_f32 v85, v38, v85
    v_mfma_f32_16x16x32_bf16 v[100:103], a[244:247], v[128:131], v[100:103]
    v_mul_f32 v86, v38, v86
    v_mul_f32 v87, v38, v87
    v_mfma_f32_16x16x32_bf16 v[104:107], a[244:247], v[132:135], v[104:107]
    ds_read_b128 a[244:247], v2 offset:53248
    v_cvt_pk_bf16_f32 v84, v84, v85
    v_mfma_f32_16x16x32_bf16 v[108:111], a[224:227], v[128:131], v[108:111]
    buffer_load_dwordx4 a[44:47], v1, s[4:7], s43 offen offset:3072 sc1
    v_mfma_f32_16x16x32_bf16 v[112:115], a[224:227], v[132:135], v[112:115]
    s_waitcnt lgkmcnt(3)
    ds_read_b128 a[224:227], v13 offset:15360
    v_cvt_pk_bf16_f32 v85, v86, v87
    v_mfma_f32_16x16x32_bf16 v[92:95], a[228:231], v[136:139], v[92:95]
    s_add_u32 m0, s74, 0
    s_add_u32 s44, s52, 0
    buffer_load_dwordx4 v1, s[4:7], s44 offen offset:0 sc1 lds
    v_mfma_f32_16x16x32_bf16 v[96:99], a[228:231], v[140:143], v[96:99]
    ds_read_b128 a[228:231], v2 offset:54784
    v_mul_f32 v88, v39, v88
    v_mfma_f32_16x16x32_bf16 v[100:103], a[232:235], v[136:139], v[100:103]
    v_mul_f32 v89, v39, v89
    v_mul_f32 v90, v39, v90
    v_mfma_f32_16x16x32_bf16 v[104:107], a[232:235], v[140:143], v[104:107]
    s_waitcnt lgkmcnt(3)
    ds_read_b128 a[232:235], v2 offset:55808
    v_mul_f32 v91, v39, v91
    v_mfma_f32_16x16x32_bf16 v[108:111], a[236:239], v[136:139], v[108:111]
    s_add_u32 s43, s92, 12288
    buffer_load_dwordx4 a[48:51], v1, s[4:7], s43 offen offset:0 sc1
    v_mfma_f32_16x16x32_bf16 v[112:115], a[236:239], v[140:143], v[112:115]
    ds_read_b128 a[236:239], v13 offset:17920
    v_cvt_pk_bf16_f32 v86, v88, v89
    v_mfma_f32_16x16x32_bf16 v[92:95], a[240:243], v[144:147], v[92:95]
    v_cvt_pk_bf16_f32 v87, v90, v91
    v_mul_f32 v38, 0x3ea52b5c, v38
    v_mfma_f32_16x16x32_bf16 v[96:99], a[240:243], v[148:151], v[96:99]
    s_waitcnt lgkmcnt(3)
    ds_read_b128 a[240:243], v2 offset:57344
    v_mul_f32 v39, 0x3ea52b5c, v39
    v_mfma_f32_16x16x32_bf16 v[100:103], a[244:247], v[144:147], v[100:103]
    buffer_load_dwordx4 a[52:55], v1, s[4:7], s43 offen offset:1024 sc1
    buffer_load_dwordx4 v1, s[4:7], s44 offen offset:1024 sc1 lds
    v_mfma_f32_16x16x32_bf16 v[104:107], a[244:247], v[148:151], v[104:107]
    ds_read_b128 a[244:247], v2 offset:58368
    v_mfma_f32_16x16x32_bf16 v[108:111], a[224:227], v[144:147], v[108:111]
    v_permlane16_swap_b32 v84, v86
    v_mfma_f32_16x16x32_bf16 v[112:115], a[224:227], v[148:151], v[112:115]
    s_waitcnt lgkmcnt(3)
    ds_read_b128 a[224:227], v13 offset:20480
    v_mfma_f32_16x16x32_bf16 v[92:95], a[228:231], v[152:155], v[92:95]
    buffer_store_dwordx4 v[68:71], v1, s[4:7], s34 offen sc1
    v_mfma_f32_16x16x32_bf16 v[96:99], a[228:231], v[156:159], v[96:99]
    ds_read_b128 a[228:231], v2 offset:59904
    v_mfma_f32_16x16x32_bf16 v[100:103], a[232:235], v[152:155], v[100:103]
    buffer_load_dwordx4 a[56:59], v1, s[4:7], s43 offen offset:2048 sc1
    v_mfma_f32_16x16x32_bf16 v[104:107], a[232:235], v[156:159], v[104:107]
    s_waitcnt lgkmcnt(3)
    ds_read_b128 a[232:235], v2 offset:60928
    v_mfma_f32_16x16x32_bf16 v[108:111], a[236:239], v[152:155], v[108:111]
    buffer_load_dwordx4 v1, s[4:7], s44 offen offset:2048 sc1 lds
    v_mov_b32 v50, 1
    s_waitcnt vmcnt(12)
    s_mov_b64 exec, 1
    buffer_store_dword v50, v0, s[4:7], s73 offen offset:0 sc1
    s_mov_b64 exec, -1
    v_mfma_f32_16x16x32_bf16 v[112:115], a[236:239], v[156:159], v[112:115]
    ds_read_b128 a[236:239], v13 offset:23040
    v_mfma_f32_16x16x32_bf16 v[92:95], a[240:243], v[160:163], v[92:95]
    v_permlane16_swap_b32 v85, v87
    v_mfma_f32_16x16x32_bf16 v[96:99], a[240:243], v[164:167], v[96:99]
    s_waitcnt lgkmcnt(3)
    ds_read_b128 a[240:243], v2 offset:62464
    v_mfma_f32_16x16x32_bf16 v[100:103], a[244:247], v[160:163], v[100:103]
    buffer_load_dwordx4 a[60:63], v1, s[4:7], s43 offen offset:3072 sc1
    buffer_store_dwordx4 v[84:87], v9, s[4:7], s34 offen offset:1024 sc1
    v_mfma_f32_16x16x32_bf16 v[104:107], a[244:247], v[164:167], v[104:107]
    ds_read_b128 a[244:247], v2 offset:63488
    v_mfma_f32_16x16x32_bf16 v[108:111], a[224:227], v[160:163], v[108:111]
    v_mfma_f32_16x16x32_bf16 v[112:115], a[224:227], v[164:167], v[112:115]
    s_waitcnt lgkmcnt(3)
    ds_read_b128 a[224:227], v13 offset:25600
    v_mfma_f32_16x16x32_bf16 v[92:95], a[228:231], v[168:171], v[92:95]
    s_barrier
    v_mfma_f32_16x16x32_bf16 v[96:99], a[228:231], v[172:175], v[96:99]
    ds_read_b128 a[228:231], v2 offset:65024
    v_add_u32 v15, s95, v1
    v_mfma_f32_16x16x32_bf16 v[100:103], a[232:235], v[168:171], v[100:103]
    buffer_load_dwordx4 v1, s[4:7], s44 offen offset:3072 sc1 lds
    ds_write_b64 v5, v[52:53] offset:24576
    v_mfma_f32_16x16x32_bf16 v[104:107], a[232:235], v[172:175], v[104:107]
    s_waitcnt lgkmcnt(4)
    ds_read_b128 a[232:235], v3 offset:512
    v_subrev_u32 v124, 0, v7
    v_mfma_f32_16x16x32_bf16 v[108:111], a[236:239], v[168:171], v[108:111]
    ds_write_b64 v5, v[54:55] offset:24584
    v_mfma_f32_16x16x32_bf16 v[112:115], a[236:239], v[172:175], v[112:115]
    ds_read_b128 a[236:239], v13 offset:28160
    v_and_b32 v124, s77, v124
    v_mfma_f32_16x16x32_bf16 v[92:95], a[240:243], v[176:179], v[92:95]
    ds_write_b64 v6, v[76:77] offset:27136
    v_mfma_f32_16x16x32_bf16 v[96:99], a[240:243], v[180:183], v[96:99]
    s_waitcnt lgkmcnt(6)
    ds_read_b128 a[240:243], v3 offset:2048
    v_subrev_u32 v125, 1, v7
    v_mfma_f32_16x16x32_bf16 v[100:103], a[244:247], v[176:179], v[100:103]
    ds_write_b64 v11, v[60:61] offset:25600
    v_mfma_f32_16x16x32_bf16 v[104:107], a[244:247], v[180:183], v[104:107]
    ds_read_b128 a[244:247], v3 offset:3072
    v_and_b32 v125, s77, v125
    v_mfma_f32_16x16x32_bf16 v[108:111], a[224:227], v[176:179], v[108:111]
    s_add_u32 m0, s74, 16384
    s_add_u32 s44, s52, 16384
    buffer_load_dwordx4 v1, s[4:7], s44 offen offset:0 sc1 lds
    ds_write_b64 v11, v[62:63] offset:25608
    v_mfma_f32_16x16x32_bf16 v[112:115], a[224:227], v[180:183], v[112:115]
    s_waitcnt lgkmcnt(7)
    ds_read_b128 a[224:227], v13 offset:30720
    v_subrev_u32 v126, 2, v7
    v_mfma_f32_16x16x32_bf16 v[92:95], a[228:231], v[184:187], v[92:95]
    ds_write_b64 v12, v[78:79] offset:26624
    v_mfma_f32_16x16x32_bf16 v[96:99], a[228:231], v[188:191], v[96:99]
    ds_read_b128 a[228:231], v3 offset:4608
    v_and_b32 v126, s77, v126
    v_mfma_f32_16x16x32_bf16 v[100:103], a[232:235], v[184:187], v[100:103]
    ds_write_b64 v12, v[80:81] offset:26632
    v_mfma_f32_16x16x32_bf16 v[104:107], a[232:235], v[188:191], v[104:107]
    s_waitcnt lgkmcnt(7)
    ds_read_b128 a[232:235], v3 offset:5632
    v_subrev_u32 v127, 3, v7
    v_mfma_f32_16x16x32_bf16 v[108:111], a[236:239], v[184:187], v[108:111]
    v_and_b32 v127, s77, v127
    v_subrev_u32 v128, 8, v7
    v_mfma_f32_16x16x32_bf16 v[112:115], a[236:239], v[188:191], v[112:115]
    ds_read_b128 a[236:239], v13 offset:33280
    v_and_b32 v128, s77, v128
    v_mfma_f32_16x16x32_bf16 v[92:95], a[240:243], v[192:195], v[92:95]
    buffer_load_dwordx4 v1, s[4:7], s44 offen offset:1024 sc1 lds
    v_mfma_f32_16x16x32_bf16 v[96:99], a[240:243], v[196:199], v[96:99]
    s_waitcnt lgkmcnt(5)
    ds_read_b128 a[240:243], v3 offset:7168
    v_subrev_u32 v129, 9, v7
    v_mfma_f32_16x16x32_bf16 v[100:103], a[244:247], v[192:195], v[100:103]
    v_and_b32 v129, s77, v129
    v_subrev_u32 v130, 10, v7
    v_mfma_f32_16x16x32_bf16 v[104:107], a[244:247], v[196:199], v[104:107]
    ds_read_b128 a[244:247], v3 offset:8192
    v_and_b32 v130, s77, v130
    v_mfma_f32_16x16x32_bf16 v[108:111], a[224:227], v[192:195], v[108:111]
    v_subrev_u32 v131, 11, v7
    v_and_b32 v131, s77, v131
    v_mfma_f32_16x16x32_bf16 v[112:115], a[224:227], v[196:199], v[112:115]
    s_waitcnt lgkmcnt(3)
    ds_read_b128 a[224:227], v13 offset:35840
    v_subrev_u32 v132, 16, v7
    v_mfma_f32_16x16x32_bf16 v[92:95], a[228:231], v[200:203], v[92:95]
    s_bfm_b64 vcc, 16, 32
    v_cndmask_b32 v32, 0, v42, vcc
    v_cndmask_b32 v33, 0, v43, vcc
    v_mfma_f32_16x16x32_bf16 v[96:99], a[228:231], v[204:207], v[96:99]
    ds_read_b128 a[228:231], v3 offset:9728
    v_and_b32 v132, s77, v132
    v_mfma_f32_16x16x32_bf16 v[100:103], a[232:235], v[200:203], v[100:103]
    s_bfm_b64 vcc, 16, 32
    v_cndmask_b32 v36, 0, v44, vcc
    v_cndmask_b32 v37, 0, v45, vcc
    buffer_load_dwordx4 v1, s[4:7], s44 offen offset:2048 sc1 lds
    v_mfma_f32_16x16x32_bf16 v[104:107], a[232:235], v[204:207], v[104:107]
    s_waitcnt lgkmcnt(3)
    ds_read_b128 a[232:235], v3 offset:10752
    v_subrev_u32 v133, 17, v7
    v_mfma_f32_16x16x32_bf16 v[108:111], a[236:239], v[200:203], v[108:111]
    v_and_b32 v133, s77, v133
    v_subrev_u32 v134, 18, v7
    v_mfma_f32_16x16x32_bf16 v[112:115], a[236:239], v[204:207], v[112:115]
    ds_read_b128 a[236:239], v13 offset:38400
    v_and_b32 v134, s77, v134
    v_mfma_f32_16x16x32_bf16 v[92:95], a[248:251], v[30:33], v[92:95]
    v_subrev_u32 v135, 19, v7
    v_and_b32 v135, s77, v135
    v_mfma_f32_16x16x32_bf16 v[96:99], a[248:251], v[34:37], v[96:99]
    v_subrev_u32 v136, 24, v7
    v_and_b32 v136, s77, v136
    v_mfma_f32_16x16x32_bf16 v[92:95], a[240:243], v[208:211], v[92:95]
    v_subrev_u32 v137, 25, v7
    v_and_b32 v137, s77, v137
    v_mfma_f32_16x16x32_bf16 v[96:99], a[240:243], v[212:215], v[96:99]
    s_waitcnt lgkmcnt(3)
    ds_read_b128 a[240:243], v3 offset:12288
    v_subrev_u32 v138, 26, v7
    v_mfma_f32_16x16x32_bf16 v[100:103], a[244:247], v[208:211], v[100:103]
    buffer_load_dwordx4 v1, s[4:7], s44 offen offset:3072 sc1 lds
    v_mfma_f32_16x16x32_bf16 v[104:107], a[244:247], v[212:215], v[104:107]
    ds_read_b128 a[244:247], v3 offset:13312
    v_and_b32 v138, s77, v138
    v_mfma_f32_16x16x32_bf16 v[108:111], a[224:227], v[208:211], v[108:111]
    v_subrev_u32 v139, 27, v7
    v_and_b32 v139, s77, v139
    v_mfma_f32_16x16x32_bf16 v[112:115], a[224:227], v[212:215], v[112:115]
    s_waitcnt lgkmcnt(3)
    ds_read_b128 a[224:227], v13 offset:40960
    v_mfma_f32_16x16x32_bf16 v[92:95], a[228:231], v[216:219], v[92:95]
    s_bfm_b64 vcc, 16, 16
    v_cndmask_b32 v32, 0, v42, vcc
    v_cndmask_b32 v33, 0, v43, vcc
    v_mfma_f32_16x16x32_bf16 v[96:99], a[228:231], v[220:223], v[96:99]
    ds_read_b128 a[228:231], v3 offset:14848
    v_mfma_f32_16x16x32_bf16 v[100:103], a[232:235], v[216:219], v[100:103]
    s_barrier
    s_bfm_b64 vcc, 16, 16
    v_cndmask_b32 v36, 0, v44, vcc
    v_cndmask_b32 v37, 0, v45, vcc
    buffer_load_dword v140, v49, s[4:7], 0 offen sc1
    v_mfma_f32_16x16x32_bf16 v[104:107], a[232:235], v[220:223], v[104:107]
    s_waitcnt lgkmcnt(3)
    ds_read_b128 a[232:235], v3 offset:15872
    v_mfma_f32_16x16x32_bf16 v[108:111], a[236:239], v[216:219], v[108:111]
    ds_write_b64 v15, v[68:69] offset:20480
    v_mfma_f32_16x16x32_bf16 v[112:115], a[236:239], v[220:223], v[112:115]
    ds_read_b128 a[236:239], v13 offset:43520
    ds_write_b64 v15, v[70:71] offset:20488
    v_mfma_f32_16x16x32_bf16 v[100:103], a[248:251], v[30:33], v[100:103]
    s_add_u32 m0, s74, 32768
    s_add_u32 s44, s52, 32768
    buffer_load_dwordx4 v1, s[4:7], s44 offen offset:0 sc1 lds
    v_mfma_f32_16x16x32_bf16 v[104:107], a[248:251], v[34:37], v[104:107]
    ds_write_b64 v8, v[84:85] offset:21504
    v_mfma_f32_16x16x32_bf16 v[92:95], a[240:243], v[224:227], v[92:95]
    v_mfma_f32_16x16x32_bf16 v[96:99], a[240:243], v[228:231], v[96:99]
    s_waitcnt lgkmcnt(6)
    ds_read_b128 a[240:243], v3 offset:17408
    v_mfma_f32_16x16x32_bf16 v[100:103], a[244:247], v[224:227], v[100:103]
    ds_write_b64 v8, v[86:87] offset:21512
    v_mfma_f32_16x16x32_bf16 v[104:107], a[244:247], v[228:231], v[104:107]
    ds_read_b128 a[244:247], v3 offset:18432
    v_mfma_f32_16x16x32_bf16 v[108:111], a[224:227], v[224:227], v[108:111]
    v_mfma_f32_16x16x32_bf16 v[112:115], a[224:227], v[228:231], v[112:115]
    s_waitcnt lgkmcnt(7)
    ds_read_b128 a[224:227], v13 offset:46080
    buffer_load_dwordx4 v1, s[4:7], s44 offen offset:1024 sc1 lds
    v_mfma_f32_16x16x32_bf16 v[92:95], a[228:231], v[232:235], v[92:95]
    s_bfm_b64 vcc, 16, 48
    v_cndmask_b32 v32, 0, v42, vcc
    v_cndmask_b32 v33, 0, v43, vcc
    v_mfma_f32_16x16x32_bf16 v[96:99], a[228:231], v[236:239], v[96:99]
    ds_read_b128 a[228:231], v3 offset:19968
    v_mfma_f32_16x16x32_bf16 v[100:103], a[232:235], v[232:235], v[100:103]
    s_bfm_b64 vcc, 16, 48
    v_cndmask_b32 v36, 0, v44, vcc
    v_cndmask_b32 v37, 0, v45, vcc
    v_mfma_f32_16x16x32_bf16 v[104:107], a[232:235], v[236:239], v[104:107]
    s_waitcnt lgkmcnt(4)
    ds_read_b128 a[232:235], v3 offset:20992
    v_mfma_f32_16x16x32_bf16 v[108:111], a[236:239], v[232:235], v[108:111]
    v_mfma_f32_16x16x32_bf16 v[112:115], a[236:239], v[236:239], v[112:115]
    ds_read_b128 a[236:239], v13 offset:48640
    v_mfma_f32_16x16x32_bf16 v[108:111], a[248:251], v[30:33], v[108:111]
    v_mfma_f32_16x16x32_bf16 v[112:115], a[248:251], v[34:37], v[112:115]
    v_mfma_f32_16x16x32_bf16 v[92:95], a[240:243], v[240:243], v[92:95]
    buffer_load_dwordx4 v1, s[4:7], s44 offen offset:2048 sc1 lds
    v_mfma_f32_16x16x32_bf16 v[96:99], a[240:243], v[244:247], v[96:99]
    s_waitcnt lgkmcnt(3)
    v_mfma_f32_16x16x32_bf16 v[100:103], a[244:247], v[240:243], v[100:103]
    v_mfma_f32_16x16x32_bf16 v[104:107], a[244:247], v[244:247], v[104:107]
    v_mfma_f32_16x16x32_bf16 v[108:111], a[224:227], v[240:243], v[108:111]
    v_mfma_f32_16x16x32_bf16 v[112:115], a[224:227], v[244:247], v[112:115]
    s_waitcnt lgkmcnt(1)
    v_mfma_f32_16x16x32_bf16 v[92:95], a[228:231], v[248:251], v[92:95]
    v_mfma_f32_16x16x32_bf16 v[96:99], a[228:231], v[252:255], v[96:99]
    v_mfma_f32_16x16x32_bf16 v[100:103], a[232:235], v[248:251], v[100:103]
    buffer_load_dwordx4 v1, s[4:7], s44 offen offset:3072 sc1 lds
    v_mov_b32 v50, 2
    s_waitcnt vmcnt(10)
    s_mov_b64 exec, 1
    buffer_store_dword v50, v0, s[4:7], s73 offen offset:0 sc1
    s_mov_b64 exec, -1
    v_mfma_f32_16x16x32_bf16 v[104:107], a[232:235], v[252:255], v[104:107]
    s_waitcnt lgkmcnt(0)
    v_mfma_f32_16x16x32_bf16 v[108:111], a[236:239], v[248:251], v[108:111]
    v_mfma_f32_16x16x32_bf16 v[112:115], a[236:239], v[252:255], v[112:115]
    s_add_u32 s43, s91, 0
    buffer_load_dwordx4 v[156:159], v1, s[4:7], s43 offen offset:0 sc1
    buffer_load_dwordx4 v[160:163], v1, s[4:7], s43 offen offset:1024 sc1
    buffer_load_dwordx4 v[164:167], v1, s[4:7], s43 offen offset:2048 sc1
L_p2_0:
    v_and_b32 v46, 3, v0
    v_bfe_u32 v47, v0, 4, 1
    v_cmp_ne_u32 vcc, 0, v47
    v_lshrrev_b32 v48, 1, v46
    v_bfe_u32 v47, v0, 2, 2
    v_cndmask_b32 v48, v48, 2, vcc
    v_lshrrev_b32 v8, 5, v0
    v_lshl_add_u32 v47, v8, 2, v47
    v_lshlrev_b32 v8, 2, v48
    v_xor_b32 v47, v47, v8
    v_lshlrev_b32 v47, 4, v47
    v_lshl_add_u32 v47, v48, 9, v47
    v_and_b32 v48, 1, v46
    v_min_u32 v8, 1, v46
    v_cndmask_b32 v8, v48, v8, vcc
    v_xor_b32 v10, 1, v46
    v_min_u32 v10, 1, v10
    v_cndmask_b32 v10, v48, v10, vcc
    v_lshl_add_u32 v8, v8, 3, v47
    v_lshl_add_u32 v10, v10, 3, v47
    v_xor_b32 v9, 0x80, v8
    v_xor_b32 v11, 0x80, v10
    v_add_u32 v8, s79, v8
    v_add_u32 v9, s79, v9
    v_add_u32 v10, s95, v10
    v_add_u32 v11, s95, v11
    v_pk_mul_f32 v[92:93], v[92:93], v[38:39] op_sel:[0,0] op_sel_hi:[1,0]
    v_pk_mul_f32 v[94:95], v[94:95], v[38:39] op_sel:[0,0] op_sel_hi:[1,0]
    v_cvt_pk_bf16_f32 v26, v92, v93
    v_cvt_pk_bf16_f32 v27, v94, v95
    v_pk_mul_f32 v[96:97], v[96:97], v[38:39] op_sel:[0,1] op_sel_hi:[1,1]
    v_pk_mul_f32 v[98:99], v[98:99], v[38:39] op_sel:[0,1] op_sel_hi:[1,1]
    v_cvt_pk_bf16_f32 v28, v96, v97
    v_cvt_pk_bf16_f32 v29, v98, v99
    v_pk_mul_f32 v[108:109], v[108:109], v[38:39] op_sel:[0,0] op_sel_hi:[1,0]
    v_pk_mul_f32 v[110:111], v[110:111], v[38:39] op_sel:[0,0] op_sel_hi:[1,0]
    v_cvt_pk_bf16_f32 v30, v108, v109
    v_cvt_pk_bf16_f32 v31, v110, v111
    v_pk_mul_f32 v[112:113], v[112:113], v[38:39] op_sel:[0,1] op_sel_hi:[1,1]
    v_pk_mul_f32 v[114:115], v[114:115], v[38:39] op_sel:[0,1] op_sel_hi:[1,1]
    v_cvt_pk_bf16_f32 v32, v112, v113
    v_cvt_pk_bf16_f32 v33, v114, v115
    v_permlane16_swap_b32 v26, v28
    v_permlane16_swap_b32 v27, v29
    v_pk_mul_f32 v[100:101], v[100:101], v[38:39] op_sel:[0,0] op_sel_hi:[1,0]
    v_pk_mul_f32 v[102:103], v[102:103], v[38:39] op_sel:[0,0] op_sel_hi:[1,0]
    v_cvt_pk_bf16_f32 v34, v100, v101
    v_cvt_pk_bf16_f32 v35, v102, v103
    v_pk_mul_f32 v[104:105], v[104:105], v[38:39] op_sel:[0,1] op_sel_hi:[1,1]
    v_pk_mul_f32 v[106:107], v[106:107], v[38:39] op_sel:[0,1] op_sel_hi:[1,1]
    v_cvt_pk_bf16_f32 v36, v104, v105
    v_cvt_pk_bf16_f32 v37, v106, v107
    v_permlane16_swap_b32 v30, v32
    v_permlane16_swap_b32 v31, v33
    v_permlane16_swap_b32 v34, v36
    v_permlane16_swap_b32 v35, v37
    v_cndmask_b32 v32, 0, v30, s[48:49]
    v_cndmask_b32 v33, 0, v31, s[48:49]
    v_cndmask_b32 v30, v30, 0, s[48:49]
    v_cndmask_b32 v31, v31, 0, s[48:49]
    s_waitcnt vmcnt(8)
    v_cmp_gt_u32 vcc, 1, v140
    s_nop 0
    s_cbranch_vccz L_ka0ed
L_ka0:
    s_mov_b32 s45, 200000
L_ka0_b:
    buffer_load_dword v140, v49, s[4:7], 0 offen sc1
    s_sub_u32 s45, s45, 1
    s_cbranch_scc1 L_ka0_c
    s_waitcnt vmcnt(0)
    v_cmp_gt_u32 vcc, 1, v140
    s_nop 0
    s_cbranch_vccnz L_ka0_b
L_ka0_c:
    s_waitcnt vmcnt(0)
    s_branch L_ka0ed
L_ka0ed:
    s_add_u32 m0, s79, 12288
    s_add_u32 s42, s93, 4294955008
    buffer_load_dwordx4 v40, s[4:7], s42 offen offset:0 sc1 lds
    buffer_load_dwordx4 v40, s[4:7], s42 offen offset:1024 sc1 lds
    buffer_load_dwordx4 v40, s[4:7], s42 offen offset:2048 sc1 lds
    s_add_u32 m0, s79, 0
    s_add_u32 s42, s93, 4294942720
    buffer_load_dwordx4 v41, s[4:7], s42 offen offset:0 sc1 lds
    buffer_load_dwordx4 v41, s[4:7], s42 offen offset:1024 sc1 lds
    buffer_load_dwordx4 v41, s[4:7], s42 offen offset:2048 sc1 lds
    s_cmp_ge_u32 s3, 2
    s_cselect_b32 s38, s38, s39
    v_add_u32 v40, s38, v1
    ds_read_b128 a[204:207], v5 offset:24576
    ds_read_b64 a[208:209], v6 offset:27136
    ds_read_b64_tr_b16 a[212:213], v8 offset:25600
    ds_read_b64_tr_b16 a[214:215], v9 offset:25600
    s_waitcnt lgkmcnt(3)
    v_mfma_f32_32x32x16_bf16 v[52:67], a[204:207], v[26:29], v[124:139]
    ds_read_b128 a[204:207], v15 offset:20480
    s_waitcnt lgkmcnt(3)
    v_mfma_f32_32x32x8_bf16 v[52:67], a[208:209], v[30:31], v[52:67]
    v_and_b32 v46, 31, v0
    v_lshrrev_b32 v47, 5, v0
    v_lshrrev_b32 v13, 4, v46
    v_mul_u32_u24 v13, 57344, v13
    v_and_b32 v46, 15, v46
    v_lshl_add_u32 v13, v46, 4, v13
    v_lshl_add_u32 v12, v47, 8, v13
    v_lshl_add_u32 v13, v47, 3, v13
    s_waitcnt lgkmcnt(0)
    v_mfma_f32_32x32x16_bf16 v[68:83], a[204:207], v[34:37], v[124:139]
    s_nop 1
    v_exp_f32 v52, v52
    v_exp_f32 v53, v53
    v_exp_f32 v54, v54
    v_exp_f32 v55, v55
    v_cvt_pk_bf16_f32 v116, v52, v53
    v_cvt_pk_bf16_f32 v117, v54, v55
    v_mfma_f32_32x32x8_bf16 v[68:83], a[208:209], v[32:33], v[68:83]
    v_exp_f32 v56, v56
    v_exp_f32 v57, v57
    v_exp_f32 v58, v58
    v_exp_f32 v59, v59
    v_cvt_pk_bf16_f32 v118, v56, v57
    v_cvt_pk_bf16_f32 v119, v58, v59
    ds_read_b64_tr_b16 a[216:217], v8 offset:25856
    ds_read_b64_tr_b16 a[218:219], v9 offset:25856
    v_exp_f32 v60, v60
    v_exp_f32 v61, v61
    v_exp_f32 v62, v62
    v_exp_f32 v63, v63
    v_cvt_pk_bf16_f32 v120, v60, v61
    v_cvt_pk_bf16_f32 v121, v62, v63
    v_mfma_f32_32x32x16_bf16 v[84:99], a[212:215], v[116:119], 0
    ds_read_b64_tr_b16 a[212:213], v10 offset:21504
    ds_read_b64_tr_b16 a[214:215], v11 offset:21504
    v_exp_f32 v64, v64
    v_exp_f32 v65, v65
    v_exp_f32 v66, v66
    v_exp_f32 v67, v67
    v_cvt_pk_bf16_f32 v122, v64, v65
    v_cvt_pk_bf16_f32 v123, v66, v67
    v_exp_f32 v68, v68
    v_exp_f32 v69, v69
    v_exp_f32 v70, v70
    v_exp_f32 v71, v71
    v_cvt_pk_bf16_f32 v116, v68, v69
    v_cvt_pk_bf16_f32 v117, v70, v71
    v_exp_f32 v72, v72
    v_exp_f32 v73, v73
    v_exp_f32 v74, v74
    v_exp_f32 v75, v75
    v_cvt_pk_bf16_f32 v118, v72, v73
    v_cvt_pk_bf16_f32 v119, v74, v75
    s_waitcnt lgkmcnt(2)
    v_mfma_f32_32x32x16_bf16 v[84:99], a[216:219], v[120:123], v[84:99]
    ds_read_b64_tr_b16 a[216:217], v10 offset:21760
    ds_read_b64_tr_b16 a[218:219], v11 offset:21760
    v_exp_f32 v76, v76
    v_exp_f32 v77, v77
    v_exp_f32 v78, v78
    v_exp_f32 v79, v79
    v_cvt_pk_bf16_f32 v120, v76, v77
    v_cvt_pk_bf16_f32 v121, v78, v79
    s_waitcnt lgkmcnt(2)
    v_mfma_f32_32x32x16_bf16 v[100:115], a[212:215], v[116:119], 0
    v_exp_f32 v80, v80
    v_exp_f32 v81, v81
    v_exp_f32 v82, v82
    v_exp_f32 v83, v83
    v_cvt_pk_bf16_f32 v122, v80, v81
    v_cvt_pk_bf16_f32 v123, v82, v83
    v_xor_b32 v124, s77, v124
    v_xor_b32 v125, s77, v125
    v_xor_b32 v126, s77, v126
    v_xor_b32 v127, s77, v127
    v_xor_b32 v128, s77, v128
    v_xor_b32 v129, s77, v129
    v_xor_b32 v130, s77, v130
    v_xor_b32 v131, s77, v131
    v_xor_b32 v132, s77, v132
    v_xor_b32 v133, s77, v133
    v_xor_b32 v134, s77, v134
    v_xor_b32 v135, s77, v135
    v_xor_b32 v136, s77, v136
    v_xor_b32 v137, s77, v137
    v_xor_b32 v138, s77, v138
    v_xor_b32 v139, s77, v139
    v_bfe_u32 v148, v0, 2, 1
    v_lshlrev_b32 v148, 4, v148
    v_and_or_b32 v148, v0, 3, v148
    v_lshl_add_u32 v148, v148, 7, s85
    v_and_b32 v47, 1, v0
    v_lshl_add_u32 v47, v47, 7, s86
    v_cndmask_b32 v148, v148, v47, s[48:49]
    v_bfe_u32 v47, v0, 3, 1
    v_mul_u32_u24 v47, 57344, v47
    v_add_u32 v148, v148, v47
    v_mov_b32 v47, s63
    v_mul_u32_u24 v149, 48, v47
    v_lshl_add_u32 v47, v47, 2, 32
    v_sub_u32 v47, v47, v149
    v_bfe_i32 v51, v0, 3, 1
    v_and_b32 v47, v47, v51
    v_add_u32 v149, v149, v47
    v_and_b32 v47, 23, v0
    v_add_u32 v149, v149, v47
    v_lshl_add_u32 v149, v149, 7, s82
    v_mov_b32 v47, s84
    v_cndmask_b32 v149, v149, v47, s[48:49]
    s_add_u32 s41, s3, 1
    s_and_b32 s41, s41, 3
    s_mov_b32 s16, s41
    s_mul_i32 s20, s41, 57344
    s_add_u32 s20, s20, s90
    s_add_u32 s41, s3, 2
    s_and_b32 s41, s41, 3
    s_mov_b32 s17, s41
    s_mul_i32 s21, s41, 57344
    s_add_u32 s21, s21, s90
    s_add_u32 s41, s3, 3
    s_and_b32 s41, s41, 3
    s_mov_b32 s18, s41
    s_mul_i32 s22, s41, 57344
    s_add_u32 s22, s22, s90
    s_mul_i32 s23, s3, 57344
    s_add_u32 s23, s23, s90
    v_lshlrev_b32 v48, 2, v0
    v_and_b32 v48, 31, v48
    v_add_u32 v48, s100, v48
    buffer_load_dword v46, v49, s[4:7], 0 offen sc1
    s_waitcnt vmcnt(4)
    s_waitcnt lgkmcnt(0)
    s_barrier
    ds_read_b128 a[204:207], v5 offset:21504
    ds_read_b64 a[208:209], v6 offset:24064
    ds_read_b64_tr_b16 a[212:213], v8 offset:22528
    ds_read_b64_tr_b16 a[214:215], v9 offset:22528
    s_waitcnt lgkmcnt(3)
    v_mfma_f32_32x32x16_bf16 v[52:67], a[204:207], v[26:29], 0
    ds_read_b128 a[204:207], v5 offset:18432
    s_waitcnt lgkmcnt(3)
    v_mfma_f32_32x32x8_bf16 v[52:67], a[208:209], v[30:31], v[52:67]
    ds_read_b64 a[208:209], v6 offset:20992
    s_waitcnt lgkmcnt(1)
    v_mfma_f32_32x32x16_bf16 v[68:83], a[204:207], v[26:29], 0
    ds_read_b128 a[204:207], v5 offset:15360
    s_nop 7
    v_exp_f32 v52, v52
    v_exp_f32 v53, v53
    v_exp_f32 v54, v54
    v_exp_f32 v55, v55
    v_cvt_pk_bf16_f32 v116, v52, v53
    v_cvt_pk_bf16_f32 v117, v54, v55
    s_waitcnt lgkmcnt(1)
    v_mfma_f32_32x32x8_bf16 v[68:83], a[208:209], v[30:31], v[68:83]
    v_exp_f32 v56, v56
    v_exp_f32 v57, v57
    v_exp_f32 v58, v58
    v_exp_f32 v59, v59
    v_cvt_pk_bf16_f32 v118, v56, v57
    v_cvt_pk_bf16_f32 v119, v58, v59
    v_mfma_f32_32x32x16_bf16 v[100:115], a[216:219], v[120:123], v[100:115]
    s_waitcnt lgkmcnt(0)
    ds_read_b64 a[208:209], v6 offset:17920
    ds_read_b64_tr_b16 a[216:217], v8 offset:22784
    ds_read_b64_tr_b16 a[218:219], v9 offset:22784
    s_waitcnt vmcnt(0)
    v_cmp_gt_u32 vcc, 2, v46
    s_nop 0
    s_cbranch_vccnz L_kb0
L_kb0ed:
    s_mul_i32 m0, s3, 5120
    s_add_u32 m0, m0, 133120
    s_add_u32 s42, s96, 4294946816
    buffer_load_dwordx4 v40, s[4:7], s42 offen offset:0 sc1 lds
    buffer_load_dwordx4 v40, s[4:7], s42 offen offset:1024 sc1 lds
    buffer_load_dwordx4 v40, s[4:7], s42 offen offset:2048 sc1 lds
    buffer_load_dwordx4 v40, s[4:7], s42 offen offset:3072 sc1 lds
    s_mul_i32 m0, s3, 5120
    s_add_u32 m0, m0, 137216
    s_add_u32 s42, s96, 4294950912
    buffer_load_dwordx4 v40, s[4:7], s42 offen offset:0 sc1 lds
    v_exp_f32 v60, v60
    v_exp_f32 v61, v61
    v_exp_f32 v62, v62
    v_exp_f32 v63, v63
    v_cvt_pk_bf16_f32 v120, v60, v61
    v_cvt_pk_bf16_f32 v121, v62, v63
    v_mfma_f32_32x32x16_bf16 v[84:99], a[212:215], v[116:119], v[84:99]
    ds_read_b64_tr_b16 a[212:213], v8 offset:19456
    ds_read_b64_tr_b16 a[214:215], v9 offset:19456
    v_exp_f32 v64, v64
    v_exp_f32 v65, v65
    v_exp_f32 v66, v66
    v_exp_f32 v67, v67
    v_cvt_pk_bf16_f32 v122, v64, v65
    v_cvt_pk_bf16_f32 v123, v66, v67
    v_mfma_f32_32x32x16_bf16 v[52:67], a[204:207], v[26:29], 0
    s_waitcnt lgkmcnt(2)
    ds_read_b128 a[204:207], v5 offset:12288
    v_exp_f32 v68, v68
    v_exp_f32 v69, v69
    v_exp_f32 v70, v70
    v_exp_f32 v71, v71
    v_cvt_pk_bf16_f32 v116, v68, v69
    v_cvt_pk_bf16_f32 v117, v70, v71
    v_mfma_f32_32x32x8_bf16 v[52:67], a[208:209], v[30:31], v[52:67]
    v_exp_f32 v72, v72
    v_exp_f32 v73, v73
    v_exp_f32 v74, v74
    v_exp_f32 v75, v75
    v_cvt_pk_bf16_f32 v118, v72, v73
    v_cvt_pk_bf16_f32 v119, v74, v75
    v_mfma_f32_32x32x16_bf16 v[84:99], a[216:219], v[120:123], v[84:99]
    s_waitcnt lgkmcnt(0)
    ds_read_b64 a[208:209], v6 offset:14848
    ds_read_b64_tr_b16 a[216:217], v8 offset:19712
    ds_read_b64_tr_b16 a[218:219], v9 offset:19712
    v_exp_f32 v76, v76
    v_exp_f32 v77, v77
    v_exp_f32 v78, v78
    v_exp_f32 v79, v79
    v_cvt_pk_bf16_f32 v120, v76, v77
    v_cvt_pk_bf16_f32 v121, v78, v79
    v_mfma_f32_32x32x16_bf16 v[84:99], a[212:215], v[116:119], v[84:99]
    ds_read_b64_tr_b16 a[212:213], v8 offset:16384
    ds_read_b64_tr_b16 a[214:215], v9 offset:16384
    v_exp_f32 v80, v80
    v_exp_f32 v81, v81
    v_exp_f32 v82, v82
    v_exp_f32 v83, v83
    v_cvt_pk_bf16_f32 v122, v80, v81
    v_cvt_pk_bf16_f32 v123, v82, v83
    v_mfma_f32_32x32x16_bf16 v[68:83], a[204:207], v[26:29], 0
    s_waitcnt lgkmcnt(2)
    v_exp_f32 v52, v52
    v_exp_f32 v53, v53
    v_exp_f32 v54, v54
    v_exp_f32 v55, v55
    v_cvt_pk_bf16_f32 v116, v52, v53
    v_cvt_pk_bf16_f32 v117, v54, v55
    v_mfma_f32_32x32x8_bf16 v[68:83], a[208:209], v[30:31], v[68:83]
    v_exp_f32 v56, v56
    v_exp_f32 v57, v57
    v_exp_f32 v58, v58
    v_exp_f32 v59, v59
    v_cvt_pk_bf16_f32 v118, v56, v57
    v_cvt_pk_bf16_f32 v119, v58, v59
    v_mfma_f32_32x32x16_bf16 v[84:99], a[216:219], v[120:123], v[84:99]
    s_barrier
    ds_read_b128 a[204:207], v5 offset:9216
    ds_read_b64 a[208:209], v6 offset:11776
    ds_read_b64_tr_b16 a[216:217], v8 offset:16640
    ds_read_b64_tr_b16 a[218:219], v9 offset:16640
    v_exp_f32 v60, v60
    v_exp_f32 v61, v61
    v_exp_f32 v62, v62
    v_exp_f32 v63, v63
    v_cvt_pk_bf16_f32 v120, v60, v61
    v_cvt_pk_bf16_f32 v121, v62, v63
    s_waitcnt lgkmcnt(4)
    v_mfma_f32_32x32x16_bf16 v[84:99], a[212:215], v[116:119], v[84:99]
    ds_read_b64_tr_b16 a[212:213], v8 offset:13312
    ds_read_b64_tr_b16 a[214:215], v9 offset:13312
    s_add_u32 s43, s91, 0
    buffer_load_dwordx4 v[168:171], v1, s[4:7], s43 offen offset:3072 sc1
    v_exp_f32 v64, v64
    v_exp_f32 v65, v65
    v_exp_f32 v66, v66
    v_exp_f32 v67, v67
    v_cvt_pk_bf16_f32 v122, v64, v65
    v_cvt_pk_bf16_f32 v123, v66, v67
    s_waitcnt lgkmcnt(5)
    v_mfma_f32_32x32x16_bf16 v[52:67], a[204:207], v[26:29], 0
    s_waitcnt lgkmcnt(2)
    ds_read_b128 a[204:207], v5 offset:6144
    s_add_u32 s43, s91, 4096
    buffer_load_dwordx4 v[172:175], v1, s[4:7], s43 offen offset:0 sc1
    v_exp_f32 v68, v68
    v_exp_f32 v69, v69
    v_exp_f32 v70, v70
    v_exp_f32 v71, v71
    v_cvt_pk_bf16_f32 v116, v68, v69
    v_cvt_pk_bf16_f32 v117, v70, v71
    v_mfma_f32_32x32x8_bf16 v[52:67], a[208:209], v[30:31], v[52:67]
    v_exp_f32 v72, v72
    v_exp_f32 v73, v73
    v_exp_f32 v74, v74
    v_exp_f32 v75, v75
    v_cvt_pk_bf16_f32 v118, v72, v73
    v_cvt_pk_bf16_f32 v119, v74, v75
    v_mfma_f32_32x32x16_bf16 v[84:99], a[216:219], v[120:123], v[84:99]
    s_waitcnt lgkmcnt(0)
    ds_read_b64 a[208:209], v6 offset:8704
    ds_read_b64_tr_b16 a[216:217], v8 offset:13568
    ds_read_b64_tr_b16 a[218:219], v9 offset:13568
    v_exp_f32 v76, v76
    v_exp_f32 v77, v77
    v_exp_f32 v78, v78
    v_exp_f32 v79, v79
    v_cvt_pk_bf16_f32 v120, v76, v77
    v_cvt_pk_bf16_f32 v121, v78, v79
    v_mfma_f32_32x32x16_bf16 v[84:99], a[212:215], v[116:119], v[84:99]
    ds_read_b64_tr_b16 a[212:213], v8 offset:10240
    ds_read_b64_tr_b16 a[214:215], v9 offset:10240
    buffer_load_dwordx4 v[176:179], v1, s[4:7], s43 offen offset:1024 sc1
    buffer_load_dwordx4 v[180:183], v1, s[4:7], s43 offen offset:2048 sc1
    v_exp_f32 v80, v80
    v_exp_f32 v81, v81
    v_exp_f32 v82, v82
    v_exp_f32 v83, v83
    v_cvt_pk_bf16_f32 v122, v80, v81
    v_cvt_pk_bf16_f32 v123, v82, v83
    v_mfma_f32_32x32x16_bf16 v[68:83], a[204:207], v[26:29], 0
    s_waitcnt lgkmcnt(2)
    ds_read_b128 a[204:207], v5 offset:3072
    buffer_load_dwordx4 v[184:187], v1, s[4:7], s43 offen offset:3072 sc1
    v_exp_f32 v52, v52
    v_exp_f32 v53, v53
    v_exp_f32 v54, v54
    v_exp_f32 v55, v55
    v_cvt_pk_bf16_f32 v116, v52, v53
    v_cvt_pk_bf16_f32 v117, v54, v55
    v_mfma_f32_32x32x8_bf16 v[68:83], a[208:209], v[30:31], v[68:83]
    v_exp_f32 v56, v56
    v_exp_f32 v57, v57
    v_exp_f32 v58, v58
    v_exp_f32 v59, v59
    v_cvt_pk_bf16_f32 v118, v56, v57
    v_cvt_pk_bf16_f32 v119, v58, v59
    v_mfma_f32_32x32x16_bf16 v[84:99], a[216:219], v[120:123], v[84:99]
    s_waitcnt lgkmcnt(0)
    ds_read_b64 a[208:209], v6 offset:5632
    ds_read_b64_tr_b16 a[216:217], v8 offset:10496
    ds_read_b64_tr_b16 a[218:219], v9 offset:10496
    v_exp_f32 v60, v60
    v_exp_f32 v61, v61
    v_exp_f32 v62, v62
    v_exp_f32 v63, v63
    v_cvt_pk_bf16_f32 v120, v60, v61
    v_cvt_pk_bf16_f32 v121, v62, v63
    v_mfma_f32_32x32x16_bf16 v[84:99], a[212:215], v[116:119], v[84:99]
    ds_read_b64_tr_b16 a[212:213], v8 offset:7168
    ds_read_b64_tr_b16 a[214:215], v9 offset:7168
    s_add_u32 s43, s91, 8192
    buffer_load_dwordx4 v[188:191], v1, s[4:7], s43 offen offset:0 sc1
    v_exp_f32 v64, v64
    v_exp_f32 v65, v65
    v_exp_f32 v66, v66
    v_exp_f32 v67, v67
    v_cvt_pk_bf16_f32 v122, v64, v65
    v_cvt_pk_bf16_f32 v123, v66, v67
    v_mfma_f32_32x32x16_bf16 v[52:67], a[204:207], v[26:29], 0
    s_waitcnt lgkmcnt(2)
    ds_read_b128 a[204:207], v5 offset:0
    buffer_load_dwordx4 v[192:195], v1, s[4:7], s43 offen offset:1024 sc1
    buffer_load_dwordx4 v[196:199], v1, s[4:7], s43 offen offset:2048 sc1
    v_exp_f32 v68, v68
    v_exp_f32 v69, v69
    v_exp_f32 v70, v70
    v_exp_f32 v71, v71
    v_cvt_pk_bf16_f32 v116, v68, v69
    v_cvt_pk_bf16_f32 v117, v70, v71
    v_mfma_f32_32x32x8_bf16 v[52:67], a[208:209], v[30:31], v[52:67]
    v_exp_f32 v72, v72
    v_exp_f32 v73, v73
    v_exp_f32 v74, v74
    v_exp_f32 v75, v75
    v_cvt_pk_bf16_f32 v118, v72, v73
    v_cvt_pk_bf16_f32 v119, v74, v75
    v_mfma_f32_32x32x16_bf16 v[84:99], a[216:219], v[120:123], v[84:99]
    s_waitcnt lgkmcnt(0)
    ds_read_b64 a[208:209], v6 offset:2560
    ds_read_b64_tr_b16 a[216:217], v8 offset:7424
    ds_read_b64_tr_b16 a[218:219], v9 offset:7424
    v_exp_f32 v76, v76
    v_exp_f32 v77, v77
    v_exp_f32 v78, v78
    v_exp_f32 v79, v79
    v_cvt_pk_bf16_f32 v120, v76, v77
    v_cvt_pk_bf16_f32 v121, v78, v79
    v_mfma_f32_32x32x16_bf16 v[84:99], a[212:215], v[116:119], v[84:99]
    ds_read_b64_tr_b16 a[212:213], v8 offset:4096
    ds_read_b64_tr_b16 a[214:215], v9 offset:4096
    buffer_load_dwordx4 v[200:203], v1, s[4:7], s43 offen offset:3072 sc1
    v_exp_f32 v80, v80
    v_exp_f32 v81, v81
    v_exp_f32 v82, v82
    v_exp_f32 v83, v83
    v_cvt_pk_bf16_f32 v122, v80, v81
    v_cvt_pk_bf16_f32 v123, v82, v83
    v_mfma_f32_32x32x16_bf16 v[68:83], a[204:207], v[26:29], v[124:139]
    s_waitcnt lgkmcnt(2)
    s_mov_b32 exec_lo, 0xffff
    s_mov_b32 exec_hi, 0x303
    buffer_load_dword v51, v148, s[4:7], 0 offen sc1
    s_mov_b64 exec, -1
    v_exp_f32 v52, v52
    v_exp_f32 v53, v53
    v_exp_f32 v54, v54
    v_exp_f32 v55, v55
    v_cvt_pk_bf16_f32 v116, v52, v53
    v_cvt_pk_bf16_f32 v117, v54, v55
    v_mfma_f32_32x32x8_bf16 v[68:83], a[208:209], v[30:31], v[68:83]
    v_exp_f32 v56, v56
    v_exp_f32 v57, v57
    v_exp_f32 v58, v58
    v_exp_f32 v59, v59
    v_cvt_pk_bf16_f32 v118, v56, v57
    v_cvt_pk_bf16_f32 v119, v58, v59
    v_mfma_f32_32x32x16_bf16 v[84:99], a[216:219], v[120:123], v[84:99]
    s_waitcnt vmcnt(10)
    s_barrier
    ds_read_b128 a[204:207], v15 offset:17920
    ds_read_b64 a[208:209], v6 offset:24064
    ds_read_b64_tr_b16 a[216:217], v8 offset:4352
    ds_read_b64_tr_b16 a[218:219], v9 offset:4352
    v_exp_f32 v60, v60
    v_exp_f32 v61, v61
    v_exp_f32 v62, v62
    v_exp_f32 v63, v63
    v_cvt_pk_bf16_f32 v120, v60, v61
    v_cvt_pk_bf16_f32 v121, v62, v63
    s_waitcnt lgkmcnt(4)
    v_mfma_f32_32x32x16_bf16 v[84:99], a[212:215], v[116:119], v[84:99]
    ds_read_b64_tr_b16 a[212:213], v8 offset:1024
    ds_read_b64_tr_b16 a[214:215], v9 offset:1024
    s_mov_b32 exec_lo, 0xff0fff
    s_mov_b32 exec_hi, 1
    buffer_load_dword v51, v149, s[4:7], 0 offen sc1
    s_mov_b64 exec, -1
    s_add_u32 s43, s91, 12288
    buffer_load_dwordx4 v[204:207], v1, s[4:7], s43 offen offset:0 sc1
    v_exp_f32 v64, v64
    v_exp_f32 v65, v65
    v_exp_f32 v66, v66
    v_exp_f32 v67, v67
    v_cvt_pk_bf16_f32 v122, v64, v65
    v_cvt_pk_bf16_f32 v123, v66, v67
    s_waitcnt lgkmcnt(5)
    v_mfma_f32_32x32x16_bf16 v[52:67], a[204:207], v[34:37], 0
    s_waitcnt lgkmcnt(2)
    ds_read_b128 a[204:207], v15 offset:15360
    buffer_load_dwordx4 v[208:211], v1, s[4:7], s43 offen offset:1024 sc1
    v_exp_f32 v68, v68
    v_exp_f32 v69, v69
    v_exp_f32 v70, v70
    v_exp_f32 v71, v71
    v_cvt_pk_bf16_f32 v116, v68, v69
    v_cvt_pk_bf16_f32 v117, v70, v71
    v_mfma_f32_32x32x8_bf16 v[52:67], a[208:209], v[32:33], v[52:67]
    v_exp_f32 v72, v72
    v_exp_f32 v73, v73
    v_exp_f32 v74, v74
    v_exp_f32 v75, v75
    v_cvt_pk_bf16_f32 v118, v72, v73
    v_cvt_pk_bf16_f32 v119, v74, v75
    v_mfma_f32_32x32x16_bf16 v[84:99], a[216:219], v[120:123], v[84:99]
    s_waitcnt lgkmcnt(0)
    ds_read_b64 a[208:209], v6 offset:20992
    ds_read_b64_tr_b16 a[216:217], v8 offset:1280
    ds_read_b64_tr_b16 a[218:219], v9 offset:1280
    v_exp_f32 v76, v76
    v_exp_f32 v77, v77
    v_exp_f32 v78, v78
    v_exp_f32 v79, v79
    v_cvt_pk_bf16_f32 v120, v76, v77
    v_cvt_pk_bf16_f32 v121, v78, v79
    v_mfma_f32_32x32x16_bf16 v[84:99], a[212:215], v[116:119], v[84:99]
    ds_read_b64_tr_b16 a[212:213], v10 offset:18944
    ds_read_b64_tr_b16 a[214:215], v11 offset:18944
    buffer_load_dwordx4 v[212:215], v1, s[4:7], s43 offen offset:2048 sc1
    v_exp_f32 v80, v80
    v_exp_f32 v81, v81
    v_exp_f32 v82, v82
    v_exp_f32 v83, v83
    v_cvt_pk_bf16_f32 v122, v80, v81
    v_cvt_pk_bf16_f32 v123, v82, v83
    v_mfma_f32_32x32x16_bf16 v[68:83], a[204:207], v[34:37], 0
    s_waitcnt lgkmcnt(2)
    ds_read_b128 a[204:207], v15 offset:12800
    buffer_load_dwordx4 v[216:219], v1, s[4:7], s43 offen offset:3072 sc1
    s_add_u32 s43, s91, 16384
    buffer_load_dwordx4 v[220:223], v1, s[4:7], s43 offen offset:0 sc1
    v_exp_f32 v52, v52
    v_exp_f32 v53, v53
    v_exp_f32 v54, v54
    v_exp_f32 v55, v55
    v_cvt_pk_bf16_f32 v116, v52, v53
    v_cvt_pk_bf16_f32 v117, v54, v55
    v_mfma_f32_32x32x8_bf16 v[68:83], a[208:209], v[32:33], v[68:83]
    v_exp_f32 v56, v56
    v_exp_f32 v57, v57
    v_exp_f32 v58, v58
    v_exp_f32 v59, v59
    v_cvt_pk_bf16_f32 v118, v56, v57
    v_cvt_pk_bf16_f32 v119, v58, v59
    v_mfma_f32_32x32x16_bf16 v[84:99], a[216:219], v[120:123], v[84:99]
    s_waitcnt lgkmcnt(0)
    ds_read_b64 a[208:209], v6 offset:17920
    ds_read_b64_tr_b16 a[216:217], v10 offset:19200
    ds_read_b64_tr_b16 a[218:219], v11 offset:19200
    v_exp_f32 v60, v60
    v_exp_f32 v61, v61
    v_exp_f32 v62, v62
    v_exp_f32 v63, v63
    v_cvt_pk_bf16_f32 v120, v60, v61
    v_cvt_pk_bf16_f32 v121, v62, v63
    v_mfma_f32_32x32x16_bf16 v[100:115], a[212:215], v[116:119], v[100:115]
    ds_read_b64_tr_b16 a[212:213], v10 offset:16384
    ds_read_b64_tr_b16 a[214:215], v11 offset:16384
    buffer_load_dwordx4 v[224:227], v1, s[4:7], s43 offen offset:1024 sc1
    v_exp_f32 v64, v64
    v_exp_f32 v65, v65
    v_exp_f32 v66, v66
    v_exp_f32 v67, v67
    v_cvt_pk_bf16_f32 v122, v64, v65
    v_cvt_pk_bf16_f32 v123, v66, v67
    s_mov_b32 s34, 671088640
    v_subrev_u32 v46, 729808896, v96
    v_cmp_lt_u32 vcc, s34, v46
    s_nop 0
    s_cmp_eq_u64 vcc, 0
    s_cselect_b32 s55, -1, 0
    v_rcp_f32 v44, v96
    s_nop 0
    v_mul_f32 v84, v44, v84
    v_mul_f32 v85, v44, v85
    v_mul_f32 v86, v44, v86
    v_mul_f32 v87, v44, v87
    v_mul_f32 v88, v44, v88
    v_mul_f32 v89, v44, v89
    v_mul_f32 v90, v44, v90
    v_mul_f32 v91, v44, v91
    v_mul_f32 v92, v44, v92
    v_mul_f32 v93, v44, v93
    v_mul_f32 v94, v44, v94
    v_mul_f32 v95, v44, v95
    v_cvt_pk_bf16_f32 v142, v84, v85
    v_cvt_pk_bf16_f32 v143, v86, v87
    v_cvt_pk_bf16_f32 v144, v88, v89
    v_cvt_pk_bf16_f32 v145, v90, v91
    v_cvt_pk_bf16_f32 v146, v92, v93
    v_cvt_pk_bf16_f32 v147, v94, v95
    v_mfma_f32_32x32x16_bf16 v[52:67], a[204:207], v[34:37], 0
    s_waitcnt lgkmcnt(2)
    ds_read_b128 a[204:207], v15 offset:10240
    s_mov_b32 exec_lo, s55
    s_mov_b32 exec_hi, s55
    s_cmp_lg_u32 s50, 0
    s_cbranch_scc1 L_wt_1
    buffer_store_dwordx4 v[142:145], v12, s[4:7], s85 offen
L_bk_2:
    s_mov_b64 exec, -1
    buffer_load_dwordx4 v[228:231], v1, s[4:7], s43 offen offset:2048 sc1
    v_exp_f32 v68, v68
    v_exp_f32 v69, v69
    v_exp_f32 v70, v70
    v_exp_f32 v71, v71
    v_cvt_pk_bf16_f32 v116, v68, v69
    v_cvt_pk_bf16_f32 v117, v70, v71
    v_mfma_f32_32x32x8_bf16 v[52:67], a[208:209], v[32:33], v[52:67]
    v_exp_f32 v72, v72
    v_exp_f32 v73, v73
    v_exp_f32 v74, v74
    v_exp_f32 v75, v75
    v_cvt_pk_bf16_f32 v118, v72, v73
    v_cvt_pk_bf16_f32 v119, v74, v75
    v_mfma_f32_32x32x16_bf16 v[100:115], a[216:219], v[120:123], v[100:115]
    s_waitcnt lgkmcnt(0)
    ds_read_b64 a[208:209], v6 offset:14848
    ds_read_b64_tr_b16 a[216:217], v10 offset:16640
    ds_read_b64_tr_b16 a[218:219], v11 offset:16640
    v_exp_f32 v76, v76
    v_exp_f32 v77, v77
    v_exp_f32 v78, v78
    v_exp_f32 v79, v79
    v_cvt_pk_bf16_f32 v120, v76, v77
    v_cvt_pk_bf16_f32 v121, v78, v79
    v_mfma_f32_32x32x16_bf16 v[100:115], a[212:215], v[116:119], v[100:115]
    ds_read_b64_tr_b16 a[212:213], v10 offset:13824
    ds_read_b64_tr_b16 a[214:215], v11 offset:13824
    s_mul_i32 s40, s3, 2048
    s_add_u32 s40, s40, s72
    s_add_u32 s40, s40, 131072
    buffer_load_dwordx2 a[196:197], v14, s[4:7], s40 offen offset:0 sc1
    buffer_load_dwordx2 a[198:199], v14, s[4:7], s40 offen offset:512 sc1
    v_exp_f32 v80, v80
    v_exp_f32 v81, v81
    v_exp_f32 v82, v82
    v_exp_f32 v83, v83
    v_cvt_pk_bf16_f32 v122, v80, v81
    v_cvt_pk_bf16_f32 v123, v82, v83
    v_mfma_f32_32x32x16_bf16 v[68:83], a[204:207], v[34:37], 0
    s_waitcnt lgkmcnt(2)
    ds_read_b128 a[204:207], v15 offset:7680
    buffer_load_dwordx2 a[200:201], v14, s[4:7], s40 offen offset:1024 sc1
    v_exp_f32 v52, v52
    v_exp_f32 v53, v53
    v_exp_f32 v54, v54
    v_exp_f32 v55, v55
    v_cvt_pk_bf16_f32 v116, v52, v53
    v_cvt_pk_bf16_f32 v117, v54, v55
    v_mfma_f32_32x32x8_bf16 v[68:83], a[208:209], v[32:33], v[68:83]
    v_exp_f32 v56, v56
    v_exp_f32 v57, v57
    v_exp_f32 v58, v58
    v_exp_f32 v59, v59
    v_cvt_pk_bf16_f32 v118, v56, v57
    v_cvt_pk_bf16_f32 v119, v58, v59
    v_mfma_f32_32x32x16_bf16 v[100:115], a[216:219], v[120:123], v[100:115]
    s_waitcnt lgkmcnt(0)
    ds_read_b64 a[208:209], v6 offset:11776
    ds_read_b64_tr_b16 a[216:217], v10 offset:14080
    ds_read_b64_tr_b16 a[218:219], v11 offset:14080
    v_exp_f32 v60, v60
    v_exp_f32 v61, v61
    v_exp_f32 v62, v62
    v_exp_f32 v63, v63
    v_cvt_pk_bf16_f32 v120, v60, v61
    v_cvt_pk_bf16_f32 v121, v62, v63
    v_mfma_f32_32x32x16_bf16 v[100:115], a[212:215], v[116:119], v[100:115]
    ds_read_b64_tr_b16 a[212:213], v10 offset:11264
    ds_read_b64_tr_b16 a[214:215], v11 offset:11264
    buffer_load_dwordx2 a[202:203], v14, s[4:7], s40 offen offset:1536 sc1
    v_exp_f32 v64, v64
    v_exp_f32 v65, v65
    v_exp_f32 v66, v66
    v_exp_f32 v67, v67
    v_cvt_pk_bf16_f32 v122, v64, v65
    v_cvt_pk_bf16_f32 v123, v66, v67
    v_mfma_f32_32x32x16_bf16 v[52:67], a[204:207], v[34:37], 0
    s_waitcnt lgkmcnt(2)
    ds_read_b128 a[204:207], v15 offset:5120
    s_add_u32 m0, s74, 49152
    s_add_u32 s44, s52, 49152
    buffer_load_dwordx4 v1, s[4:7], s44 offen offset:0 sc1 lds
    buffer_load_dwordx4 v1, s[4:7], s44 offen offset:1024 sc1 lds
    v_exp_f32 v68, v68
    v_exp_f32 v69, v69
    v_exp_f32 v70, v70
    v_exp_f32 v71, v71
    v_cvt_pk_bf16_f32 v116, v68, v69
    v_cvt_pk_bf16_f32 v117, v70, v71
    v_mfma_f32_32x32x8_bf16 v[52:67], a[208:209], v[32:33], v[52:67]
    v_exp_f32 v72, v72
    v_exp_f32 v73, v73
    v_exp_f32 v74, v74
    v_exp_f32 v75, v75
    v_cvt_pk_bf16_f32 v118, v72, v73
    v_cvt_pk_bf16_f32 v119, v74, v75
    v_mfma_f32_32x32x16_bf16 v[100:115], a[216:219], v[120:123], v[100:115]
    s_waitcnt lgkmcnt(0)
    ds_read_b64 a[208:209], v6 offset:8704
    ds_read_b64_tr_b16 a[216:217], v10 offset:11520
    ds_read_b64_tr_b16 a[218:219], v11 offset:11520
    v_exp_f32 v76, v76
    v_exp_f32 v77, v77
    v_exp_f32 v78, v78
    v_exp_f32 v79, v79
    v_cvt_pk_bf16_f32 v120, v76, v77
    v_cvt_pk_bf16_f32 v121, v78, v79
    v_mfma_f32_32x32x16_bf16 v[100:115], a[212:215], v[116:119], v[100:115]
    ds_read_b64_tr_b16 a[212:213], v10 offset:8704
    ds_read_b64_tr_b16 a[214:215], v11 offset:8704
    s_add_u32 s43, s92, 16384
    buffer_load_dwordx4 a[64:67], v1, s[4:7], s43 offen offset:0 sc1
    v_exp_f32 v80, v80
    v_exp_f32 v81, v81
    v_exp_f32 v82, v82
    v_exp_f32 v83, v83
    v_cvt_pk_bf16_f32 v122, v80, v81
    v_cvt_pk_bf16_f32 v123, v82, v83
    v_mfma_f32_32x32x16_bf16 v[68:83], a[204:207], v[34:37], 0
    s_waitcnt lgkmcnt(2)
    ds_read_b128 a[204:207], v15 offset:2560
    v_mov_b32 v50, 1
    s_waitcnt vmcnt(8)
    s_mov_b32 s46, s55
    s_and_b64 exec, s[46:47], 1
    s_cmp_lg_u32 s50, 0
    s_cbranch_scc1 L_wt_3
    buffer_store_dword v50, v0, s[4:7], s101 offen offset:0
L_bk_4:
    s_mov_b64 exec, -1
    buffer_load_dwordx4 a[68:71], v1, s[4:7], s43 offen offset:1024 sc1
    v_exp_f32 v52, v52
    v_exp_f32 v53, v53
    v_exp_f32 v54, v54
    v_exp_f32 v55, v55
    v_cvt_pk_bf16_f32 v116, v52, v53
    v_cvt_pk_bf16_f32 v117, v54, v55
    v_mfma_f32_32x32x8_bf16 v[68:83], a[208:209], v[32:33], v[68:83]
    v_exp_f32 v56, v56
    v_exp_f32 v57, v57
    v_exp_f32 v58, v58
    v_exp_f32 v59, v59
    v_cvt_pk_bf16_f32 v118, v56, v57
    v_cvt_pk_bf16_f32 v119, v58, v59
    v_mfma_f32_32x32x16_bf16 v[100:115], a[216:219], v[120:123], v[100:115]
    s_waitcnt lgkmcnt(0)
    ds_read_b64 a[208:209], v6 offset:5632
    ds_read_b64_tr_b16 a[216:217], v10 offset:8960
    ds_read_b64_tr_b16 a[218:219], v11 offset:8960
    v_exp_f32 v60, v60
    v_exp_f32 v61, v61
    v_exp_f32 v62, v62
    v_exp_f32 v63, v63
    v_cvt_pk_bf16_f32 v120, v60, v61
    v_cvt_pk_bf16_f32 v121, v62, v63
    v_mfma_f32_32x32x16_bf16 v[100:115], a[212:215], v[116:119], v[100:115]
    ds_read_b64_tr_b16 a[212:213], v10 offset:6144
    ds_read_b64_tr_b16 a[214:215], v11 offset:6144
    buffer_load_dwordx4 a[72:75], v1, s[4:7], s43 offen offset:2048 sc1
    buffer_load_dwordx4 a[76:79], v1, s[4:7], s43 offen offset:3072 sc1
    v_exp_f32 v64, v64
    v_exp_f32 v65, v65
    v_exp_f32 v66, v66
    v_exp_f32 v67, v67
    v_cvt_pk_bf16_f32 v122, v64, v65
    v_cvt_pk_bf16_f32 v123, v66, v67
    v_mfma_f32_32x32x16_bf16 v[52:67], a[204:207], v[34:37], 0
    s_waitcnt lgkmcnt(2)
    ds_read_b128 a[204:207], v15 offset:0
    s_add_u32 s43, s92, 20480
    buffer_load_dwordx4 a[80:83], v1, s[4:7], s43 offen offset:0 sc1
    v_exp_f32 v68, v68
    v_exp_f32 v69, v69
    v_exp_f32 v70, v70
    v_exp_f32 v71, v71
    v_cvt_pk_bf16_f32 v116, v68, v69
    v_cvt_pk_bf16_f32 v117, v70, v71
    v_mfma_f32_32x32x8_bf16 v[52:67], a[208:209], v[32:33], v[52:67]
    v_exp_f32 v72, v72
    v_exp_f32 v73, v73
    v_exp_f32 v74, v74
    v_exp_f32 v75, v75
    v_cvt_pk_bf16_f32 v118, v72, v73
    v_cvt_pk_bf16_f32 v119, v74, v75
    v_mfma_f32_32x32x16_bf16 v[100:115], a[216:219], v[120:123], v[100:115]
    s_waitcnt lgkmcnt(0)
    ds_read_b64 a[208:209], v6 offset:2560
    ds_read_b64_tr_b16 a[216:217], v10 offset:6400
    ds_read_b64_tr_b16 a[218:219], v11 offset:6400
    v_exp_f32 v76, v76
    v_exp_f32 v77, v77
    v_exp_f32 v78, v78
    v_exp_f32 v79, v79
    v_cvt_pk_bf16_f32 v120, v76, v77
    v_cvt_pk_bf16_f32 v121, v78, v79
    v_mfma_f32_32x32x16_bf16 v[100:115], a[212:215], v[116:119], v[100:115]
    ds_read_b64_tr_b16 a[212:213], v10 offset:3584
    ds_read_b64_tr_b16 a[214:215], v11 offset:3584
    buffer_load_dwordx4 a[84:87], v1, s[4:7], s43 offen offset:1024 sc1
    v_exp_f32 v80, v80
    v_exp_f32 v81, v81
    v_exp_f32 v82, v82
    v_exp_f32 v83, v83
    v_cvt_pk_bf16_f32 v122, v80, v81
    v_cvt_pk_bf16_f32 v123, v82, v83
    v_mfma_f32_32x32x16_bf16 v[68:83], a[204:207], v[34:37], v[124:139]
    s_waitcnt lgkmcnt(2)
    buffer_load_dwordx4 a[88:91], v1, s[4:7], s43 offen offset:2048 sc1
    buffer_load_dwordx4 a[92:95], v1, s[4:7], s43 offen offset:3072 sc1
    v_exp_f32 v52, v52
    v_exp_f32 v53, v53
    v_exp_f32 v54, v54
    v_exp_f32 v55, v55
    v_cvt_pk_bf16_f32 v116, v52, v53
    v_cvt_pk_bf16_f32 v117, v54, v55
    v_mfma_f32_32x32x8_bf16 v[68:83], a[208:209], v[32:33], v[68:83]
    v_exp_f32 v56, v56
    v_exp_f32 v57, v57
    v_exp_f32 v58, v58
    v_exp_f32 v59, v59
    v_cvt_pk_bf16_f32 v118, v56, v57
    v_cvt_pk_bf16_f32 v119, v58, v59
    v_mfma_f32_32x32x16_bf16 v[100:115], a[216:219], v[120:123], v[100:115]
    ds_read_b64_tr_b16 a[216:217], v10 offset:3840
    ds_read_b64_tr_b16 a[218:219], v11 offset:3840
    v_exp_f32 v60, v60
    v_exp_f32 v61, v61
    v_exp_f32 v62, v62
    v_exp_f32 v63, v63
    v_cvt_pk_bf16_f32 v120, v60, v61
    v_cvt_pk_bf16_f32 v121, v62, v63
    s_waitcnt lgkmcnt(2)
    v_mfma_f32_32x32x16_bf16 v[100:115], a[212:215], v[116:119], v[100:115]
    ds_read_b64_tr_b16 a[212:213], v10 offset:1024
    ds_read_b64_tr_b16 a[214:215], v11 offset:1024
    buffer_load_dword v47, v48, s[4:7], 0 offen sc1
    v_exp_f32 v64, v64
    v_exp_f32 v65, v65
    v_exp_f32 v66, v66
    v_exp_f32 v67, v67
    v_cvt_pk_bf16_f32 v122, v64, v65
    v_cvt_pk_bf16_f32 v123, v66, v67
    v_exp_f32 v68, v68
    v_exp_f32 v69, v69
    v_exp_f32 v70, v70
    v_exp_f32 v71, v71
    v_cvt_pk_bf16_f32 v116, v68, v69
    v_cvt_pk_bf16_f32 v117, v70, v71
    v_exp_f32 v72, v72
    v_exp_f32 v73, v73
    v_exp_f32 v74, v74
    v_exp_f32 v75, v75
    v_cvt_pk_bf16_f32 v118, v72, v73
    v_cvt_pk_bf16_f32 v119, v74, v75
    s_waitcnt lgkmcnt(2)
    v_mfma_f32_32x32x16_bf16 v[100:115], a[216:219], v[120:123], v[100:115]
    ds_read_b64_tr_b16 a[216:217], v10 offset:1280
    ds_read_b64_tr_b16 a[218:219], v11 offset:1280
    v_exp_f32 v76, v76
    v_exp_f32 v77, v77
    v_exp_f32 v78, v78
    v_exp_f32 v79, v79
    v_cvt_pk_bf16_f32 v120, v76, v77
    v_cvt_pk_bf16_f32 v121, v78, v79
    s_waitcnt lgkmcnt(2)
    v_mfma_f32_32x32x16_bf16 v[100:115], a[212:215], v[116:119], v[100:115]
    v_exp_f32 v80, v80
    v_exp_f32 v81, v81
    v_exp_f32 v82, v82
    v_exp_f32 v83, v83
    v_cvt_pk_bf16_f32 v122, v80, v81
    v_cvt_pk_bf16_f32 v123, v82, v83
    s_waitcnt lgkmcnt(0)
    s_nop 0
    v_mfma_f32_32x32x16_bf16 v[100:115], a[216:219], v[120:123], v[100:115]
    s_mov_b32 s34, 671088640
    s_mov_b32 s40, 0
    s_nop 9
    v_subrev_u32 v46, 729808896, v112
    v_cmp_lt_u32 vcc, s34, v46
    s_nop 0
    s_cmp_eq_u64 vcc, 0
    s_cselect_b32 s34, s55, 0
    s_cmp_eq_u32 s34, 0
    s_cbranch_scc1 L_truemax
L_norm0:
    v_rcp_f32 v44, v112
    s_nop 0
    v_pk_mul_f32 v[100:101], v[100:101], v[44:45] op_sel_hi:[1,0]
    v_pk_mul_f32 v[102:103], v[102:103], v[44:45] op_sel_hi:[1,0]
    v_pk_mul_f32 v[104:105], v[104:105], v[44:45] op_sel_hi:[1,0]
    v_pk_mul_f32 v[106:107], v[106:107], v[44:45] op_sel_hi:[1,0]
    v_pk_mul_f32 v[108:109], v[108:109], v[44:45] op_sel_hi:[1,0]
    v_pk_mul_f32 v[110:111], v[110:111], v[44:45] op_sel_hi:[1,0]
    v_cvt_pk_bf16_f32 v116, v100, v101
    v_cvt_pk_bf16_f32 v117, v102, v103
    v_cvt_pk_bf16_f32 v118, v104, v105
    v_cvt_pk_bf16_f32 v119, v106, v107
    v_cvt_pk_bf16_f32 v120, v108, v109
    v_cvt_pk_bf16_f32 v121, v110, v111
    v_cndmask_b32 v146, v146, v120, s[48:49]
    v_cndmask_b32 v147, v147, v121, s[48:49]
    s_cmp_lg_u32 s50, 0
    s_cbranch_scc1 L_wt_5
    buffer_store_dwordx4 v[116:119], v12, s[4:7], s85 offen offset:2048
    buffer_store_dwordx2 v[146:147], v13, s[4:7], s86 offen
L_bk_6:
    s_waitcnt vmcnt(2)
    v_cmp_gt_u32 vcc, 1, v47
    s_nop 0
    s_cbranch_vccz L_ck_7ed
L_ck_7:
    s_mov_b32 s45, 200000
L_ck_7_b:
    buffer_load_dword v47, v48, s[4:7], 0 offen sc1
    s_sub_u32 s45, s45, 1
    s_cbranch_scc1 L_ck_7_c
    s_waitcnt vmcnt(0)
    v_cmp_gt_u32 vcc, 1, v47
    s_nop 0
    s_cbranch_vccnz L_ck_7_b
L_ck_7_c:
    s_waitcnt vmcnt(0)
    s_branch L_ck_7ed
L_ck_7ed:
    s_add_u32 s42, s20, 0
    buffer_load_dwordx4 a[224:227], v1, s[4:7], s42 offen offset:0 sc1
    buffer_load_dwordx4 a[228:231], v1, s[4:7], s42 offen offset:1024 sc1
    s_add_u32 s42, s21, 0
    buffer_load_dwordx4 a[232:235], v1, s[4:7], s42 offen offset:0 sc1
    buffer_load_dwordx4 a[236:239], v1, s[4:7], s42 offen offset:1024 sc1
    s_add_u32 s42, s22, 0
    buffer_load_dwordx4 a[240:243], v1, s[4:7], s42 offen offset:0 sc1
    buffer_load_dwordx4 a[244:247], v1, s[4:7], s42 offen offset:1024 sc1
L_p3_0:
    s_waitcnt vmcnt(5)
    v_mfma_f32_16x16x32_bf16 v[52:55], v[156:159], a[224:227], 0
    v_mov_b32 v50, 2
    s_mov_b64 exec, 1
    s_cmp_lg_u32 s50, 0
    s_cbranch_scc1 L_wt_8
    buffer_store_dword v50, v0, s[4:7], s101 offen offset:0
L_bk_9:
    s_mov_b64 exec, -1
    v_mfma_f32_16x16x32_bf16 v[56:59], v[160:163], a[224:227], 0
    s_barrier
    v_and_b32 v26, 15, v0
    v_mfma_f32_16x16x32_bf16 v[60:63], v[164:167], a[224:227], 0
    s_add_u32 s43, s91, 16384
    buffer_load_dwordx4 v[232:235], v1, s[4:7], s43 offen offset:3072 sc1
    v_mfma_f32_16x16x32_bf16 v[64:67], v[168:171], a[224:227], 0
    s_add_u32 s43, s91, 20480
    buffer_load_dwordx4 v[236:239], v1, s[4:7], s43 offen offset:0 sc1
    v_mfma_f32_16x16x32_bf16 v[68:71], v[172:175], a[224:227], 0
    buffer_load_dwordx4 v[240:243], v1, s[4:7], s43 offen offset:1024 sc1
    s_waitcnt vmcnt(8)
    v_mfma_f32_16x16x32_bf16 v[52:55], v[176:179], a[228:231], v[52:55]
    buffer_load_dwordx4 v[244:247], v1, s[4:7], s43 offen offset:2048 sc1
    v_mfma_f32_16x16x32_bf16 v[56:59], v[180:183], a[228:231], v[56:59]
    buffer_load_dwordx4 v[248:251], v1, s[4:7], s43 offen offset:3072 sc1
    v_mfma_f32_16x16x32_bf16 v[60:63], v[184:187], a[228:231], v[60:63]
    s_add_u32 s43, s91, 24576
    buffer_load_dwordx4 v[252:255], v1, s[4:7], s43 offen offset:0 sc1
    v_mfma_f32_16x16x32_bf16 v[64:67], v[188:191], a[228:231], v[64:67]
    v_lshrrev_b32 v27, 5, v0
    v_mov_b32 v5, s63
    v_mfma_f32_16x16x32_bf16 v[68:71], v[192:195], a[228:231], v[68:71]
    v_lshl_add_u32 v6, v5, 1, v27
    v_lshlrev_b32 v6, 8, v6
    s_waitcnt vmcnt(10)
    v_mfma_f32_16x16x32_bf16 v[72:75], v[156:159], a[232:235], 0
    v_mul_u32_u24 v5, 6144, v5
    v_add_u32 v5, v5, v1
    v_mfma_f32_16x16x32_bf16 v[76:79], v[160:163], a[232:235], 0
    v_lshl_add_u32 v6, v26, 4, v6
    v_lshlrev_b32 v7, 2, v27
    v_mfma_f32_16x16x32_bf16 v[80:83], v[164:167], a[232:235], 0
    buffer_load_dword v47, v48, s[4:7], 0 offen sc1
    v_mfma_f32_16x16x32_bf16 v[84:87], v[168:171], a[232:235], 0
    v_lshl_add_u32 v7, v26, 3, v7
    v_bfe_u32 v27, v0, 4, 1
    v_mfma_f32_16x16x32_bf16 v[88:91], v[172:175], a[232:235], 0
    v_lshl_add_u32 v6, v27, 3, v6
    v_add_u32 v6, 0x1000, v6
    s_waitcnt vmcnt(10)
    v_mfma_f32_16x16x32_bf16 v[72:75], v[176:179], a[236:239], v[72:75]
    v_and_b32 v11, 7, v0
    v_lshl_add_u32 v12, v11, 7, s89
    v_mfma_f32_16x16x32_bf16 v[76:79], v[180:183], a[236:239], v[76:79]
    v_lshl_add_u32 v11, v11, 7, s88
    v_sub_u32 v12, v12, v11
    v_mfma_f32_16x16x32_bf16 v[80:83], v[184:187], a[236:239], v[80:83]
    v_bfe_i32 v51, v0, 3, 1
    v_and_b32 v12, v12, v51
    v_mfma_f32_16x16x32_bf16 v[84:87], v[188:191], a[236:239], v[84:87]
    v_add_u32 v12, v11, v12
    v_and_b32 v11, 15, v0
    v_mfma_f32_16x16x32_bf16 v[88:91], v[192:195], a[236:239], v[88:91]
    v_lshl_add_u32 v11, v11, 7, s87
    v_cndmask_b32 v11, v11, v12, s[48:49]
    s_waitcnt vmcnt(9)
    v_mfma_f32_16x16x32_bf16 v[92:95], v[156:159], a[240:243], 0
    v_bfe_u32 v12, v0, 4, 1
    v_mul_u32_u24 v12, 57344, v12
    v_mfma_f32_16x16x32_bf16 v[96:99], v[160:163], a[240:243], 0
    v_add_u32 v11, v11, v12
    v_mfma_f32_16x16x32_bf16 v[100:103], v[164:167], a[240:243], 0
    v_mov_b32 v9, s3
    v_mul_u32_u24 v9, 15360, v9
    v_mfma_f32_16x16x32_bf16 v[104:107], v[168:171], a[240:243], 0
    v_add_u32 v9, 102400, v9
    v_add_u32 v9, v9, v1
    v_mfma_f32_16x16x32_bf16 v[108:111], v[172:175], a[240:243], 0
    v_accvgpr_read_b32 v152, a196
    v_accvgpr_read_b32 v153, a197
    v_accvgpr_read_b32 v154, a198
    v_accvgpr_read_b32 v155, a199
    v_add_f32 v152, v152, v154
    v_add_f32 v153, v153, v155
    v_accvgpr_read_b32 v154, a200
    v_accvgpr_read_b32 v155, a201
    v_add_f32 v152, v152, v154
    v_add_f32 v153, v153, v155
    v_accvgpr_read_b32 v154, a202
    v_accvgpr_read_b32 v155, a203
    v_add_f32 v152, v152, v154
    v_add_f32 v153, v153, v155
    v_lshl_add_u32 v154, s3, 9, v14
    v_add_u32 v154, 98304, v154
    ds_write_b64 v154, v[152:153]
    v_lshlrev_b32 v26, 16, v16
    v_and_b32 v27, 0xffff0000, v16
    s_waitcnt vmcnt(8)
    v_mfma_f32_16x16x32_bf16 v[92:95], v[176:179], a[244:247], v[92:95]
    s_waitcnt vmcnt(0)
    v_cmp_gt_u32 vcc, 2, v47
    s_nop 0
    s_cbranch_vccz L_ck_10ed
L_ck_10:
    s_mov_b32 s45, 200000
L_ck_10_b:
    buffer_load_dword v47, v48, s[4:7], 0 offen sc1
    s_sub_u32 s45, s45, 1
    s_cbranch_scc1 L_ck_10_c
    s_waitcnt vmcnt(0)
    v_cmp_gt_u32 vcc, 2, v47
    s_nop 0
    s_cbranch_vccnz L_ck_10_b
L_ck_10_c:
    s_waitcnt vmcnt(0)
    s_branch L_ck_10ed
L_ck_10ed:
    s_add_u32 s42, s20, 0
    buffer_load_dwordx4 a[204:207], v1, s[4:7], s42 offen offset:2048 sc1
    buffer_load_dwordx4 a[208:211], v1, s[4:7], s42 offen offset:3072 sc1
    s_add_u32 s42, s20, 4096
    buffer_load_dwordx4 a[212:215], v1, s[4:7], s42 offen offset:0 sc1
    s_add_u32 s42, s21, 0
    buffer_load_dwordx4 a[216:219], v1, s[4:7], s42 offen offset:2048 sc1
    buffer_load_dwordx4 a[220:223], v1, s[4:7], s42 offen offset:3072 sc1
    s_add_u32 s42, s21, 4096
    buffer_load_dwordx4 v[116:119], v1, s[4:7], s42 offen offset:0 sc1
    s_add_u32 s42, s22, 0
    buffer_load_dwordx4 v[120:123], v1, s[4:7], s42 offen offset:2048 sc1
    buffer_load_dwordx4 v[124:127], v1, s[4:7], s42 offen offset:3072 sc1
    v_mfma_f32_16x16x32_bf16 v[96:99], v[180:183], a[244:247], v[96:99]
    v_lshlrev_b32 v28, 16, v17
    v_and_b32 v29, 0xffff0000, v17
    v_mfma_f32_16x16x32_bf16 v[100:103], v[184:187], a[244:247], v[100:103]
    s_add_u32 s42, s22, 4096
    buffer_load_dwordx4 v[128:131], v1, s[4:7], s42 offen offset:0 sc1
    v_mfma_f32_16x16x32_bf16 v[104:107], v[188:191], a[244:247], v[104:107]
    v_lshlrev_b32 v30, 16, v18
    v_and_b32 v31, 0xffff0000, v18
    v_mfma_f32_16x16x32_bf16 v[108:111], v[192:195], a[244:247], v[108:111]
    v_lshlrev_b32 v32, 16, v19
    v_and_b32 v33, 0xffff0000, v19
    s_waitcnt vmcnt(8)
    v_mfma_f32_16x16x32_bf16 v[52:55], v[196:199], a[204:207], v[52:55]
    v_lshlrev_b32 v34, 16, v20
    v_and_b32 v35, 0xffff0000, v20
    v_mfma_f32_16x16x32_bf16 v[56:59], v[200:203], a[204:207], v[56:59]
    s_add_u32 s42, s23, 0
    buffer_load_dwordx4 v[132:135], v1, s[4:7], s42 offen offset:0 sc1
    v_mfma_f32_16x16x32_bf16 v[60:63], v[204:207], a[204:207], v[60:63]
    v_lshlrev_b32 v36, 16, v21
    v_and_b32 v37, 0xffff0000, v21
    v_mfma_f32_16x16x32_bf16 v[64:67], v[208:211], a[204:207], v[64:67]
    v_lshlrev_b32 v38, 16, v22
    v_and_b32 v39, 0xffff0000, v22
    v_mfma_f32_16x16x32_bf16 v[68:71], v[212:215], a[204:207], v[68:71]
    v_lshlrev_b32 v40, 16, v23
    v_and_b32 v41, 0xffff0000, v23
    s_waitcnt vmcnt(8)
    v_mfma_f32_16x16x32_bf16 v[52:55], v[216:219], a[208:211], v[52:55]
    v_lshlrev_b32 v42, 16, v24
    v_and_b32 v43, 0xffff0000, v24
    v_mfma_f32_16x16x32_bf16 v[56:59], v[220:223], a[208:211], v[56:59]
    buffer_load_dwordx4 v[136:139], v1, s[4:7], s42 offen offset:1024 sc1
    v_mfma_f32_16x16x32_bf16 v[60:63], v[224:227], a[208:211], v[60:63]
    v_lshlrev_b32 v44, 16, v25
    v_and_b32 v45, 0xffff0000, v25
    v_mfma_f32_16x16x32_bf16 v[64:67], v[228:231], a[208:211], v[64:67]
    v_mfma_f32_16x16x32_bf16 v[68:71], v[232:235], a[208:211], v[68:71]
    s_waitcnt vmcnt(8)
    v_mfma_f32_16x16x32_bf16 v[52:55], v[236:239], a[212:215], v[52:55]
    buffer_load_dwordx4 v[140:143], v1, s[4:7], s42 offen offset:2048 sc1
    v_mfma_f32_16x16x32_bf16 v[56:59], v[240:243], a[212:215], v[56:59]
    v_mfma_f32_16x16x32_bf16 v[60:63], v[244:247], a[212:215], v[60:63]
    buffer_load_dwordx4 v[144:147], v1, s[4:7], s42 offen offset:3072 sc1
    v_mfma_f32_16x16x32_bf16 v[64:67], v[248:251], a[212:215], v[64:67]
    v_mfma_f32_16x16x32_bf16 v[68:71], v[252:255], a[212:215], v[68:71]
    s_add_u32 s42, s23, 4096
    buffer_load_dwordx4 v[148:151], v1, s[4:7], s42 offen offset:0 sc1
    s_waitcnt vmcnt(10)
    v_mfma_f32_16x16x32_bf16 v[72:75], v[196:199], a[216:219], v[72:75]
    s_mul_i32 s41, s16, 15360
    s_add_u32 s41, s41, 102400
    s_waitcnt vmcnt(9)
    v_mfma_f32_16x16x32_bf16 v[72:75], v[216:219], a[220:223], v[72:75]
    v_add_u32 v8, s41, v1
    s_waitcnt vmcnt(8)
    v_mfma_f32_16x16x32_bf16 v[72:75], v[236:239], v[116:119], v[72:75]
    ds_write_b128 v8, v[52:55] offset:0
    v_mfma_f32_16x16x32_bf16 v[76:79], v[200:203], a[216:219], v[76:79]
    v_mfma_f32_16x16x32_bf16 v[76:79], v[220:223], a[220:223], v[76:79]
    v_mfma_f32_16x16x32_bf16 v[76:79], v[240:243], v[116:119], v[76:79]
    ds_write_b128 v8, v[56:59] offset:1024
    v_mfma_f32_16x16x32_bf16 v[80:83], v[204:207], a[216:219], v[80:83]
    v_mfma_f32_16x16x32_bf16 v[80:83], v[224:227], a[220:223], v[80:83]
    s_add_u32 m0, s74, 49152
    s_add_u32 s44, s52, 49152
    buffer_load_dwordx4 v1, s[4:7], s44 offen offset:2048 sc1 lds
    v_mfma_f32_16x16x32_bf16 v[80:83], v[244:247], v[116:119], v[80:83]
    ds_write_b128 v8, v[60:63] offset:2048
    v_mfma_f32_16x16x32_bf16 v[84:87], v[208:211], a[216:219], v[84:87]
    v_mfma_f32_16x16x32_bf16 v[84:87], v[228:231], a[220:223], v[84:87]
    buffer_load_dwordx4 v1, s[4:7], s44 offen offset:3072 sc1 lds
    v_mfma_f32_16x16x32_bf16 v[84:87], v[248:251], v[116:119], v[84:87]
    ds_write_b128 v8, v[64:67] offset:3072
    v_mfma_f32_16x16x32_bf16 v[88:91], v[212:215], a[216:219], v[88:91]
    v_mfma_f32_16x16x32_bf16 v[88:91], v[232:235], a[220:223], v[88:91]
    s_add_u32 m0, s74, 65536
    s_add_u32 s44, s52, 65536
    buffer_load_dwordx4 v1, s[4:7], s44 offen offset:0 sc1 lds
    v_mfma_f32_16x16x32_bf16 v[88:91], v[252:255], v[116:119], v[88:91]
    ds_write_b128 v8, v[68:71] offset:4096
    s_waitcnt vmcnt(10)
    v_mfma_f32_16x16x32_bf16 v[92:95], v[196:199], v[120:123], v[92:95]
    s_mul_i32 s41, s17, 15360
    s_add_u32 s41, s41, 107520
    s_waitcnt vmcnt(9)
    v_mfma_f32_16x16x32_bf16 v[92:95], v[216:219], v[124:127], v[92:95]
    buffer_load_dwordx4 v1, s[4:7], s44 offen offset:1024 sc1 lds
    v_add_u32 v8, s41, v1
    s_waitcnt vmcnt(9)
    v_mfma_f32_16x16x32_bf16 v[92:95], v[236:239], v[128:131], v[92:95]
    ds_write_b128 v8, v[72:75] offset:0
    v_mfma_f32_16x16x32_bf16 v[96:99], v[200:203], v[120:123], v[96:99]
    v_mfma_f32_16x16x32_bf16 v[96:99], v[220:223], v[124:127], v[96:99]
    buffer_load_dwordx4 v1, s[4:7], s44 offen offset:2048 sc1 lds
    v_mfma_f32_16x16x32_bf16 v[96:99], v[240:243], v[128:131], v[96:99]
    ds_write_b128 v8, v[76:79] offset:1024
    v_mfma_f32_16x16x32_bf16 v[100:103], v[204:207], v[120:123], v[100:103]
    v_mfma_f32_16x16x32_bf16 v[100:103], v[224:227], v[124:127], v[100:103]
    buffer_load_dwordx4 v1, s[4:7], s44 offen offset:3072 sc1 lds
    v_mfma_f32_16x16x32_bf16 v[100:103], v[244:247], v[128:131], v[100:103]
    ds_write_b128 v8, v[80:83] offset:2048
    v_mfma_f32_16x16x32_bf16 v[104:107], v[208:211], v[120:123], v[104:107]
    v_mfma_f32_16x16x32_bf16 v[104:107], v[228:231], v[124:127], v[104:107]
    s_add_u32 m0, s74, 81920
    s_add_u32 s44, s52, 81920
    buffer_load_dwordx4 v1, s[4:7], s44 offen offset:0 sc1 lds
    v_mfma_f32_16x16x32_bf16 v[104:107], v[248:251], v[128:131], v[104:107]
    ds_write_b128 v8, v[84:87] offset:3072
    v_mfma_f32_16x16x32_bf16 v[108:111], v[212:215], v[120:123], v[108:111]
    v_mfma_f32_16x16x32_bf16 v[108:111], v[232:235], v[124:127], v[108:111]
    buffer_load_dwordx4 v1, s[4:7], s44 offen offset:1024 sc1 lds
    v_mfma_f32_16x16x32_bf16 v[108:111], v[252:255], v[128:131], v[108:111]
    ds_write_b128 v8, v[88:91] offset:4096
    s_waitcnt vmcnt(12)
    v_mfma_f32_16x16x32_bf16 v[26:29], v[156:159], v[132:135], v[26:29]
    s_mul_i32 s41, s18, 15360
    s_add_u32 s41, s41, 112640
    s_waitcnt vmcnt(11)
    v_mfma_f32_16x16x32_bf16 v[26:29], v[176:179], v[136:139], v[26:29]
    s_mov_b32 exec_lo, 0xff00ff
    s_mov_b32 exec_hi, 0
    buffer_load_dword v51, v11, s[4:7], 0 offen sc1
    s_mov_b64 exec, -1
    v_add_u32 v8, s41, v1
    s_waitcnt vmcnt(11)
    v_mfma_f32_16x16x32_bf16 v[26:29], v[196:199], v[140:143], v[26:29]
    ds_write_b128 v8, v[92:95] offset:0
    s_waitcnt vmcnt(10)
    v_mfma_f32_16x16x32_bf16 v[26:29], v[216:219], v[144:147], v[26:29]
    s_waitcnt lgkmcnt(1)
    s_barrier
    ds_read_b128 v[52:55], v9 offset:0
    s_waitcnt vmcnt(9)
    v_mfma_f32_16x16x32_bf16 v[26:29], v[236:239], v[148:151], v[26:29]
    s_add_u32 s43, s92, 24576
    buffer_load_dwordx4 a[96:99], v1, s[4:7], s43 offen offset:0 sc1
    v_mfma_f32_16x16x32_bf16 v[30:33], v[160:163], v[132:135], v[30:33]
    ds_write_b128 v8, v[96:99] offset:1024
    v_mfma_f32_16x16x32_bf16 v[30:33], v[180:183], v[136:139], v[30:33]
    ds_read_b128 v[56:59], v9 offset:1024
    v_mfma_f32_16x16x32_bf16 v[30:33], v[200:203], v[140:143], v[30:33]
    buffer_load_dwordx4 a[100:103], v1, s[4:7], s43 offen offset:1024 sc1
    v_mfma_f32_16x16x32_bf16 v[30:33], v[220:223], v[144:147], v[30:33]
    ds_write_b128 v8, v[100:103] offset:2048
    v_mfma_f32_16x16x32_bf16 v[30:33], v[240:243], v[148:151], v[30:33]
    ds_read_b128 v[60:63], v9 offset:2048
    v_mfma_f32_16x16x32_bf16 v[34:37], v[164:167], v[132:135], v[34:37]
    buffer_load_dwordx4 a[104:107], v1, s[4:7], s43 offen offset:2048 sc1
    v_mfma_f32_16x16x32_bf16 v[34:37], v[184:187], v[136:139], v[34:37]
    ds_write_b128 v8, v[104:107] offset:3072
    v_mfma_f32_16x16x32_bf16 v[34:37], v[204:207], v[140:143], v[34:37]
    ds_read_b128 v[64:67], v9 offset:3072
    v_mfma_f32_16x16x32_bf16 v[34:37], v[224:227], v[144:147], v[34:37]
    buffer_load_dwordx4 a[108:111], v1, s[4:7], s43 offen offset:3072 sc1
    v_mfma_f32_16x16x32_bf16 v[34:37], v[244:247], v[148:151], v[34:37]
    ds_write_b128 v8, v[108:111] offset:4096
    v_mfma_f32_16x16x32_bf16 v[38:41], v[168:171], v[132:135], v[38:41]
    ds_read_b128 v[68:71], v9 offset:4096
    v_mfma_f32_16x16x32_bf16 v[38:41], v[188:191], v[136:139], v[38:41]
    s_add_u32 s43, s92, 28672
    buffer_load_dwordx4 a[112:115], v1, s[4:7], s43 offen offset:0 sc1
    v_mfma_f32_16x16x32_bf16 v[38:41], v[208:211], v[140:143], v[38:41]
    s_waitcnt lgkmcnt(1)
    s_barrier
    ds_read_b128 v[92:95], v9 offset:10240
    v_mfma_f32_16x16x32_bf16 v[38:41], v[228:231], v[144:147], v[38:41]
    ds_read_b128 v[96:99], v9 offset:11264
    ds_read_b128 v[72:75], v9 offset:5120
    v_mfma_f32_16x16x32_bf16 v[38:41], v[248:251], v[148:151], v[38:41]
    buffer_load_dwordx4 a[116:119], v1, s[4:7], s43 offen offset:1024 sc1
    v_mfma_f32_16x16x32_bf16 v[42:45], v[172:175], v[132:135], v[42:45]
    ds_read_b128 v[100:103], v9 offset:12288
    ds_read_b128 v[76:79], v9 offset:6144
    v_mfma_f32_16x16x32_bf16 v[42:45], v[192:195], v[136:139], v[42:45]
    ds_read_b128 v[104:107], v9 offset:13312
    ds_read_b128 v[80:83], v9 offset:7168
    v_mfma_f32_16x16x32_bf16 v[42:45], v[212:215], v[140:143], v[42:45]
    buffer_load_dwordx4 a[120:123], v1, s[4:7], s43 offen offset:2048 sc1
    v_mfma_f32_16x16x32_bf16 v[42:45], v[232:235], v[144:147], v[42:45]
    ds_read_b128 v[108:111], v9 offset:14336
    ds_read_b128 v[84:87], v9 offset:8192
    v_mfma_f32_16x16x32_bf16 v[42:45], v[252:255], v[148:151], v[42:45]
    buffer_load_dwordx4 a[124:127], v1, s[4:7], s43 offen offset:3072 sc1
    ds_read_b128 v[88:91], v9 offset:9216
    s_waitcnt lgkmcnt(7)
    v_add_f32 v52, v52, v72
    v_add_f32 v53, v53, v73
    v_add_f32 v54, v54, v74
    v_add_f32 v55, v55, v75
    s_waitcnt lgkmcnt(5)
    v_add_f32 v56, v56, v76
    v_add_f32 v57, v57, v77
    v_add_f32 v58, v58, v78
    v_add_f32 v59, v59, v79
    s_waitcnt lgkmcnt(3)
    v_add_f32 v60, v60, v80
    v_add_f32 v61, v61, v81
    v_add_f32 v62, v62, v82
    v_add_f32 v63, v63, v83
    s_waitcnt lgkmcnt(1)
    v_add_f32 v64, v64, v84
    v_add_f32 v65, v65, v85
    v_add_f32 v66, v66, v86
    v_add_f32 v67, v67, v87
    s_waitcnt lgkmcnt(0)
    v_add_f32 v68, v68, v88
    v_add_f32 v69, v69, v89
    v_add_f32 v70, v70, v90
    v_add_f32 v71, v71, v91
    v_add_u32 v46, 98304, v14
    ds_read_b64 v[140:141], v46 offset:0
    ds_read_b64 v[142:143], v46 offset:512
    ds_read_b64 v[144:145], v46 offset:1024
    ds_read_b64 v[146:147], v46 offset:1536
    s_waitcnt lgkmcnt(0)
    s_barrier
    v_pk_add_f32 v[52:53], v[52:53], v[92:93]
    v_pk_add_f32 v[54:55], v[54:55], v[94:95]
    v_pk_add_f32 v[56:57], v[56:57], v[96:97]
    v_pk_add_f32 v[58:59], v[58:59], v[98:99]
    v_pk_add_f32 v[60:61], v[60:61], v[100:101]
    v_pk_add_f32 v[62:63], v[62:63], v[102:103]
    v_pk_add_f32 v[64:65], v[64:65], v[104:105]
    v_pk_add_f32 v[66:67], v[66:67], v[106:107]
    v_pk_add_f32 v[68:69], v[68:69], v[108:109]
    v_pk_add_f32 v[70:71], v[70:71], v[110:111]
    v_pk_add_f32 v[26:27], v[26:27], v[52:53]
    v_pk_add_f32 v[28:29], v[28:29], v[54:55]
    v_pk_add_f32 v[30:31], v[30:31], v[56:57]
    v_pk_add_f32 v[32:33], v[32:33], v[58:59]
    v_pk_add_f32 v[34:35], v[34:35], v[60:61]
    v_pk_add_f32 v[36:37], v[36:37], v[62:63]
    v_pk_add_f32 v[38:39], v[38:39], v[64:65]
    v_pk_add_f32 v[40:41], v[40:41], v[66:67]
    v_pk_add_f32 v[42:43], v[42:43], v[68:69]
    v_pk_add_f32 v[44:45], v[44:45], v[70:71]
    v_cvt_pk_bf16_f32 v16, v26, v27
    v_cvt_pk_bf16_f32 v17, v28, v29
    v_cvt_pk_bf16_f32 v18, v30, v31
    v_cvt_pk_bf16_f32 v19, v32, v33
    v_cvt_pk_bf16_f32 v20, v34, v35
    v_cvt_pk_bf16_f32 v21, v36, v37
    v_cvt_pk_bf16_f32 v22, v38, v39
    v_cvt_pk_bf16_f32 v23, v40, v41
    v_cvt_pk_bf16_f32 v24, v42, v43
    v_cvt_pk_bf16_f32 v25, v44, v45
    s_cmp_lg_u32 s50, 0
    s_cbranch_scc1 L_wt_11
    buffer_store_dwordx4 v[16:19], v5, s[4:7], s82 offen
    buffer_store_dwordx4 v[20:23], v5, s[4:7], s82 offen offset:2048
    buffer_store_dwordx2 v[24:25], v6, s[4:7], s82 offen
L_bk_12:
    v_dot2_f32_bf16 v26, v16, s70, 0
    v_dot2_f32_bf16 v27, v16, v16, 0
    v_dot2_f32_bf16 v26, v17, s70, v26
    v_dot2_f32_bf16 v27, v17, v17, v27
    v_dot2_f32_bf16 v26, v18, s70, v26
    v_dot2_f32_bf16 v27, v18, v18, v27
    v_dot2_f32_bf16 v26, v19, s70, v26
    v_dot2_f32_bf16 v27, v19, v19, v27
    v_dot2_f32_bf16 v26, v20, s70, v26
    v_dot2_f32_bf16 v27, v20, v20, v27
    v_dot2_f32_bf16 v26, v21, s70, v26
    v_dot2_f32_bf16 v27, v21, v21, v27
    v_dot2_f32_bf16 v26, v22, s70, v26
    v_dot2_f32_bf16 v27, v22, v22, v27
    v_dot2_f32_bf16 v26, v23, s70, v26
    v_dot2_f32_bf16 v27, v23, v23, v27
    v_dot2_f32_bf16 v26, v24, s70, v26
    v_dot2_f32_bf16 v27, v24, v24, v27
    v_dot2_f32_bf16 v26, v25, s70, v26
    v_dot2_f32_bf16 v27, v25, v25, v27
    s_nop 2
    v_permlane32_swap_b32 v26, v27
    v_add_f32 v26, v26, v27
    v_mov_b32 v27, v26
    s_nop 1
    v_permlane16_swap_b32 v26, v27
    v_add_f32 v26, v26, v27
    s_cmp_lg_u32 s50, 0
    s_cbranch_scc1 L_wt_13
    buffer_store_dword v26, v7, s[4:7], s84 offen
L_bk_14:
    s_add_u32 m0, s74, 81920
    s_add_u32 s44, s52, 81920
    buffer_load_dwordx4 v1, s[4:7], s44 offen offset:2048 sc1 lds
    buffer_load_dwordx4 v1, s[4:7], s44 offen offset:3072 sc1 lds
    s_add_u32 m0, s74, 98304
    s_add_u32 s44, s52, 98304
    buffer_load_dwordx4 v1, s[4:7], s44 offen offset:0 sc1 lds
    buffer_load_dwordx4 v1, s[4:7], s44 offen offset:1024 sc1 lds
    buffer_load_dwordx4 v1, s[4:7], s44 offen offset:2048 sc1 lds
    buffer_load_dwordx4 v1, s[4:7], s44 offen offset:3072 sc1 lds
    v_mov_b32 v50, 1
    s_waitcnt vmcnt(7)
    s_mov_b64 exec, 1
    s_cmp_lg_u32 s50, 0
    s_cbranch_scc1 L_wt_15
    buffer_store_dword v50, v0, s[4:7], s98 offen offset:0
L_bk_16:
    s_mov_b64 exec, -1
L_p4_0:
    s_mov_b32 s59, L_p4_0+2048-L_pc
    s_load_dword s65, s[0:1], s59
    s_add_u32 s59, s59, 64
    s_load_dword s65, s[0:1], s59
    v_lshlrev_b32 v34, 2, v0
    v_and_b32 v34, 63, v34
    s_waitcnt vmcnt(7)
    v_mov_b32 v50, 2
    s_mov_b64 exec, 1
    s_cmp_lg_u32 s50, 0
    s_cbranch_scc1 L_wt_17
    buffer_store_dword v50, v0, s[4:7], s98 offen offset:0
L_bk_18:
    s_mov_b64 exec, -1
    v_add_f32 v140, v140, v142
    v_add_f32 v141, v141, v143
    v_add_f32 v140, v140, v144
    v_add_f32 v141, v141, v145
    v_add_f32 v140, v140, v146
    v_add_f32 v141, v141, v147
    v_cvt_pk_bf16_f32 v142, v140, v140
    v_and_b32 v142, 0xffff0000, v142
    v_sub_f32 v140, v140, v142
    v_cvt_pk_bf16_f32 v140, v142, v140
    v_accvgpr_write_b32 a252, v140
    v_accvgpr_write_b32 a253, v140
    v_cvt_pk_bf16_f32 v143, v141, v141
    v_and_b32 v143, 0xffff0000, v143
    v_sub_f32 v141, v141, v143
    v_cvt_pk_bf16_f32 v141, v143, v141
    v_accvgpr_write_b32 a254, v141
    v_accvgpr_write_b32 a255, v141
    v_and_b32 v26, 31, v0
    v_lshrrev_b32 v15, 5, v0
    v_lshlrev_b32 v15, 11, v15
    v_lshl_add_u32 v15, v26, 3, v15
    v_and_b32 v46, 31, v0
    v_lshrrev_b32 v47, 5, v0
    v_lshrrev_b32 v5, 4, v46
    v_mul_u32_u24 v5, 57344, v5
    v_and_b32 v46, 15, v46
    v_lshl_add_u32 v48, v47, 4, v46
    v_lshl_add_u32 v5, v48, 4, v5
    v_add_u32 v6, 57344, v1
    v_add_u32 v48, 4, v46
    v_and_b32 v48, 16, v48
    v_lshl_add_u32 v10, v48, 14, v1
    v_lshrrev_b32 v48, 4, v0
    v_lshlrev_b32 v48, 6, v48
    v_sub_u32 v10, v10, v48
    v_add_u32 v10, 83968, v10
    v_lshlrev_b32 v48, 2, v0
    v_and_b32 v48, 31, v48
    v_add_u32 v48, s100, v48
    s_add_u32 s41, s3, 1
    s_and_b32 s41, s41, 3
    s_mov_b32 s16, s41
    s_mul_i32 s20, s41, 57344
    s_add_u32 s20, s20, s90
    s_add_u32 s41, s3, 2
    s_and_b32 s41, s41, 3
    s_mov_b32 s17, s41
    s_mul_i32 s21, s41, 57344
    s_add_u32 s21, s21, s90
    s_add_u32 s41, s3, 3
    s_and_b32 s41, s41, 3
    s_mov_b32 s18, s41
    s_mul_i32 s22, s41, 57344
    s_add_u32 s22, s22, s90
    s_mul_i32 s23, s3, 57344
    s_add_u32 s23, s23, s90
    s_barrier
    ds_read_b128 a[224:227], v1 offset:0
    ds_read_b128 a[228:231], v1 offset:1024
    ds_read_b128 a[232:235], v1 offset:2048
    ds_read_b128 a[236:239], v1 offset:3072
    ds_read_b128 a[240:243], v1 offset:4096
    ds_read_b128 a[244:247], v1 offset:5120
    s_mov_b32 s45, 200000
L_poll_19:
    buffer_load_dword v35, v34, s[4:7], s99 offen sc1
    s_sub_u32 s45, s45, 1
    s_cbranch_scc1 L_got_20
    s_waitcnt vmcnt(0)
    v_cmp_gt_u32 vcc, 1, v35
    s_nop 0
    s_cbranch_vccnz L_poll_19
L_got_20:
    s_waitcnt vmcnt(0)
    s_add_u32 s42, s80, 0
    buffer_load_dwordx4 a[204:207], v1, s[4:7], s42 offen offset:0 sc1
    buffer_load_dwordx4 a[208:211], v1, s[4:7], s42 offen offset:1024 sc1
    buffer_load_dwordx4 a[212:215], v1, s[4:7], s42 offen offset:2048 sc1
    buffer_load_dwordx4 a[216:219], v1, s[4:7], s42 offen offset:3072 sc1
    s_add_u32 s42, s80, 4096
    buffer_load_dwordx4 a[220:223], v1, s[4:7], s42 offen offset:0 sc1
    buffer_load_dwordx4 v[116:119], v1, s[4:7], s42 offen offset:1024 sc1
    buffer_load_dwordx4 v[120:123], v1, s[4:7], s42 offen offset:2048 sc1
    buffer_load_dwordx4 v[124:127], v1, s[4:7], s42 offen offset:3072 sc1
    s_waitcnt vmcnt(7) lgkmcnt(0)
    v_mfma_f32_16x16x32_bf16 v[52:55], a[224:227], a[204:207], 0
    buffer_load_dword v37, v34, s[4:7], s99 offen sc1
    s_add_u32 s42, s80, 8192
    buffer_load_dwordx4 v[128:131], v1, s[4:7], s42 offen offset:0 sc1
    s_waitcnt vmcnt(8)
    v_mfma_f32_16x16x32_bf16 v[56:59], a[224:227], a[208:211], 0
    ds_read_b128 a[224:227], v1 offset:6144
    v_mfma_f32_16x16x32_bf16 v[60:63], a[228:231], a[204:207], 0
    v_mfma_f32_16x16x32_bf16 v[64:67], a[228:231], a[208:211], 0
    ds_read_b128 a[228:231], v1 offset:7168
    v_mfma_f32_16x16x32_bf16 v[68:71], a[232:235], a[204:207], 0
    buffer_load_dwordx4 v[132:135], v1, s[4:7], s42 offen offset:1024 sc1
    v_mfma_f32_16x16x32_bf16 v[72:75], a[232:235], a[208:211], 0
    ds_read_b128 a[232:235], v1 offset:8192
    v_mfma_f32_16x16x32_bf16 v[76:79], a[236:239], a[204:207], 0
    v_mfma_f32_16x16x32_bf16 v[80:83], a[236:239], a[208:211], 0
    s_waitcnt vmcnt(7)
    ds_read_b128 a[236:239], v1 offset:9216
    v_mfma_f32_16x16x32_bf16 v[52:55], a[240:243], a[212:215], v[52:55]
    buffer_load_dwordx4 v[136:139], v1, s[4:7], s42 offen offset:2048 sc1
    v_mfma_f32_16x16x32_bf16 v[56:59], a[240:243], a[216:219], v[56:59]
    s_waitcnt lgkmcnt(3)
    ds_read_b128 a[240:243], v1 offset:10240
    v_mfma_f32_16x16x32_bf16 v[60:63], a[244:247], a[212:215], v[60:63]
    buffer_load_dwordx4 v[140:143], v1, s[4:7], s42 offen offset:3072 sc1
    v_mfma_f32_16x16x32_bf16 v[64:67], a[244:247], a[216:219], v[64:67]
    ds_read_b128 a[244:247], v1 offset:11264
    v_mfma_f32_16x16x32_bf16 v[68:71], a[224:227], a[212:215], v[68:71]
    v_mfma_f32_16x16x32_bf16 v[72:75], a[224:227], a[216:219], v[72:75]
    s_waitcnt lgkmcnt(3)
    ds_read_b128 a[224:227], v1 offset:12288
    v_mfma_f32_16x16x32_bf16 v[76:79], a[228:231], a[212:215], v[76:79]
    s_add_u32 s42, s80, 12288
    buffer_load_dwordx4 v[144:147], v1, s[4:7], s42 offen offset:0 sc1
    v_mfma_f32_16x16x32_bf16 v[80:83], a[228:231], a[216:219], v[80:83]
    s_waitcnt vmcnt(8)
    ds_read_b128 a[228:231], v1 offset:13312
    v_mfma_f32_16x16x32_bf16 v[52:55], a[232:235], a[220:223], v[52:55]
    v_mfma_f32_16x16x32_bf16 v[56:59], a[232:235], v[116:119], v[56:59]
    s_waitcnt lgkmcnt(3)
    ds_read_b128 a[232:235], v1 offset:14336
    v_mfma_f32_16x16x32_bf16 v[60:63], a[236:239], a[220:223], v[60:63]
    buffer_load_dwordx4 v[148:151], v1, s[4:7], s42 offen offset:1024 sc1
    v_mfma_f32_16x16x32_bf16 v[64:67], a[236:239], v[116:119], v[64:67]
    ds_read_b128 a[236:239], v1 offset:15360
    v_mfma_f32_16x16x32_bf16 v[68:71], a[240:243], a[220:223], v[68:71]
    v_mfma_f32_16x16x32_bf16 v[72:75], a[240:243], v[116:119], v[72:75]
    s_waitcnt lgkmcnt(3)
    ds_read_b128 a[240:243], v1 offset:16384
    v_mfma_f32_16x16x32_bf16 v[76:79], a[244:247], a[220:223], v[76:79]
    buffer_load_dwordx4 v[152:155], v1, s[4:7], s42 offen offset:2048 sc1
    v_mfma_f32_16x16x32_bf16 v[80:83], a[244:247], v[116:119], v[80:83]
    s_waitcnt vmcnt(8)
    ds_read_b128 a[244:247], v1 offset:17408
    v_mfma_f32_16x16x32_bf16 v[52:55], a[224:227], v[120:123], v[52:55]
    v_mfma_f32_16x16x32_bf16 v[56:59], a[224:227], v[124:127], v[56:59]
    s_waitcnt lgkmcnt(3)
    ds_read_b128 a[224:227], v1 offset:18432
    v_mfma_f32_16x16x32_bf16 v[60:63], a[228:231], v[120:123], v[60:63]
    buffer_load_dwordx4 v[156:159], v1, s[4:7], s42 offen offset:3072 sc1
    v_mfma_f32_16x16x32_bf16 v[64:67], a[228:231], v[124:127], v[64:67]
    ds_read_b128 a[228:231], v1 offset:19456
    v_mfma_f32_16x16x32_bf16 v[68:71], a[232:235], v[120:123], v[68:71]
    s_barrier
    s_waitcnt vmcnt(8)
    v_cmp_gt_u32 vcc, 2, v37
    s_nop 0
    s_cbranch_vccnz L_sx_21
L_sx_21ed:
    buffer_load_dwordx2 v[26:27], v15, s[4:7], s81 offen offset:0 sc1
    v_mfma_f32_16x16x32_bf16 v[72:75], a[232:235], v[124:127], v[72:75]
    s_waitcnt lgkmcnt(3)
    ds_read_b128 a[232:235], v2 offset:16384
    v_mfma_f32_16x16x32_bf16 v[76:79], a[236:239], v[120:123], v[76:79]
    v_mfma_f32_16x16x32_bf16 v[80:83], a[236:239], v[124:127], v[80:83]
    s_waitcnt vmcnt(7)
    ds_read_b128 a[236:239], v1 offset:20480
    v_mfma_f32_16x16x32_bf16 v[52:55], a[240:243], v[128:131], v[52:55]
    buffer_load_dwordx2 v[28:29], v15, s[4:7], s81 offen offset:512 sc1
    v_mfma_f32_16x16x32_bf16 v[56:59], a[240:243], v[132:135], v[56:59]
    s_waitcnt lgkmcnt(3)
    ds_read_b128 a[240:243], v1 offset:21504
    v_mfma_f32_16x16x32_bf16 v[60:63], a[244:247], v[128:131], v[60:63]
    v_mfma_f32_16x16x32_bf16 v[64:67], a[244:247], v[132:135], v[64:67]
    ds_read_b128 a[244:247], v1 offset:22528
    v_mfma_f32_16x16x32_bf16 v[68:71], a[224:227], v[128:131], v[68:71]
    buffer_load_dwordx2 v[30:31], v15, s[4:7], s81 offen offset:1024 sc1
    v_mfma_f32_16x16x32_bf16 v[72:75], a[224:227], v[132:135], v[72:75]
    s_waitcnt lgkmcnt(3)
    ds_read_b128 a[224:227], v1 offset:23552
    v_mfma_f32_16x16x32_bf16 v[76:79], a[228:231], v[128:131], v[76:79]
    v_mfma_f32_16x16x32_bf16 v[80:83], a[228:231], v[132:135], v[80:83]
    ds_read_b128 a[228:231], v1 offset:24576
    v_mfma_f32_16x16x32_bf16 v[84:87], a[232:235], a[204:207], 0
    buffer_load_dwordx2 v[32:33], v15, s[4:7], s81 offen offset:1536 sc1
    v_mfma_f32_16x16x32_bf16 v[88:91], a[232:235], a[208:211], 0
    s_waitcnt vmcnt(8) lgkmcnt(3)
    ds_read_b128 a[232:235], v1 offset:25600
    v_mfma_f32_16x16x32_bf16 v[52:55], a[236:239], v[136:139], v[52:55]
    v_mfma_f32_16x16x32_bf16 v[56:59], a[236:239], v[140:143], v[56:59]
    ds_read_b128 a[236:239], v1 offset:26624
    v_mfma_f32_16x16x32_bf16 v[60:63], a[240:243], v[136:139], v[60:63]
    s_add_u32 s42, s80, 16384
    buffer_load_dwordx4 v[160:163], v1, s[4:7], s42 offen offset:0 sc1
    v_mfma_f32_16x16x32_bf16 v[64:67], a[240:243], v[140:143], v[64:67]
    s_waitcnt lgkmcnt(3)
    ds_read_b128 a[240:243], v1 offset:27648
    v_mfma_f32_16x16x32_bf16 v[68:71], a[244:247], v[136:139], v[68:71]
    buffer_load_dwordx4 v[164:167], v1, s[4:7], s42 offen offset:1024 sc1
    v_mfma_f32_16x16x32_bf16 v[72:75], a[244:247], v[140:143], v[72:75]
    ds_read_b128 a[244:247], v1 offset:28672
    v_mfma_f32_16x16x32_bf16 v[76:79], a[224:227], v[136:139], v[76:79]
    v_mfma_f32_16x16x32_bf16 v[80:83], a[224:227], v[140:143], v[80:83]
    s_waitcnt vmcnt(8) lgkmcnt(3)
    ds_read_b128 a[224:227], v1 offset:29696
    v_mfma_f32_16x16x32_bf16 v[52:55], a[228:231], v[144:147], v[52:55]
    buffer_load_dwordx4 v[168:171], v1, s[4:7], s42 offen offset:2048 sc1
    v_mfma_f32_16x16x32_bf16 v[56:59], a[228:231], v[148:151], v[56:59]
    ds_read_b128 a[228:231], v1 offset:30720
    v_mfma_f32_16x16x32_bf16 v[60:63], a[232:235], v[144:147], v[60:63]
    v_mfma_f32_16x16x32_bf16 v[64:67], a[232:235], v[148:151], v[64:67]
    s_waitcnt lgkmcnt(3)
    ds_read_b128 a[232:235], v1 offset:31744
    v_mfma_f32_16x16x32_bf16 v[68:71], a[236:239], v[144:147], v[68:71]
    buffer_load_dwordx4 v[172:175], v1, s[4:7], s42 offen offset:3072 sc1
    v_mfma_f32_16x16x32_bf16 v[72:75], a[236:239], v[148:151], v[72:75]
    ds_read_b128 a[236:239], v1 offset:32768
    v_mfma_f32_16x16x32_bf16 v[76:79], a[240:243], v[144:147], v[76:79]
    v_mfma_f32_16x16x32_bf16 v[80:83], a[240:243], v[148:151], v[80:83]
    s_waitcnt vmcnt(8) lgkmcnt(3)
    ds_read_b128 a[240:243], v1 offset:33792
    v_mfma_f32_16x16x32_bf16 v[52:55], a[244:247], v[152:155], v[52:55]
    s_add_u32 s42, s80, 20480
    buffer_load_dwordx4 v[176:179], v1, s[4:7], s42 offen offset:0 sc1
    v_mfma_f32_16x16x32_bf16 v[56:59], a[244:247], v[156:159], v[56:59]
    ds_read_b128 a[244:247], v1 offset:34816
    v_mfma_f32_16x16x32_bf16 v[60:63], a[224:227], v[152:155], v[60:63]
    v_mfma_f32_16x16x32_bf16 v[64:67], a[224:227], v[156:159], v[64:67]
    s_waitcnt lgkmcnt(3)
    ds_read_b128 a[224:227], v1 offset:35840
    v_mfma_f32_16x16x32_bf16 v[68:71], a[228:231], v[152:155], v[68:71]
    buffer_load_dwordx4 v[180:183], v1, s[4:7], s42 offen offset:1024 sc1
    v_mfma_f32_16x16x32_bf16 v[72:75], a[228:231], v[156:159], v[72:75]
    ds_read_b128 a[228:231], v1 offset:36864
    v_mfma_f32_16x16x32_bf16 v[76:79], a[232:235], v[152:155], v[76:79]
    buffer_load_dwordx4 v[184:187], v1, s[4:7], s42 offen offset:2048 sc1
    v_mfma_f32_16x16x32_bf16 v[80:83], a[232:235], v[156:159], v[80:83]
    s_waitcnt vmcnt(5) lgkmcnt(3)
    ds_read_b128 a[232:235], v1 offset:37888
    v_mfma_f32_16x16x32_bf16 v[52:55], a[236:239], v[160:163], v[52:55]
    v_mfma_f32_16x16x32_bf16 v[56:59], a[236:239], v[164:167], v[56:59]
    ds_read_b128 a[236:239], v1 offset:38912
    v_mfma_f32_16x16x32_bf16 v[60:63], a[240:243], v[160:163], v[60:63]
    buffer_load_dwordx4 v[188:191], v1, s[4:7], s42 offen offset:3072 sc1
    v_mfma_f32_16x16x32_bf16 v[64:67], a[240:243], v[164:167], v[64:67]
    s_waitcnt lgkmcnt(3)
    ds_read_b128 a[240:243], v1 offset:39936
    v_mfma_f32_16x16x32_bf16 v[68:71], a[244:247], v[160:163], v[68:71]
    v_mfma_f32_16x16x32_bf16 v[72:75], a[244:247], v[164:167], v[72:75]
    ds_read_b128 a[244:247], v2 offset:17408
    v_mfma_f32_16x16x32_bf16 v[76:79], a[224:227], v[160:163], v[76:79]
    s_add_u32 s42, s80, 24576
    buffer_load_dwordx4 v[192:195], v1, s[4:7], s42 offen offset:0 sc1
    v_mfma_f32_16x16x32_bf16 v[80:83], a[224:227], v[164:167], v[80:83]
    s_waitcnt vmcnt(5) lgkmcnt(3)
    ds_read_b128 a[224:227], v1 offset:40960
    v_mfma_f32_16x16x32_bf16 v[52:55], a[228:231], v[168:171], v[52:55]
    v_mfma_f32_16x16x32_bf16 v[56:59], a[228:231], v[172:175], v[56:59]
    ds_read_b128 a[228:231], v1 offset:41984
    v_add_f32 v26, v26, v28
    v_mfma_f32_16x16x32_bf16 v[60:63], a[232:235], v[168:171], v[60:63]
    buffer_load_dwordx4 v[196:199], v1, s[4:7], s42 offen offset:1024 sc1
    v_mfma_f32_16x16x32_bf16 v[64:67], a[232:235], v[172:175], v[64:67]
    s_waitcnt lgkmcnt(3)
    ds_read_b128 a[232:235], v1 offset:43008
    v_add_f32 v27, v27, v29
    v_mfma_f32_16x16x32_bf16 v[68:71], a[236:239], v[168:171], v[68:71]
    v_add_f32 v30, v30, v32
    v_add_f32 v31, v31, v33
    v_mfma_f32_16x16x32_bf16 v[72:75], a[236:239], v[172:175], v[72:75]
    ds_read_b128 a[236:239], v1 offset:44032
    v_add_f32 v26, v26, v30
    v_mfma_f32_16x16x32_bf16 v[76:79], a[240:243], v[168:171], v[76:79]
    buffer_load_dwordx4 v[200:203], v1, s[4:7], s42 offen offset:2048 sc1
    v_mfma_f32_16x16x32_bf16 v[80:83], a[240:243], v[172:175], v[80:83]
    s_waitcnt lgkmcnt(3)
    ds_read_b128 a[240:243], v1 offset:45056
    v_add_f32 v27, v27, v31
    v_mfma_f32_16x16x32_bf16 v[92:95], a[244:247], a[204:207], 0
    buffer_load_dwordx4 v[204:207], v1, s[4:7], s42 offen offset:3072 sc1
    v_mfma_f32_16x16x32_bf16 v[96:99], a[244:247], a[208:211], 0
    s_waitcnt vmcnt(6)
    ds_read_b128 a[244:247], v1 offset:46080
    v_mov_b32 v28, v26
    v_mfma_f32_16x16x32_bf16 v[52:55], a[224:227], v[176:179], v[52:55]
    v_mov_b32 v29, v27
    v_mfma_f32_16x16x32_bf16 v[56:59], a[224:227], v[180:183], v[56:59]
    s_waitcnt lgkmcnt(3)
    ds_read_b128 a[224:227], v1 offset:47104
    v_mfma_f32_16x16x32_bf16 v[60:63], a[228:231], v[176:179], v[60:63]
    s_add_u32 s42, s80, 28672
    buffer_load_dwordx4 v[208:211], v1, s[4:7], s42 offen offset:0 sc1
    v_mfma_f32_16x16x32_bf16 v[64:67], a[228:231], v[180:183], v[64:67]
    ds_read_b128 a[228:231], v1 offset:48128
    v_mfma_f32_16x16x32_bf16 v[68:71], a[232:235], v[176:179], v[68:71]
    v_permlane32_swap_b32 v26, v28
    v_mfma_f32_16x16x32_bf16 v[72:75], a[232:235], v[180:183], v[72:75]
    s_waitcnt lgkmcnt(3)
    ds_read_b128 a[232:235], v1 offset:49152
    v_mfma_f32_16x16x32_bf16 v[76:79], a[236:239], v[176:179], v[76:79]
    buffer_load_dwordx4 v[212:215], v1, s[4:7], s42 offen offset:1024 sc1
    v_mfma_f32_16x16x32_bf16 v[80:83], a[236:239], v[180:183], v[80:83]
    s_waitcnt vmcnt(6)
    ds_read_b128 a[236:239], v1 offset:50176
    v_mfma_f32_16x16x32_bf16 v[52:55], a[240:243], v[184:187], v[52:55]
    v_permlane32_swap_b32 v27, v29
    v_mfma_f32_16x16x32_bf16 v[56:59], a[240:243], v[188:191], v[56:59]
    s_waitcnt lgkmcnt(3)
    ds_read_b128 a[240:243], v1 offset:51200
    v_add_f32 v26, v26, v28
    v_mfma_f32_16x16x32_bf16 v[60:63], a[244:247], v[184:187], v[60:63]
    buffer_load_dwordx4 v[216:219], v1, s[4:7], s42 offen offset:2048 sc1
    v_mfma_f32_16x16x32_bf16 v[64:67], a[244:247], v[188:191], v[64:67]
    ds_read_b128 a[244:247], v1 offset:52224
    v_add_f32 v27, v27, v29
    v_mfma_f32_16x16x32_bf16 v[68:71], a[224:227], v[184:187], v[68:71]
    v_mul_f32 v26, 0xbacccccd, v26
    v_mul_f32 v27, 0x3acccccd, v27
    v_mfma_f32_16x16x32_bf16 v[72:75], a[224:227], v[188:191], v[72:75]
    s_waitcnt lgkmcnt(3)
    ds_read_b128 a[224:227], v1 offset:53248
    v_mov_b32 v28, v26
    v_mfma_f32_16x16x32_bf16 v[76:79], a[228:231], v[184:187], v[76:79]
    buffer_load_dwordx4 v[220:223], v1, s[4:7], s42 offen offset:3072 sc1
    v_mfma_f32_16x16x32_bf16 v[80:83], a[228:231], v[188:191], v[80:83]
    s_waitcnt vmcnt(6)
    ds_read_b128 a[228:231], v1 offset:54272
    v_fma_f32 v27, -v26, v26, v27
    v_mfma_f32_16x16x32_bf16 v[52:55], a[232:235], v[192:195], v[52:55]
    s_add_u32 s42, s80, 32768
    buffer_load_dwordx4 v[224:227], v1, s[4:7], s42 offen offset:0 sc1
    v_mfma_f32_16x16x32_bf16 v[56:59], a[232:235], v[196:199], v[56:59]
    s_waitcnt lgkmcnt(3)
    ds_read_b128 a[232:235], v1 offset:55296
    v_max_f32 v27, 0, v27
    v_mfma_f32_16x16x32_bf16 v[60:63], a[236:239], v[192:195], v[60:63]
    v_add_f32 v27, 0x3727c5ac, v27
    v_mfma_f32_16x16x32_bf16 v[64:67], a[236:239], v[196:199], v[64:67]
    ds_read_b128 a[236:239], v1 offset:56320
    v_mfma_f32_16x16x32_bf16 v[68:71], a[240:243], v[192:195], v[68:71]
    buffer_load_dwordx4 v[228:231], v1, s[4:7], s42 offen offset:1024 sc1
    v_mfma_f32_16x16x32_bf16 v[72:75], a[240:243], v[196:199], v[72:75]
    s_waitcnt lgkmcnt(3)
    ds_read_b128 a[240:243], v1 offset:57344
    v_mfma_f32_16x16x32_bf16 v[76:79], a[244:247], v[192:195], v[76:79]
    v_permlane16_swap_b32 v26, v28
    v_mfma_f32_16x16x32_bf16 v[80:83], a[244:247], v[196:199], v[80:83]
    s_waitcnt vmcnt(6)
    ds_read_b128 a[244:247], v1 offset:58368
    v_mfma_f32_16x16x32_bf16 v[52:55], a[224:227], v[200:203], v[52:55]
    buffer_load_dwordx4 v[232:235], v1, s[4:7], s42 offen offset:2048 sc1
    v_mfma_f32_16x16x32_bf16 v[56:59], a[224:227], v[204:207], v[56:59]
    s_waitcnt lgkmcnt(3)
    ds_read_b128 a[224:227], v1 offset:59392
    v_mfma_f32_16x16x32_bf16 v[60:63], a[228:231], v[200:203], v[60:63]
    v_rsq_f32 v38, v27
    v_mfma_f32_16x16x32_bf16 v[64:67], a[228:231], v[204:207], v[64:67]
    ds_read_b128 a[228:231], v1 offset:60416
    v_cvt_pk_bf16_f32 v42, v26, v26
    v_mfma_f32_16x16x32_bf16 v[68:71], a[232:235], v[200:203], v[68:71]
    buffer_load_dwordx4 v[236:239], v1, s[4:7], s42 offen offset:3072 sc1
    v_mfma_f32_16x16x32_bf16 v[72:75], a[232:235], v[204:207], v[72:75]
    s_waitcnt lgkmcnt(3)
    ds_read_b128 a[232:235], v10 offset:0
    v_and_b32 v43, 0xffff0000, v42
    v_mfma_f32_16x16x32_bf16 v[76:79], a[236:239], v[200:203], v[76:79]
    v_sub_f32 v43, v26, v43
    v_cvt_pk_bf16_f32 v43, v43, v43
    v_mfma_f32_16x16x32_bf16 v[80:83], a[236:239], v[204:207], v[80:83]
    s_waitcnt vmcnt(6)
    ds_read_b128 a[236:239], v1 offset:61440
    v_cvt_pk_bf16_f32 v44, v28, v28
    v_mfma_f32_16x16x32_bf16 v[52:55], a[240:243], v[208:211], v[52:55]
    s_add_u32 s42, s80, 36864
    buffer_load_dwordx4 v[240:243], v1, s[4:7], s42 offen offset:0 sc1
    v_mfma_f32_16x16x32_bf16 v[56:59], a[240:243], v[212:215], v[56:59]
    s_waitcnt lgkmcnt(3)
    ds_read_b128 a[240:243], v1 offset:62464
    v_and_b32 v45, 0xffff0000, v44
    v_mfma_f32_16x16x32_bf16 v[60:63], a[244:247], v[208:211], v[60:63]
    buffer_load_dwordx4 v[244:247], v1, s[4:7], s42 offen offset:1024 sc1
    v_mfma_f32_16x16x32_bf16 v[64:67], a[244:247], v[212:215], v[64:67]
    ds_read_b128 a[244:247], v1 offset:63488
    v_sub_f32 v45, v28, v45
    v_cvt_pk_bf16_f32 v45, v45, v45
    v_mul_f32 v40, v27, v38
    v_mul_f32 v38, 0xbfb8aa3b, v38
    v_mov_b32 v41, v40
    v_mov_b32 v39, v38
    s_nop 0
    v_permlane16_swap_b32 v40, v41
    v_permlane16_swap_b32 v38, v39
    v_mfma_f32_16x16x32_bf16 v[68:71], a[224:227], v[208:211], v[68:71]
    s_bfm_b64 vcc, 16, 0
    v_cndmask_b32 v30, 0, v42, vcc
    v_cndmask_b32 v31, 0, v43, vcc
    v_mfma_f32_16x16x32_bf16 v[72:75], a[224:227], v[212:215], v[72:75]
    s_waitcnt lgkmcnt(3)
    ds_read_b128 a[224:227], v1 offset:64512
    v_mov_b32 v32, 0
    v_mov_b32 v33, 0
    v_mfma_f32_16x16x32_bf16 v[76:79], a[228:231], v[208:211], v[76:79]
    s_bfm_b64 vcc, 16, 0
    v_cndmask_b32 v34, 0, v44, vcc
    v_cndmask_b32 v35, 0, v45, vcc
    buffer_load_dwordx4 v[248:251], v1, s[4:7], s42 offen offset:2048 sc1
    v_mfma_f32_16x16x32_bf16 v[80:83], a[228:231], v[212:215], v[80:83]
    ds_read_b128 a[228:231], v2 offset:0
    v_mov_b32 v36, 0
    v_mov_b32 v37, 0
    v_mfma_f32_16x16x32_bf16 v[100:103], a[232:235], a[204:207], 0
    v_mfma_f32_16x16x32_bf16 v[104:107], a[232:235], a[208:211], 0
    s_waitcnt lgkmcnt(3)
    ds_read_b128 a[232:235], v2 offset:1024
    v_mfma_f32_16x16x32_bf16 v[52:55], a[252:255], v[30:33], v[52:55]
    buffer_load_dwordx4 v[252:255], v1, s[4:7], s42 offen offset:3072 sc1
    v_mfma_f32_16x16x32_bf16 v[56:59], a[252:255], v[34:37], v[56:59]
    s_waitcnt vmcnt(8)
    v_mfma_f32_16x16x32_bf16 v[52:55], a[236:239], v[216:219], v[52:55]
    v_mfma_f32_16x16x32_bf16 v[56:59], a[236:239], v[220:223], v[56:59]
    ds_read_b128 a[236:239], v2 offset:2048
    s_add_u32 m0, s74, 114688
    s_add_u32 s44, s52, 114688
    buffer_load_dwordx4 v1, s[4:7], s44 offen offset:0 sc1 lds
    v_mfma_f32_16x16x32_bf16 v[60:63], a[240:243], v[216:219], v[60:63]
    s_bfm_b64 vcc, 16, 32
    v_cndmask_b32 v30, 0, v42, vcc
    v_cndmask_b32 v31, 0, v43, vcc
    v_mfma_f32_16x16x32_bf16 v[64:67], a[240:243], v[220:223], v[64:67]
    s_waitcnt lgkmcnt(3)
    ds_read_b128 a[240:243], v2 offset:3072
    v_mfma_f32_16x16x32_bf16 v[68:71], a[244:247], v[216:219], v[68:71]
    s_bfm_b64 vcc, 16, 32
    v_cndmask_b32 v34, 0, v44, vcc
    v_cndmask_b32 v35, 0, v45, vcc
    v_mfma_f32_16x16x32_bf16 v[72:75], a[244:247], v[220:223], v[72:75]
    ds_read_b128 a[244:247], v2 offset:4096
    v_mfma_f32_16x16x32_bf16 v[76:79], a[224:227], v[216:219], v[76:79]
    buffer_load_dwordx4 v1, s[4:7], s44 offen offset:1024 sc1 lds
    v_mfma_f32_16x16x32_bf16 v[80:83], a[224:227], v[220:223], v[80:83]
    s_waitcnt lgkmcnt(3)
    ds_read_b128 a[224:227], v2 offset:5120
    v_mfma_f32_16x16x32_bf16 v[60:63], a[252:255], v[30:33], v[60:63]
    v_mfma_f32_16x16x32_bf16 v[64:67], a[252:255], v[34:37], v[64:67]
    s_waitcnt vmcnt(8)
    buffer_load_dwordx4 v1, s[4:7], s44 offen offset:2048 sc1 lds
    v_mfma_f32_16x16x32_bf16 v[52:55], a[228:231], v[224:227], v[52:55]
    v_mfma_f32_16x16x32_bf16 v[56:59], a[228:231], v[228:231], v[56:59]
    ds_read_b128 a[228:231], v2 offset:6144
    v_mfma_f32_16x16x32_bf16 v[60:63], a[232:235], v[224:227], v[60:63]
    s_bfm_b64 vcc, 16, 16
    v_cndmask_b32 v30, 0, v42, vcc
    v_cndmask_b32 v31, 0, v43, vcc
    v_mfma_f32_16x16x32_bf16 v[64:67], a[232:235], v[228:231], v[64:67]
    s_waitcnt lgkmcnt(3)
    ds_read_b128 a[232:235], v2 offset:7168
    buffer_load_dwordx4 v1, s[4:7], s44 offen offset:3072 sc1 lds
    v_mfma_f32_16x16x32_bf16 v[68:71], a[236:239], v[224:227], v[68:71]
    s_bfm_b64 vcc, 16, 16
    v_cndmask_b32 v34, 0, v44, vcc
    v_cndmask_b32 v35, 0, v45, vcc
    v_mfma_f32_16x16x32_bf16 v[72:75], a[236:239], v[228:231], v[72:75]
    ds_read_b128 a[236:239], v2 offset:8192
    v_mfma_f32_16x16x32_bf16 v[76:79], a[240:243], v[224:227], v[76:79]
    v_mfma_f32_16x16x32_bf16 v[80:83], a[240:243], v[228:231], v[80:83]
    s_waitcnt lgkmcnt(3)
    ds_read_b128 a[240:243], v2 offset:9216
    v_mfma_f32_16x16x32_bf16 v[68:71], a[252:255], v[30:33], v[68:71]
    s_add_u32 m0, s74, 131072
    s_add_u32 s44, s52, 131072
    s_mul_i32 s59, s3, 2048
    s_sub_u32 m0, m0, s59
    s_sub_u32 s44, s44, s59
    buffer_load_dwordx4 v1, s[4:7], s44 offen offset:0 sc1 lds
    v_mfma_f32_16x16x32_bf16 v[72:75], a[252:255], v[34:37], v[72:75]
    s_waitcnt vmcnt(9)
    v_mfma_f32_16x16x32_bf16 v[52:55], a[244:247], v[232:235], v[52:55]
    v_mfma_f32_16x16x32_bf16 v[56:59], a[244:247], v[236:239], v[56:59]
    ds_read_b128 a[244:247], v2 offset:10240
    buffer_load_dwordx4 v1, s[4:7], s44 offen offset:1024 sc1 lds
    v_mfma_f32_16x16x32_bf16 v[60:63], a[224:227], v[232:235], v[60:63]
    s_bfm_b64 vcc, 16, 48
    v_cndmask_b32 v30, 0, v42, vcc
    v_cndmask_b32 v31, 0, v43, vcc
    v_mfma_f32_16x16x32_bf16 v[64:67], a[224:227], v[236:239], v[64:67]
    s_waitcnt lgkmcnt(3)
    ds_read_b128 a[224:227], v2 offset:11264
    v_mfma_f32_16x16x32_bf16 v[68:71], a[228:231], v[232:235], v[68:71]
    s_bfm_b64 vcc, 16, 48
    v_cndmask_b32 v34, 0, v44, vcc
    v_cndmask_b32 v35, 0, v45, vcc
    v_mfma_f32_16x16x32_bf16 v[72:75], a[228:231], v[236:239], v[72:75]
    ds_read_b128 a[228:231], v2 offset:12288
    v_mfma_f32_16x16x32_bf16 v[76:79], a[232:235], v[232:235], v[76:79]
    s_mov_b32 exec_lo, 0xff00ff00
    s_mov_b32 exec_hi, 0
    buffer_load_dword v51, v11, s[4:7], 0 offen sc1
    s_mov_b64 exec, -1
    v_mfma_f32_16x16x32_bf16 v[80:83], a[232:235], v[236:239], v[80:83]
    s_waitcnt lgkmcnt(3)
    ds_read_b128 a[232:235], v2 offset:13312
    v_mfma_f32_16x16x32_bf16 v[76:79], a[252:255], v[30:33], v[76:79]
    v_mfma_f32_16x16x32_bf16 v[80:83], a[252:255], v[34:37], v[80:83]
    s_waitcnt vmcnt(9)
    v_mfma_f32_16x16x32_bf16 v[52:55], a[236:239], v[240:243], v[52:55]
    v_mfma_f32_16x16x32_bf16 v[56:59], a[236:239], v[244:247], v[56:59]
    ds_read_b128 a[236:239], v2 offset:14336
    v_mfma_f32_16x16x32_bf16 v[60:63], a[240:243], v[240:243], v[60:63]
    v_mfma_f32_16x16x32_bf16 v[64:67], a[240:243], v[244:247], v[64:67]
    s_waitcnt lgkmcnt(3)
    ds_read_b128 a[240:243], v2 offset:15360
    v_mfma_f32_16x16x32_bf16 v[68:71], a[244:247], v[240:243], v[68:71]
    v_mfma_f32_16x16x32_bf16 v[72:75], a[244:247], v[244:247], v[72:75]
    ds_read_b128 a[244:247], v2 offset:19200
    v_mfma_f32_16x16x32_bf16 v[76:79], a[224:227], v[240:243], v[76:79]
    v_mfma_f32_16x16x32_bf16 v[80:83], a[224:227], v[244:247], v[80:83]
    s_waitcnt vmcnt(7) lgkmcnt(3)
    ds_read_b128 a[224:227], v2 offset:20224
    v_mfma_f32_16x16x32_bf16 v[52:55], a[228:231], v[248:251], v[52:55]
    v_mfma_f32_16x16x32_bf16 v[56:59], a[228:231], v[252:255], v[56:59]
    ds_read_b128 a[228:231], v10 offset:2816
    v_mfma_f32_16x16x32_bf16 v[60:63], a[232:235], v[248:251], v[60:63]
    v_mfma_f32_16x16x32_bf16 v[64:67], a[232:235], v[252:255], v[64:67]
    s_waitcnt lgkmcnt(3)
    ds_read_b128 a[232:235], v2 offset:22016
    v_mfma_f32_16x16x32_bf16 v[68:71], a[236:239], v[248:251], v[68:71]
    v_mfma_f32_16x16x32_bf16 v[72:75], a[236:239], v[252:255], v[72:75]
    ds_read_b128 a[236:239], v2 offset:23040
    v_mfma_f32_16x16x32_bf16 v[76:79], a[240:243], v[248:251], v[76:79]
    s_mov_b32 exec_lo, 0
    s_mov_b32 exec_hi, 0xff00ff
    buffer_load_dword v51, v11, s[4:7], 0 offen sc1
    s_mov_b64 exec, -1
    v_mfma_f32_16x16x32_bf16 v[80:83], a[240:243], v[252:255], v[80:83]
    s_waitcnt lgkmcnt(3)
    ds_read_b128 a[240:243], v10 offset:5632
    v_mfma_f32_16x16x32_bf16 v[84:87], a[244:247], a[212:215], v[84:87]
    v_mfma_f32_16x16x32_bf16 v[88:91], a[244:247], a[216:219], v[88:91]
    ds_read_b128 a[244:247], v2 offset:24832
    v_mfma_f32_16x16x32_bf16 v[92:95], a[224:227], a[212:215], v[92:95]
    s_barrier
    v_mfma_f32_16x16x32_bf16 v[96:99], a[224:227], a[216:219], v[96:99]
    s_waitcnt lgkmcnt(3)
    ds_read_b128 a[224:227], v2 offset:25856
    v_mul_f32 v26, v38, v52
    v_exp_f32 v26, v26
    v_mfma_f32_16x16x32_bf16 v[100:103], a[228:231], a[212:215], v[100:103]
    v_mul_f32 v27, v38, v53
    v_exp_f32 v27, v27
    v_fma_f32 v26, v26, v40, v40
    v_mfma_f32_16x16x32_bf16 v[104:107], a[228:231], a[216:219], v[104:107]
    ds_read_b128 a[228:231], v10 offset:8448
    v_rcp_f32 v26, v26
    v_fma_f32 v27, v27, v40, v40
    v_mfma_f32_16x16x32_bf16 v[84:87], a[232:235], a[220:223], v[84:87]
    v_rcp_f32 v27, v27
    v_mul_f32 v28, v38, v54
    v_mfma_f32_16x16x32_bf16 v[88:91], a[232:235], v[116:119], v[88:91]
    s_waitcnt lgkmcnt(3)
    ds_read_b128 a[232:235], v2 offset:27648
    v_exp_f32 v28, v28
    v_mul_f32 v52, v52, v26
    v_mfma_f32_16x16x32_bf16 v[92:95], a[236:239], a[220:223], v[92:95]
    v_mul_f32 v53, v53, v27
    v_mul_f32 v29, v38, v55
    v_exp_f32 v29, v29
    v_mfma_f32_16x16x32_bf16 v[96:99], a[236:239], v[116:119], v[96:99]
    ds_read_b128 a[236:239], v2 offset:28672
    v_cvt_pk_bf16_f32 v52, v52, v53
    v_fma_f32 v28, v28, v40, v40
    v_mfma_f32_16x16x32_bf16 v[100:103], a[240:243], a[220:223], v[100:103]
    v_rcp_f32 v28, v28
    v_fma_f32 v29, v29, v40, v40
    v_mfma_f32_16x16x32_bf16 v[104:107], a[240:243], v[116:119], v[104:107]
    s_waitcnt lgkmcnt(3)
    ds_read_b128 a[240:243], v10 offset:11264
    v_rcp_f32 v29, v29
    v_mul_f32 v54, v54, v28
    v_mfma_f32_16x16x32_bf16 v[84:87], a[244:247], v[120:123], v[84:87]
    v_mul_f32 v55, v55, v29
    v_cvt_pk_bf16_f32 v53, v54, v55
    v_mul_f32 v26, v38, v60
    v_mfma_f32_16x16x32_bf16 v[88:91], a[244:247], v[124:127], v[88:91]
    ds_read_b128 a[244:247], v2 offset:30464
    v_exp_f32 v26, v26
    v_mul_f32 v27, v38, v61
    v_mfma_f32_16x16x32_bf16 v[92:95], a[224:227], v[120:123], v[92:95]
    v_exp_f32 v27, v27
    v_fma_f32 v26, v26, v40, v40
    v_mfma_f32_16x16x32_bf16 v[96:99], a[224:227], v[124:127], v[96:99]
    s_waitcnt lgkmcnt(3)
    ds_read_b128 a[224:227], v2 offset:31488
    v_rcp_f32 v26, v26
    v_fma_f32 v27, v27, v40, v40
    v_mfma_f32_16x16x32_bf16 v[100:103], a[228:231], v[120:123], v[100:103]
    s_mov_b32 exec_lo, 0
    s_mov_b32 exec_hi, 0xf000f00
    buffer_load_dword v51, v11, s[4:7], 0 offen sc1
    s_mov_b64 exec, -1
    v_mfma_f32_16x16x32_bf16 v[104:107], a[228:231], v[124:127], v[104:107]
    ds_read_b128 a[228:231], v10 offset:14080
    v_rcp_f32 v27, v27
    v_mul_f32 v28, v38, v62
    v_mfma_f32_16x16x32_bf16 v[84:87], a[232:235], v[128:131], v[84:87]
    v_exp_f32 v28, v28
    v_mul_f32 v60, v60, v26
    v_mul_f32 v61, v61, v27
    v_mfma_f32_16x16x32_bf16 v[88:91], a[232:235], v[132:135], v[88:91]
    s_waitcnt lgkmcnt(3)
    ds_read_b128 a[232:235], v2 offset:33280
    v_mul_f32 v29, v38, v63
    v_exp_f32 v29, v29
    v_mfma_f32_16x16x32_bf16 v[92:95], a[236:239], v[128:131], v[92:95]
    v_cvt_pk_bf16_f32 v54, v60, v61
    v_fma_f32 v28, v28, v40, v40
    v_rcp_f32 v28, v28
    v_mfma_f32_16x16x32_bf16 v[96:99], a[236:239], v[132:135], v[96:99]
    ds_read_b128 a[236:239], v2 offset:34304
    v_fma_f32 v29, v29, v40, v40
    v_rcp_f32 v29, v29
    v_mfma_f32_16x16x32_bf16 v[100:103], a[240:243], v[128:131], v[100:103]
    v_mul_f32 v62, v62, v28
    v_mul_f32 v63, v63, v29
    v_cvt_pk_bf16_f32 v55, v62, v63
    v_mfma_f32_16x16x32_bf16 v[104:107], a[240:243], v[132:135], v[104:107]
    s_waitcnt lgkmcnt(3)
    ds_read_b128 a[240:243], v10 offset:16896
    v_mfma_f32_16x16x32_bf16 v[84:87], a[244:247], v[136:139], v[84:87]
    s_cmp_lg_u32 s50, 0
    s_cbranch_scc1 L_wt_22
    buffer_store_dwordx4 v[52:55], v1, s[4:7], s87 offen offset:0
L_bk_23:
    v_mfma_f32_16x16x32_bf16 v[88:91], a[244:247], v[140:143], v[88:91]
    ds_read_b128 a[244:247], v2 offset:36096
    v_mul_f32 v26, v39, v56
    v_exp_f32 v26, v26
    v_mfma_f32_16x16x32_bf16 v[92:95], a[224:227], v[136:139], v[92:95]
    v_mul_f32 v27, v39, v57
    v_exp_f32 v27, v27
    v_fma_f32 v26, v26, v41, v41
    v_mfma_f32_16x16x32_bf16 v[96:99], a[224:227], v[140:143], v[96:99]
    s_waitcnt lgkmcnt(3)
    ds_read_b128 a[224:227], v2 offset:37120
    v_rcp_f32 v26, v26
    v_fma_f32 v27, v27, v41, v41
    v_mfma_f32_16x16x32_bf16 v[100:103], a[228:231], v[136:139], v[100:103]
    v_rcp_f32 v27, v27
    v_mul_f32 v28, v39, v58
    v_mfma_f32_16x16x32_bf16 v[104:107], a[228:231], v[140:143], v[104:107]
    ds_read_b128 a[228:231], v10 offset:19712
    v_exp_f32 v28, v28
    v_mul_f32 v56, v56, v26
    v_mfma_f32_16x16x32_bf16 v[84:87], a[232:235], v[144:147], v[84:87]
    v_mul_f32 v57, v57, v27
    v_mul_f32 v29, v39, v59
    v_exp_f32 v29, v29
    v_mfma_f32_16x16x32_bf16 v[88:91], a[232:235], v[148:151], v[88:91]
    s_waitcnt lgkmcnt(3)
    ds_read_b128 a[232:235], v2 offset:38912
    v_cvt_pk_bf16_f32 v56, v56, v57
    v_fma_f32 v28, v28, v41, v41
    v_mfma_f32_16x16x32_bf16 v[92:95], a[236:239], v[144:147], v[92:95]
    v_rcp_f32 v28, v28
    v_fma_f32 v29, v29, v41, v41
    v_mfma_f32_16x16x32_bf16 v[96:99], a[236:239], v[148:151], v[96:99]
    ds_read_b128 a[236:239], v2 offset:39936
    s_add_u32 s43, s92, 32768
    buffer_load_dwordx4 a[128:131], v1, s[4:7], s43 offen offset:0 sc1
    v_rcp_f32 v29, v29
    v_mul_f32 v58, v58, v28
    v_mfma_f32_16x16x32_bf16 v[100:103], a[240:243], v[144:147], v[100:103]
    v_mul_f32 v59, v59, v29
    v_cvt_pk_bf16_f32 v57, v58, v59
    v_mul_f32 v26, v39, v64
    v_mfma_f32_16x16x32_bf16 v[104:107], a[240:243], v[148:151], v[104:107]
    s_waitcnt lgkmcnt(3)
    ds_read_b128 a[240:243], v10 offset:22528
    v_exp_f32 v26, v26
    v_mul_f32 v27, v39, v65
    v_mfma_f32_16x16x32_bf16 v[84:87], a[244:247], v[152:155], v[84:87]
    buffer_load_dwordx4 a[132:135], v1, s[4:7], s43 offen offset:1024 sc1
    v_exp_f32 v27, v27
    v_fma_f32 v26, v26, v41, v41
    v_mfma_f32_16x16x32_bf16 v[88:91], a[244:247], v[156:159], v[88:91]
    ds_read_b128 a[244:247], v2 offset:41728
    v_rcp_f32 v26, v26
    v_fma_f32 v27, v27, v41, v41
    v_mfma_f32_16x16x32_bf16 v[92:95], a[224:227], v[152:155], v[92:95]
    v_rcp_f32 v27, v27
    v_mul_f32 v28, v39, v66
    v_mfma_f32_16x16x32_bf16 v[96:99], a[224:227], v[156:159], v[96:99]
    s_waitcnt lgkmcnt(3)
    ds_read_b128 a[224:227], v2 offset:42752
    buffer_load_dwordx4 a[136:139], v1, s[4:7], s43 offen offset:2048 sc1
    v_exp_f32 v28, v28
    v_mul_f32 v64, v64, v26
    v_mfma_f32_16x16x32_bf16 v[100:103], a[228:231], v[152:155], v[100:103]
    v_mul_f32 v65, v65, v27
    v_mul_f32 v29, v39, v67
    v_exp_f32 v29, v29
    v_mfma_f32_16x16x32_bf16 v[104:107], a[228:231], v[156:159], v[104:107]
    ds_read_b128 a[228:231], v10 offset:25344
    v_cvt_pk_bf16_f32 v58, v64, v65
    v_fma_f32 v28, v28, v41, v41
    v_mfma_f32_16x16x32_bf16 v[84:87], a[232:235], v[160:163], v[84:87]
    buffer_load_dwordx4 a[140:143], v1, s[4:7], s43 offen offset:3072 sc1
    v_rcp_f32 v28, v28
    v_fma_f32 v29, v29, v41, v41
    v_mfma_f32_16x16x32_bf16 v[88:91], a[232:235], v[164:167], v[88:91]
    s_waitcnt lgkmcnt(3)
    ds_read_b128 a[232:235], v2 offset:44544
    v_rcp_f32 v29, v29
    v_mul_f32 v66, v66, v28
    v_mfma_f32_16x16x32_bf16 v[92:95], a[236:239], v[160:163], v[92:95]
    v_mul_f32 v67, v67, v29
    v_cvt_pk_bf16_f32 v59, v66, v67
    v_mfma_f32_16x16x32_bf16 v[96:99], a[236:239], v[164:167], v[96:99]
    ds_read_b128 a[236:239], v2 offset:45568
    s_add_u32 s43, s92, 36864
    buffer_load_dwordx4 a[144:147], v1, s[4:7], s43 offen offset:0 sc1
    v_mfma_f32_16x16x32_bf16 v[100:103], a[240:243], v[160:163], v[100:103]
    s_cmp_lg_u32 s50, 0
    s_cbranch_scc1 L_wt_24
    buffer_store_dwordx4 v[56:59], v6, s[4:7], s87 offen offset:0
L_bk_25:
    v_mfma_f32_16x16x32_bf16 v[104:107], a[240:243], v[164:167], v[104:107]
    s_waitcnt lgkmcnt(3)
    ds_read_b128 a[240:243], v10 offset:28160
    v_mul_f32 v26, v38, v68
    v_exp_f32 v26, v26
    v_mfma_f32_16x16x32_bf16 v[84:87], a[244:247], v[168:171], v[84:87]
    v_mul_f32 v27, v38, v69
    v_exp_f32 v27, v27
    v_fma_f32 v26, v26, v40, v40
    v_mfma_f32_16x16x32_bf16 v[88:91], a[244:247], v[172:175], v[88:91]
    ds_read_b128 a[244:247], v2 offset:47360
    buffer_load_dwordx4 a[148:151], v1, s[4:7], s43 offen offset:1024 sc1
    v_rcp_f32 v26, v26
    v_fma_f32 v27, v27, v40, v40
    v_mfma_f32_16x16x32_bf16 v[92:95], a[224:227], v[168:171], v[92:95]
    s_waitcnt vmcnt(13)
    s_barrier
    v_rcp_f32 v27, v27
    v_mul_f32 v28, v38, v70
    v_mfma_f32_16x16x32_bf16 v[96:99], a[224:227], v[172:175], v[96:99]
    s_waitcnt lgkmcnt(3)
    ds_read_b128 a[224:227], v2 offset:48384
    v_exp_f32 v28, v28
    v_mul_f32 v68, v68, v26
    v_mfma_f32_16x16x32_bf16 v[100:103], a[228:231], v[168:171], v[100:103]
    buffer_load_dwordx4 a[152:155], v1, s[4:7], s43 offen offset:2048 sc1
    v_mul_f32 v69, v69, v27
    v_mul_f32 v29, v38, v71
    v_exp_f32 v29, v29
    v_mfma_f32_16x16x32_bf16 v[104:107], a[228:231], v[172:175], v[104:107]
    ds_read_b128 a[228:231], v10 offset:30976
    v_cvt_pk_bf16_f32 v68, v68, v69
    v_fma_f32 v28, v28, v40, v40
    v_mfma_f32_16x16x32_bf16 v[84:87], a[232:235], v[176:179], v[84:87]
    v_rcp_f32 v28, v28
    v_fma_f32 v29, v29, v40, v40
    v_mfma_f32_16x16x32_bf16 v[88:91], a[232:235], v[180:183], v[88:91]
    s_waitcnt lgkmcnt(3)
    ds_read_b128 a[232:235], v2 offset:50176
    buffer_load_dwordx4 a[156:159], v1, s[4:7], s43 offen offset:3072 sc1
    v_rcp_f32 v29, v29
    v_mul_f32 v70, v70, v28
    v_mfma_f32_16x16x32_bf16 v[92:95], a[236:239], v[176:179], v[92:95]
    v_mul_f32 v71, v71, v29
    v_cvt_pk_bf16_f32 v69, v70, v71
    v_mul_f32 v26, v38, v76
    v_mfma_f32_16x16x32_bf16 v[96:99], a[236:239], v[180:183], v[96:99]
    ds_read_b128 a[236:239], v2 offset:51200
    v_exp_f32 v26, v26
    v_mul_f32 v27, v38, v77
    v_mfma_f32_16x16x32_bf16 v[100:103], a[240:243], v[176:179], v[100:103]
    s_add_u32 s43, s92, 40960
    buffer_load_dwordx4 a[160:163], v1, s[4:7], s43 offen offset:0 sc1
    v_exp_f32 v27, v27
    v_fma_f32 v26, v26, v40, v40
    v_mfma_f32_16x16x32_bf16 v[104:107], a[240:243], v[180:183], v[104:107]
    s_waitcnt lgkmcnt(3)
    ds_read_b128 a[240:243], v10 offset:33792
    v_rcp_f32 v26, v26
    v_fma_f32 v27, v27, v40, v40
    v_mfma_f32_16x16x32_bf16 v[84:87], a[244:247], v[184:187], v[84:87]
    v_rcp_f32 v27, v27
    v_mul_f32 v28, v38, v78
    v_mfma_f32_16x16x32_bf16 v[88:91], a[244:247], v[188:191], v[88:91]
    ds_read_b128 a[244:247], v2 offset:52992
    buffer_load_dwordx4 a[164:167], v1, s[4:7], s43 offen offset:1024 sc1
    v_exp_f32 v28, v28
    v_mul_f32 v76, v76, v26
    v_mfma_f32_16x16x32_bf16 v[92:95], a[224:227], v[184:187], v[92:95]
    v_mul_f32 v77, v77, v27
    v_mul_f32 v29, v38, v79
    v_exp_f32 v29, v29
    v_mfma_f32_16x16x32_bf16 v[96:99], a[224:227], v[188:191], v[96:99]
    s_waitcnt lgkmcnt(3)
    ds_read_b128 a[224:227], v2 offset:54016
    v_cvt_pk_bf16_f32 v70, v76, v77
    v_fma_f32 v28, v28, v40, v40
    v_mfma_f32_16x16x32_bf16 v[100:103], a[228:231], v[184:187], v[100:103]
    v_rcp_f32 v28, v28
    v_fma_f32 v29, v29, v40, v40
    v_mfma_f32_16x16x32_bf16 v[104:107], a[228:231], v[188:191], v[104:107]
    ds_read_b128 a[228:231], v10 offset:36608
    buffer_load_dwordx4 a[168:171], v1, s[4:7], s43 offen offset:2048 sc1
    v_rcp_f32 v29, v29
    v_mul_f32 v78, v78, v28
    v_mfma_f32_16x16x32_bf16 v[84:87], a[232:235], v[192:195], v[84:87]
    v_mul_f32 v79, v79, v29
    v_cvt_pk_bf16_f32 v71, v78, v79
    v_mfma_f32_16x16x32_bf16 v[88:91], a[232:235], v[196:199], v[88:91]
    s_waitcnt lgkmcnt(3)
    ds_read_b128 a[232:235], v2 offset:55808
    v_mfma_f32_16x16x32_bf16 v[92:95], a[236:239], v[192:195], v[92:95]
    s_cmp_lg_u32 s50, 0
    s_cbranch_scc1 L_wt_26
    buffer_store_dwordx4 v[68:71], v1, s[4:7], s87 offen offset:1024
L_bk_27:
    buffer_load_dwordx4 a[172:175], v1, s[4:7], s43 offen offset:3072 sc1
    v_mfma_f32_16x16x32_bf16 v[96:99], a[236:239], v[196:199], v[96:99]
    ds_read_b128 a[236:239], v2 offset:56832
    v_mul_f32 v26, v39, v72
    v_exp_f32 v26, v26
    v_mfma_f32_16x16x32_bf16 v[100:103], a[240:243], v[192:195], v[100:103]
    v_mul_f32 v27, v39, v73
    v_exp_f32 v27, v27
    v_fma_f32 v26, v26, v41, v41
    v_mfma_f32_16x16x32_bf16 v[104:107], a[240:243], v[196:199], v[104:107]
    s_waitcnt lgkmcnt(3)
    ds_read_b128 a[240:243], v10 offset:39424
    s_add_u32 s43, s92, 45056
    buffer_load_dwordx4 a[176:179], v1, s[4:7], s43 offen offset:0 sc1
    v_rcp_f32 v26, v26
    v_fma_f32 v27, v27, v41, v41
    v_mfma_f32_16x16x32_bf16 v[84:87], a[244:247], v[200:203], v[84:87]
    s_bfm_b64 vcc, 16, 0
    v_cndmask_b32 v32, 0, v42, vcc
    v_cndmask_b32 v33, 0, v43, vcc
    v_rcp_f32 v27, v27
    v_mfma_f32_16x16x32_bf16 v[88:91], a[244:247], v[204:207], v[88:91]
    ds_read_b128 a[244:247], v2 offset:58624
    v_mov_b32 v30, 0
    v_mov_b32 v31, 0
    v_mul_f32 v28, v39, v74
    v_mfma_f32_16x16x32_bf16 v[92:95], a[224:227], v[200:203], v[92:95]
    s_bfm_b64 vcc, 16, 0
    v_cndmask_b32 v36, 0, v44, vcc
    v_cndmask_b32 v37, 0, v45, vcc
    buffer_load_dwordx4 a[180:183], v1, s[4:7], s43 offen offset:1024 sc1
    v_exp_f32 v28, v28
    v_mfma_f32_16x16x32_bf16 v[96:99], a[224:227], v[204:207], v[96:99]
    s_waitcnt lgkmcnt(3)
    ds_read_b128 a[224:227], v2 offset:59648
    v_mov_b32 v34, 0
    v_mov_b32 v35, 0
    v_mul_f32 v72, v72, v26
    v_mfma_f32_16x16x32_bf16 v[100:103], a[228:231], v[200:203], v[100:103]
    v_mul_f32 v73, v73, v27
    v_mul_f32 v29, v39, v75
    v_exp_f32 v29, v29
    v_mfma_f32_16x16x32_bf16 v[104:107], a[228:231], v[204:207], v[104:107]
    ds_read_b128 a[228:231], v10 offset:42240
    buffer_load_dwordx4 a[184:187], v1, s[4:7], s43 offen offset:2048 sc1
    v_cvt_pk_bf16_f32 v72, v72, v73
    v_fma_f32 v28, v28, v41, v41
    v_mfma_f32_16x16x32_bf16 v[84:87], a[252:255], v[30:33], v[84:87]
    v_rcp_f32 v28, v28
    v_fma_f32 v29, v29, v41, v41
    v_mfma_f32_16x16x32_bf16 v[88:91], a[252:255], v[34:37], v[88:91]
    v_rcp_f32 v29, v29
    v_mul_f32 v74, v74, v28
    v_mul_f32 v75, v75, v29
    v_mfma_f32_16x16x32_bf16 v[84:87], a[232:235], v[208:211], v[84:87]
    v_cvt_pk_bf16_f32 v73, v74, v75
    v_mul_f32 v26, v39, v80
    v_exp_f32 v26, v26
    v_mfma_f32_16x16x32_bf16 v[88:91], a[232:235], v[212:215], v[88:91]
    s_waitcnt lgkmcnt(3)
    ds_read_b128 a[232:235], v2 offset:61440
    buffer_load_dwordx4 a[188:191], v1, s[4:7], s43 offen offset:3072 sc1
    v_mul_f32 v27, v39, v81
    v_exp_f32 v27, v27
    v_mfma_f32_16x16x32_bf16 v[92:95], a[236:239], v[208:211], v[92:95]
    v_fma_f32 v26, v26, v41, v41
    v_rcp_f32 v26, v26
    v_fma_f32 v27, v27, v41, v41
    v_mfma_f32_16x16x32_bf16 v[96:99], a[236:239], v[212:215], v[96:99]
    ds_read_b128 a[236:239], v2 offset:62464
    v_rcp_f32 v27, v27
    v_mul_f32 v28, v39, v82
    v_mfma_f32_16x16x32_bf16 v[100:103], a[240:243], v[208:211], v[100:103]
    s_add_u32 s43, s92, 49152
    buffer_load_dwordx4 a[192:195], v1, s[4:7], s43 offen offset:0 sc1
    v_exp_f32 v28, v28
    v_mul_f32 v80, v80, v26
    v_mul_f32 v81, v81, v27
    v_mfma_f32_16x16x32_bf16 v[104:107], a[240:243], v[212:215], v[104:107]
    s_waitcnt lgkmcnt(3)
    ds_read_b128 a[240:243], v10 offset:45056
    v_mul_f32 v29, v39, v83
    v_exp_f32 v29, v29
    v_mfma_f32_16x16x32_bf16 v[84:87], a[244:247], v[216:219], v[84:87]
    s_bfm_b64 vcc, 16, 32
    v_cndmask_b32 v32, 0, v42, vcc
    v_cndmask_b32 v33, 0, v43, vcc
    v_cvt_pk_bf16_f32 v74, v80, v81
    v_fma_f32 v28, v28, v41, v41
    v_mfma_f32_16x16x32_bf16 v[88:91], a[244:247], v[220:223], v[88:91]
    ds_read_b128 a[244:247], v2 offset:64256
    buffer_load_dwordx4 a[196:199], v1, s[4:7], s43 offen offset:1024 sc1
    v_rcp_f32 v28, v28
    v_fma_f32 v29, v29, v41, v41
    v_mfma_f32_16x16x32_bf16 v[92:95], a[224:227], v[216:219], v[92:95]
    s_waitcnt vmcnt(24)
    s_barrier
    s_bfm_b64 vcc, 16, 32
    v_cndmask_b32 v36, 0, v44, vcc
    v_cndmask_b32 v37, 0, v45, vcc
    v_mfma_f32_16x16x32_bf16 v[96:99], a[224:227], v[220:223], v[96:99]
    s_waitcnt lgkmcnt(3)
    ds_read_b128 a[224:227], v2 offset:65280
    v_rcp_f32 v29, v29
    v_mul_f32 v82, v82, v28
    v_mfma_f32_16x16x32_bf16 v[100:103], a[228:231], v[216:219], v[100:103]
    buffer_load_dwordx4 a[200:203], v1, s[4:7], s43 offen offset:2048 sc1
    v_mul_f32 v83, v83, v29
    v_cvt_pk_bf16_f32 v75, v82, v83
    v_mfma_f32_16x16x32_bf16 v[104:107], a[228:231], v[220:223], v[104:107]
    ds_read_b128 a[228:231], v10 offset:47872
    v_mfma_f32_16x16x32_bf16 v[92:95], a[252:255], v[30:33], v[92:95]
    s_cmp_lg_u32 s50, 0
    s_cbranch_scc1 L_wt_28
    buffer_store_dwordx4 v[72:75], v6, s[4:7], s87 offen offset:1024
L_bk_29:
    v_mfma_f32_16x16x32_bf16 v[96:99], a[252:255], v[34:37], v[96:99]
    s_add_u32 m0, s74, 0
    s_add_u32 s44, s51, 0
    buffer_load_dwordx4 v1, s[4:7], s44 offen offset:0 sc1 lds
    v_mfma_f32_16x16x32_bf16 v[84:87], a[232:235], v[224:227], v[84:87]
    v_mfma_f32_16x16x32_bf16 v[88:91], a[232:235], v[228:231], v[88:91]
    s_waitcnt lgkmcnt(3)
    ds_read_b128 a[232:235], v3 offset:1536
    v_mfma_f32_16x16x32_bf16 v[92:95], a[236:239], v[224:227], v[92:95]
    v_mfma_f32_16x16x32_bf16 v[96:99], a[236:239], v[228:231], v[96:99]
    ds_read_b128 a[236:239], v3 offset:2560
    v_mfma_f32_16x16x32_bf16 v[100:103], a[240:243], v[224:227], v[100:103]
    buffer_load_dwordx4 v1, s[4:7], s44 offen offset:1024 sc1 lds
    v_mfma_f32_16x16x32_bf16 v[104:107], a[240:243], v[228:231], v[104:107]
    s_waitcnt lgkmcnt(3)
    ds_read_b128 a[240:243], v10 offset:50688
    v_mfma_f32_16x16x32_bf16 v[84:87], a[244:247], v[232:235], v[84:87]
    s_bfm_b64 vcc, 16, 16
    v_cndmask_b32 v32, 0, v42, vcc
    v_cndmask_b32 v33, 0, v43, vcc
    buffer_load_dwordx4 v1, s[4:7], s44 offen offset:2048 sc1 lds
    v_mfma_f32_16x16x32_bf16 v[88:91], a[244:247], v[236:239], v[88:91]
    ds_read_b128 a[244:247], v3 offset:4352
    v_mfma_f32_16x16x32_bf16 v[92:95], a[224:227], v[232:235], v[92:95]
    s_bfm_b64 vcc, 16, 16
    v_cndmask_b32 v36, 0, v44, vcc
    v_cndmask_b32 v37, 0, v45, vcc
    v_mfma_f32_16x16x32_bf16 v[96:99], a[224:227], v[236:239], v[96:99]
    s_waitcnt lgkmcnt(3)
    ds_read_b128 a[224:227], v3 offset:5376
    buffer_load_dwordx4 v1, s[4:7], s44 offen offset:3072 sc1 lds
    v_mfma_f32_16x16x32_bf16 v[100:103], a[228:231], v[232:235], v[100:103]
    v_mov_b32 v50, 3
    s_waitcnt vmcnt(4)
    s_mov_b64 exec, 1
    s_cmp_lg_u32 s50, 0
    s_cbranch_scc1 L_wt_30
    buffer_store_dword v50, v0, s[4:7], s101 offen offset:0
L_bk_31:
    s_mov_b64 exec, -1
    v_mfma_f32_16x16x32_bf16 v[104:107], a[228:231], v[236:239], v[104:107]
    ds_read_b128 a[228:231], v10 offset:53504
    v_mfma_f32_16x16x32_bf16 v[100:103], a[252:255], v[30:33], v[100:103]
    s_add_u32 m0, s74, 16384
    s_add_u32 s44, s51, 16384
    buffer_load_dwordx4 v1, s[4:7], s44 offen offset:0 sc1 lds
    v_mfma_f32_16x16x32_bf16 v[104:107], a[252:255], v[34:37], v[104:107]
    v_mfma_f32_16x16x32_bf16 v[84:87], a[232:235], v[240:243], v[84:87]
    v_mfma_f32_16x16x32_bf16 v[88:91], a[232:235], v[244:247], v[88:91]
    s_waitcnt lgkmcnt(3)
    buffer_load_dwordx4 v1, s[4:7], s44 offen offset:1024 sc1 lds
    v_mfma_f32_16x16x32_bf16 v[92:95], a[236:239], v[240:243], v[92:95]
    v_mfma_f32_16x16x32_bf16 v[96:99], a[236:239], v[244:247], v[96:99]
    v_mfma_f32_16x16x32_bf16 v[100:103], a[240:243], v[240:243], v[100:103]
    v_mfma_f32_16x16x32_bf16 v[104:107], a[240:243], v[244:247], v[104:107]
    s_waitcnt lgkmcnt(1)
    buffer_load_dwordx4 v1, s[4:7], s44 offen offset:2048 sc1 lds
    v_mfma_f32_16x16x32_bf16 v[84:87], a[244:247], v[248:251], v[84:87]
    v_mfma_f32_16x16x32_bf16 v[88:91], a[244:247], v[252:255], v[88:91]
    v_mfma_f32_16x16x32_bf16 v[92:95], a[224:227], v[248:251], v[92:95]
    buffer_load_dwordx4 v1, s[4:7], s44 offen offset:3072 sc1 lds
    v_mfma_f32_16x16x32_bf16 v[96:99], a[224:227], v[252:255], v[96:99]
    s_waitcnt lgkmcnt(0)
    v_mfma_f32_16x16x32_bf16 v[100:103], a[228:231], v[248:251], v[100:103]
    v_mfma_f32_16x16x32_bf16 v[104:107], a[228:231], v[252:255], v[104:107]
    buffer_load_dword v47, v48, s[4:7], 0 offen sc1
    v_pk_mul_f32 v[26:27], v[84:85], v[38:39] op_sel:[0,0] op_sel_hi:[1,0]
    v_exp_f32 v26, v26
    v_exp_f32 v27, v27
    v_pk_mul_f32 v[28:29], v[86:87], v[38:39] op_sel:[0,0] op_sel_hi:[1,0]
    v_exp_f32 v28, v28
    v_exp_f32 v29, v29
    v_pk_fma_f32 v[26:27], v[26:27], v[40:41], v[40:41] op_sel:[0,0,0] op_sel_hi:[1,0,0]
    v_rcp_f32 v26, v26
    v_rcp_f32 v27, v27
    v_pk_fma_f32 v[28:29], v[28:29], v[40:41], v[40:41] op_sel:[0,0,0] op_sel_hi:[1,0,0]
    v_rcp_f32 v28, v28
    v_rcp_f32 v29, v29
    v_pk_mul_f32 v[84:85], v[84:85], v[26:27]
    v_cvt_pk_bf16_f32 v84, v84, v85
    v_pk_mul_f32 v[86:87], v[86:87], v[28:29]
    v_cvt_pk_bf16_f32 v85, v86, v87
    v_pk_mul_f32 v[26:27], v[92:93], v[38:39] op_sel:[0,0] op_sel_hi:[1,0]
    v_exp_f32 v26, v26
    v_exp_f32 v27, v27
    v_pk_mul_f32 v[28:29], v[94:95], v[38:39] op_sel:[0,0] op_sel_hi:[1,0]
    v_exp_f32 v28, v28
    v_exp_f32 v29, v29
    v_pk_fma_f32 v[26:27], v[26:27], v[40:41], v[40:41] op_sel:[0,0,0] op_sel_hi:[1,0,0]
    v_rcp_f32 v26, v26
    v_rcp_f32 v27, v27
    v_pk_fma_f32 v[28:29], v[28:29], v[40:41], v[40:41] op_sel:[0,0,0] op_sel_hi:[1,0,0]
    v_rcp_f32 v28, v28
    v_rcp_f32 v29, v29
    v_pk_mul_f32 v[92:93], v[92:93], v[26:27]
    v_cvt_pk_bf16_f32 v86, v92, v93
    v_pk_mul_f32 v[94:95], v[94:95], v[28:29]
    v_cvt_pk_bf16_f32 v87, v94, v95
    s_cmp_lg_u32 s50, 0
    s_cbranch_scc1 L_wt_32
    buffer_store_dwordx4 v[84:87], v1, s[4:7], s88 offen offset:0
L_bk_33:
    v_pk_mul_f32 v[26:27], v[88:89], v[38:39] op_sel:[0,1] op_sel_hi:[1,1]
    v_exp_f32 v26, v26
    v_exp_f32 v27, v27
    v_pk_mul_f32 v[28:29], v[90:91], v[38:39] op_sel:[0,1] op_sel_hi:[1,1]
    v_exp_f32 v28, v28
    v_exp_f32 v29, v29
    v_pk_fma_f32 v[26:27], v[26:27], v[40:41], v[40:41] op_sel:[0,1,1] op_sel_hi:[1,1,1]
    v_rcp_f32 v26, v26
    v_rcp_f32 v27, v27
    v_pk_fma_f32 v[28:29], v[28:29], v[40:41], v[40:41] op_sel:[0,1,1] op_sel_hi:[1,1,1]
    v_rcp_f32 v28, v28
    v_rcp_f32 v29, v29
    v_pk_mul_f32 v[88:89], v[88:89], v[26:27]
    v_cvt_pk_bf16_f32 v88, v88, v89
    v_pk_mul_f32 v[90:91], v[90:91], v[28:29]
    v_cvt_pk_bf16_f32 v89, v90, v91
    v_pk_mul_f32 v[26:27], v[96:97], v[38:39] op_sel:[0,1] op_sel_hi:[1,1]
    v_exp_f32 v26, v26
    v_exp_f32 v27, v27
    v_pk_mul_f32 v[28:29], v[98:99], v[38:39] op_sel:[0,1] op_sel_hi:[1,1]
    v_exp_f32 v28, v28
    v_exp_f32 v29, v29
    v_pk_fma_f32 v[26:27], v[26:27], v[40:41], v[40:41] op_sel:[0,1,1] op_sel_hi:[1,1,1]
    v_rcp_f32 v26, v26
    v_rcp_f32 v27, v27
    v_pk_fma_f32 v[28:29], v[28:29], v[40:41], v[40:41] op_sel:[0,1,1] op_sel_hi:[1,1,1]
    v_rcp_f32 v28, v28
    v_rcp_f32 v29, v29
    v_pk_mul_f32 v[96:97], v[96:97], v[26:27]
    v_cvt_pk_bf16_f32 v90, v96, v97
    v_pk_mul_f32 v[98:99], v[98:99], v[28:29]
    v_cvt_pk_bf16_f32 v91, v98, v99
    s_cmp_lg_u32 s50, 0
    s_cbranch_scc1 L_wt_34
    buffer_store_dwordx4 v[88:91], v6, s[4:7], s88 offen offset:0
L_bk_35:
    v_pk_mul_f32 v[26:27], v[100:101], v[38:39] op_sel:[0,0] op_sel_hi:[1,0]
    v_exp_f32 v26, v26
    v_exp_f32 v27, v27
    v_pk_mul_f32 v[28:29], v[102:103], v[38:39] op_sel:[0,0] op_sel_hi:[1,0]
    v_exp_f32 v28, v28
    v_exp_f32 v29, v29
    v_pk_fma_f32 v[26:27], v[26:27], v[40:41], v[40:41] op_sel:[0,0,0] op_sel_hi:[1,0,0]
    v_rcp_f32 v26, v26
    v_rcp_f32 v27, v27
    v_pk_fma_f32 v[28:29], v[28:29], v[40:41], v[40:41] op_sel:[0,0,0] op_sel_hi:[1,0,0]
    v_rcp_f32 v28, v28
    v_rcp_f32 v29, v29
    v_pk_mul_f32 v[100:101], v[100:101], v[26:27]
    v_cvt_pk_bf16_f32 v100, v100, v101
    s_waitcnt vmcnt(2)
    v_cmp_gt_u32 vcc, 3, v47
    s_nop 0
    s_cbranch_vccz L_ck_38ed
L_ck_38:
    s_mov_b32 s45, 200000
L_ck_38_b:
    buffer_load_dword v47, v48, s[4:7], 0 offen sc1
    s_sub_u32 s45, s45, 1
    s_cbranch_scc1 L_ck_38_c
    s_waitcnt vmcnt(0)
    v_cmp_gt_u32 vcc, 3, v47
    s_nop 0
    s_cbranch_vccnz L_ck_38_b
L_ck_38_c:
    s_waitcnt vmcnt(0)
    s_branch L_ck_38ed
L_ck_38ed:
    s_add_u32 s42, s20, 0
    buffer_load_dwordx4 v[172:175], v1, s[4:7], s42 offen offset:0 sc1
    buffer_load_dwordx4 v[176:179], v1, s[4:7], s42 offen offset:1024 sc1
    buffer_load_dwordx4 v[180:183], v1, s[4:7], s42 offen offset:2048 sc1
    buffer_load_dwordx4 v[184:187], v1, s[4:7], s42 offen offset:3072 sc1
    s_add_u32 s42, s20, 4096
    buffer_load_dwordx4 v[188:191], v1, s[4:7], s42 offen offset:0 sc1
    buffer_load_dwordx4 v[192:195], v1, s[4:7], s42 offen offset:1024 sc1
    buffer_load_dwordx4 v[196:199], v1, s[4:7], s42 offen offset:2048 sc1
    buffer_load_dwordx4 v[200:203], v1, s[4:7], s42 offen offset:3072 sc1
    v_pk_mul_f32 v[102:103], v[102:103], v[28:29]
    v_cvt_pk_bf16_f32 v101, v102, v103
    s_add_u32 s42, s21, 0
    buffer_load_dwordx4 v[204:207], v1, s[4:7], s42 offen offset:0 sc1
    v_pk_mul_f32 v[26:27], v[104:105], v[38:39] op_sel:[0,1] op_sel_hi:[1,1]
    v_exp_f32 v26, v26
    buffer_load_dwordx4 v[208:211], v1, s[4:7], s42 offen offset:1024 sc1
    v_exp_f32 v27, v27
    v_pk_mul_f32 v[28:29], v[106:107], v[38:39] op_sel:[0,1] op_sel_hi:[1,1]
    buffer_load_dwordx4 v[212:215], v1, s[4:7], s42 offen offset:2048 sc1
    v_exp_f32 v28, v28
    v_exp_f32 v29, v29
    buffer_load_dwordx4 v[216:219], v1, s[4:7], s42 offen offset:3072 sc1
    v_pk_fma_f32 v[26:27], v[26:27], v[40:41], v[40:41] op_sel:[0,1,1] op_sel_hi:[1,1,1]
    v_rcp_f32 v26, v26
    s_add_u32 s42, s21, 4096
    buffer_load_dwordx4 v[220:223], v1, s[4:7], s42 offen offset:0 sc1
    v_rcp_f32 v27, v27
    v_pk_fma_f32 v[28:29], v[28:29], v[40:41], v[40:41] op_sel:[0,1,1] op_sel_hi:[1,1,1]
    buffer_load_dwordx4 v[224:227], v1, s[4:7], s42 offen offset:1024 sc1
    v_rcp_f32 v28, v28
    v_rcp_f32 v29, v29
    buffer_load_dwordx4 v[228:231], v1, s[4:7], s42 offen offset:2048 sc1
    v_pk_mul_f32 v[104:105], v[104:105], v[26:27]
    v_cvt_pk_bf16_f32 v102, v104, v105
    buffer_load_dwordx4 v[232:235], v1, s[4:7], s42 offen offset:3072 sc1
    v_pk_mul_f32 v[106:107], v[106:107], v[28:29]
    v_cvt_pk_bf16_f32 v103, v106, v107
    v_permlane16_swap_b32 v100, v102
    s_nop 0
    v_permlane16_swap_b32 v101, v103
    s_cmp_lg_u32 s50, 0
    s_cbranch_scc1 L_wt_36
    buffer_store_dwordx4 v[100:103], v5, s[4:7], s89 offen
L_bk_37:
L_p5_0:
    s_waitcnt vmcnt(16)
    v_mfma_f32_16x16x32_bf16 v[52:55], a[0:3], v[172:175], 0
    s_add_u32 s42, s22, 0
    buffer_load_dwordx4 v[236:239], v1, s[4:7], s42 offen offset:0 sc1
    v_mfma_f32_16x16x32_bf16 v[56:59], a[4:7], v[172:175], 0
    v_and_b32 v26, 15, v0
    v_lshrrev_b32 v27, 5, v0
    v_mfma_f32_16x16x32_bf16 v[60:63], a[8:11], v[172:175], 0
    v_mov_b32 v5, s63
    v_lshl_add_u32 v6, v5, 1, v27
    v_mfma_f32_16x16x32_bf16 v[64:67], a[12:15], v[172:175], 0
    v_lshlrev_b32 v6, 8, v6
    v_mul_u32_u24 v5, 6144, v5
    v_mfma_f32_16x16x32_bf16 v[68:71], a[16:19], v[172:175], 0
    buffer_load_dwordx4 v[240:243], v1, s[4:7], s42 offen offset:1024 sc1
    s_waitcnt vmcnt(17)
    v_mfma_f32_16x16x32_bf16 v[52:55], a[20:23], v[176:179], v[52:55]
    v_add_u32 v5, v5, v1
    v_lshl_add_u32 v6, v26, 4, v6
    v_mfma_f32_16x16x32_bf16 v[56:59], a[24:27], v[176:179], v[56:59]
    v_lshlrev_b32 v7, 2, v27
    v_lshl_add_u32 v7, v26, 3, v7
    v_mfma_f32_16x16x32_bf16 v[60:63], a[28:31], v[176:179], v[60:63]
    v_bfe_u32 v27, v0, 4, 1
    v_lshl_add_u32 v6, v27, 3, v6
    v_mfma_f32_16x16x32_bf16 v[64:67], a[32:35], v[176:179], v[64:67]
    v_add_u32 v6, 0x1000, v6
    v_mov_b32 v11, s63
    v_mfma_f32_16x16x32_bf16 v[68:71], a[36:39], v[176:179], v[68:71]
    buffer_load_dwordx4 v[244:247], v1, s[4:7], s42 offen offset:2048 sc1
    s_waitcnt vmcnt(17)
    v_mfma_f32_16x16x32_bf16 v[52:55], a[40:43], v[180:183], v[52:55]
    v_mul_u32_u24 v10, 48, v11
    v_lshl_add_u32 v11, v11, 2, 32
    v_mfma_f32_16x16x32_bf16 v[56:59], a[44:47], v[180:183], v[56:59]
    v_sub_u32 v11, v11, v10
    v_bfe_i32 v51, v0, 3, 1
    v_mfma_f32_16x16x32_bf16 v[60:63], a[48:51], v[180:183], v[60:63]
    v_and_b32 v11, v11, v51
    v_add_u32 v10, v10, v11
    v_mfma_f32_16x16x32_bf16 v[64:67], a[52:55], v[180:183], v[64:67]
    buffer_load_dwordx4 v[248:251], v1, s[4:7], s42 offen offset:3072 sc1
    v_mfma_f32_16x16x32_bf16 v[68:71], a[56:59], v[180:183], v[68:71]
    v_and_b32 v11, 23, v0
    v_add_u32 v10, v10, v11
    s_waitcnt vmcnt(17)
    v_mfma_f32_16x16x32_bf16 v[52:55], a[60:63], v[184:187], v[52:55]
    v_lshl_add_u32 v10, v10, 7, s82
    v_mov_b32 v11, s84
    v_mfma_f32_16x16x32_bf16 v[56:59], a[64:67], v[184:187], v[56:59]
    v_cndmask_b32 v10, v10, v11, s[48:49]
    v_mfma_f32_16x16x32_bf16 v[60:63], a[68:71], v[184:187], v[60:63]
    v_mov_b32 v9, s3
    v_mul_u32_u24 v9, 15360, v9
    v_mfma_f32_16x16x32_bf16 v[64:67], a[72:75], v[184:187], v[64:67]
    s_add_u32 s42, s22, 4096
    buffer_load_dwordx4 v[252:255], v1, s[4:7], s42 offen offset:0 sc1
    v_mfma_f32_16x16x32_bf16 v[68:71], a[76:79], v[184:187], v[68:71]
    v_add_u32 v9, 102400, v9
    v_add_u32 v9, v9, v1
    s_waitcnt vmcnt(17)
    v_mfma_f32_16x16x32_bf16 v[52:55], a[80:83], v[188:191], v[52:55]
    v_lshlrev_b32 v26, 16, v16
    v_and_b32 v27, 0xffff0000, v16
    v_mfma_f32_16x16x32_bf16 v[56:59], a[84:87], v[188:191], v[56:59]
    v_lshlrev_b32 v28, 16, v17
    v_and_b32 v29, 0xffff0000, v17
    v_mfma_f32_16x16x32_bf16 v[60:63], a[88:91], v[188:191], v[60:63]
    buffer_load_dwordx4 a[224:227], v1, s[4:7], s42 offen offset:1024 sc1
    v_mfma_f32_16x16x32_bf16 v[64:67], a[92:95], v[188:191], v[64:67]
    v_lshlrev_b32 v30, 16, v18
    v_and_b32 v31, 0xffff0000, v18
    v_mfma_f32_16x16x32_bf16 v[68:71], a[96:99], v[188:191], v[68:71]
    v_lshlrev_b32 v32, 16, v19
    v_and_b32 v33, 0xffff0000, v19
    s_waitcnt vmcnt(17)
    v_mfma_f32_16x16x32_bf16 v[52:55], a[100:103], v[192:195], v[52:55]
    v_lshlrev_b32 v34, 16, v20
    v_and_b32 v35, 0xffff0000, v20
    v_mfma_f32_16x16x32_bf16 v[56:59], a[104:107], v[192:195], v[56:59]
    v_lshlrev_b32 v36, 16, v21
    v_and_b32 v37, 0xffff0000, v21
    v_mfma_f32_16x16x32_bf16 v[60:63], a[108:111], v[192:195], v[60:63]
    buffer_load_dwordx4 a[228:231], v1, s[4:7], s42 offen offset:2048 sc1
    v_mfma_f32_16x16x32_bf16 v[64:67], a[112:115], v[192:195], v[64:67]
    v_lshlrev_b32 v38, 16, v22
    v_and_b32 v39, 0xffff0000, v22
    v_mfma_f32_16x16x32_bf16 v[68:71], a[116:119], v[192:195], v[68:71]
    v_lshlrev_b32 v40, 16, v23
    v_and_b32 v41, 0xffff0000, v23
    s_waitcnt vmcnt(17)
    v_mfma_f32_16x16x32_bf16 v[52:55], a[120:123], v[196:199], v[52:55]
    v_mov_b32 v50, 4
    s_waitcnt vmcnt(7)
    s_mov_b64 exec, 1
    s_cmp_lg_u32 s50, 0
    s_cbranch_scc1 L_wt_39
    buffer_store_dword v50, v0, s[4:7], s101 offen offset:0
L_bk_40:
    s_mov_b64 exec, -1
    v_mfma_f32_16x16x32_bf16 v[56:59], a[124:127], v[196:199], v[56:59]
    s_barrier
    buffer_load_dwordx4 a[232:235], v1, s[4:7], s42 offen offset:3072 sc1
    v_mfma_f32_16x16x32_bf16 v[60:63], a[128:131], v[196:199], v[60:63]
    s_add_u32 s43, s92, 49152
    buffer_load_dwordx4 a[204:207], v1, s[4:7], s43 offen offset:3072 sc1
    v_mfma_f32_16x16x32_bf16 v[64:67], a[132:135], v[196:199], v[64:67]
    v_lshlrev_b32 v42, 16, v24
    v_and_b32 v43, 0xffff0000, v24
    v_mfma_f32_16x16x32_bf16 v[68:71], a[136:139], v[196:199], v[68:71]
    v_lshlrev_b32 v44, 16, v25
    v_and_b32 v45, 0xffff0000, v25
    v_mfma_f32_16x16x32_bf16 v[52:55], a[140:143], v[200:203], v[52:55]
    s_add_u32 s43, s92, 53248
    buffer_load_dwordx4 a[208:211], v1, s[4:7], s43 offen offset:0 sc1
    v_mfma_f32_16x16x32_bf16 v[56:59], a[144:147], v[200:203], v[56:59]
    v_mfma_f32_16x16x32_bf16 v[60:63], a[148:151], v[200:203], v[60:63]
    v_mfma_f32_16x16x32_bf16 v[64:67], a[152:155], v[200:203], v[64:67]
    buffer_load_dwordx4 a[212:215], v1, s[4:7], s43 offen offset:1024 sc1
    v_mfma_f32_16x16x32_bf16 v[68:71], a[156:159], v[200:203], v[68:71]
    v_mfma_f32_16x16x32_bf16 v[72:75], a[0:3], v[204:207], 0
    v_mfma_f32_16x16x32_bf16 v[76:79], a[4:7], v[204:207], 0
    buffer_load_dwordx4 a[216:219], v1, s[4:7], s43 offen offset:2048 sc1
    v_mfma_f32_16x16x32_bf16 v[80:83], a[8:11], v[204:207], 0
    v_mfma_f32_16x16x32_bf16 v[84:87], a[12:15], v[204:207], 0
    v_mfma_f32_16x16x32_bf16 v[88:91], a[16:19], v[204:207], 0
    buffer_load_dwordx4 a[220:223], v1, s[4:7], s43 offen offset:3072 sc1
    v_mfma_f32_16x16x32_bf16 v[72:75], a[20:23], v[208:211], v[72:75]
    v_mfma_f32_16x16x32_bf16 v[76:79], a[24:27], v[208:211], v[76:79]
    v_mfma_f32_16x16x32_bf16 v[80:83], a[28:31], v[208:211], v[80:83]
    s_add_u32 s43, s92, 57344
    buffer_load_dwordx4 v[116:119], v1, s[4:7], s43 offen offset:0 sc1
    v_mfma_f32_16x16x32_bf16 v[84:87], a[32:35], v[208:211], v[84:87]
    v_mfma_f32_16x16x32_bf16 v[88:91], a[36:39], v[208:211], v[88:91]
    v_mfma_f32_16x16x32_bf16 v[72:75], a[40:43], v[212:215], v[72:75]
    buffer_load_dword v47, v48, s[4:7], 0 offen sc1
    v_mfma_f32_16x16x32_bf16 v[76:79], a[44:47], v[212:215], v[76:79]
    buffer_load_dwordx4 v[120:123], v1, s[4:7], s43 offen offset:1024 sc1
    v_mfma_f32_16x16x32_bf16 v[80:83], a[48:51], v[212:215], v[80:83]
    v_mfma_f32_16x16x32_bf16 v[84:87], a[52:55], v[212:215], v[84:87]
    buffer_load_dwordx4 v[124:127], v1, s[4:7], s43 offen offset:2048 sc1
    v_mfma_f32_16x16x32_bf16 v[88:91], a[56:59], v[212:215], v[88:91]
    v_mfma_f32_16x16x32_bf16 v[72:75], a[60:63], v[216:219], v[72:75]
    v_mfma_f32_16x16x32_bf16 v[76:79], a[64:67], v[216:219], v[76:79]
    buffer_load_dwordx4 v[128:131], v1, s[4:7], s43 offen offset:3072 sc1
    v_mfma_f32_16x16x32_bf16 v[80:83], a[68:71], v[216:219], v[80:83]
    v_mfma_f32_16x16x32_bf16 v[84:87], a[72:75], v[216:219], v[84:87]
    v_mfma_f32_16x16x32_bf16 v[88:91], a[76:79], v[216:219], v[88:91]
    s_add_u32 s43, s92, 61440
    buffer_load_dwordx4 v[132:135], v1, s[4:7], s43 offen offset:0 sc1
    v_mfma_f32_16x16x32_bf16 v[72:75], a[80:83], v[220:223], v[72:75]
    v_mfma_f32_16x16x32_bf16 v[76:79], a[84:87], v[220:223], v[76:79]
    v_mfma_f32_16x16x32_bf16 v[80:83], a[88:91], v[220:223], v[80:83]
    buffer_load_dwordx4 v[136:139], v1, s[4:7], s43 offen offset:1024 sc1
    v_mfma_f32_16x16x32_bf16 v[84:87], a[92:95], v[220:223], v[84:87]
    v_mfma_f32_16x16x32_bf16 v[88:91], a[96:99], v[220:223], v[88:91]
    v_mfma_f32_16x16x32_bf16 v[72:75], a[100:103], v[224:227], v[72:75]
    buffer_load_dwordx4 v[140:143], v1, s[4:7], s43 offen offset:2048 sc1
    v_mfma_f32_16x16x32_bf16 v[76:79], a[104:107], v[224:227], v[76:79]
    v_mfma_f32_16x16x32_bf16 v[80:83], a[108:111], v[224:227], v[80:83]
    v_mfma_f32_16x16x32_bf16 v[84:87], a[112:115], v[224:227], v[84:87]
    buffer_load_dwordx4 v[144:147], v1, s[4:7], s43 offen offset:3072 sc1
    v_mfma_f32_16x16x32_bf16 v[88:91], a[116:119], v[224:227], v[88:91]
    v_mfma_f32_16x16x32_bf16 v[72:75], a[120:123], v[228:231], v[72:75]
    v_mfma_f32_16x16x32_bf16 v[76:79], a[124:127], v[228:231], v[76:79]
    s_add_u32 s43, s92, 65536
    buffer_load_dwordx4 v[148:151], v1, s[4:7], s43 offen offset:0 sc1
    v_mfma_f32_16x16x32_bf16 v[80:83], a[128:131], v[228:231], v[80:83]
    v_mfma_f32_16x16x32_bf16 v[84:87], a[132:135], v[228:231], v[84:87]
    v_mfma_f32_16x16x32_bf16 v[88:91], a[136:139], v[228:231], v[88:91]
    buffer_load_dwordx4 v[152:155], v1, s[4:7], s43 offen offset:1024 sc1
    v_mfma_f32_16x16x32_bf16 v[72:75], a[140:143], v[232:235], v[72:75]
    v_mfma_f32_16x16x32_bf16 v[76:79], a[144:147], v[232:235], v[76:79]
    v_mfma_f32_16x16x32_bf16 v[80:83], a[148:151], v[232:235], v[80:83]
    buffer_load_dwordx4 v[156:159], v1, s[4:7], s43 offen offset:2048 sc1
    v_mfma_f32_16x16x32_bf16 v[84:87], a[152:155], v[232:235], v[84:87]
    v_mfma_f32_16x16x32_bf16 v[88:91], a[156:159], v[232:235], v[88:91]
    s_waitcnt vmcnt(25)
    v_mfma_f32_16x16x32_bf16 v[92:95], a[0:3], v[236:239], 0
    buffer_load_dwordx4 v[160:163], v1, s[4:7], s43 offen offset:3072 sc1
    v_mfma_f32_16x16x32_bf16 v[96:99], a[4:7], v[236:239], 0
    v_mfma_f32_16x16x32_bf16 v[100:103], a[8:11], v[236:239], 0
    v_mfma_f32_16x16x32_bf16 v[104:107], a[12:15], v[236:239], 0
    s_add_u32 s43, s92, 69632
    buffer_load_dwordx4 v[164:167], v1, s[4:7], s43 offen offset:0 sc1
    v_mfma_f32_16x16x32_bf16 v[108:111], a[16:19], v[236:239], 0
    s_waitcnt vmcnt(26)
    v_mfma_f32_16x16x32_bf16 v[92:95], a[20:23], v[240:243], v[92:95]
    v_mfma_f32_16x16x32_bf16 v[96:99], a[24:27], v[240:243], v[96:99]
    buffer_load_dwordx4 v[168:171], v1, s[4:7], s43 offen offset:1024 sc1
    v_mfma_f32_16x16x32_bf16 v[100:103], a[28:31], v[240:243], v[100:103]
    v_mfma_f32_16x16x32_bf16 v[104:107], a[32:35], v[240:243], v[104:107]
    v_mfma_f32_16x16x32_bf16 v[108:111], a[36:39], v[240:243], v[108:111]
    s_waitcnt vmcnt(26)
    v_mfma_f32_16x16x32_bf16 v[92:95], a[40:43], v[244:247], v[92:95]
    v_mfma_f32_16x16x32_bf16 v[96:99], a[44:47], v[244:247], v[96:99]
    v_mfma_f32_16x16x32_bf16 v[100:103], a[48:51], v[244:247], v[100:103]
    s_waitcnt vmcnt(13)
    v_cmp_gt_u32 vcc, 4, v47
    s_nop 0
    s_cbranch_vccz L_ck_41ed
L_ck_41:
    s_mov_b32 s45, 200000
L_ck_41_b:
    buffer_load_dword v47, v48, s[4:7], 0 offen sc1
    s_sub_u32 s45, s45, 1
    s_cbranch_scc1 L_ck_41_c
    s_waitcnt vmcnt(0)
    v_cmp_gt_u32 vcc, 4, v47
    s_nop 0
    s_cbranch_vccnz L_ck_41_b
L_ck_41_c:
    s_waitcnt vmcnt(0)
    s_branch L_ck_41ed
L_ck_41ed:
    s_add_u32 s42, s20, 8192
    buffer_load_dwordx4 a[236:239], v1, s[4:7], s42 offen offset:0 sc1
    buffer_load_dwordx4 a[240:243], v1, s[4:7], s42 offen offset:1024 sc1
    buffer_load_dwordx4 a[244:247], v1, s[4:7], s42 offen offset:2048 sc1
    v_mfma_f32_16x16x32_bf16 v[104:107], a[52:55], v[244:247], v[104:107]
    v_mfma_f32_16x16x32_bf16 v[108:111], a[56:59], v[244:247], v[108:111]
    v_mfma_f32_16x16x32_bf16 v[92:95], a[60:63], v[248:251], v[92:95]
    v_mfma_f32_16x16x32_bf16 v[96:99], a[64:67], v[248:251], v[96:99]
    buffer_load_dwordx4 v[172:175], v1, s[4:7], s42 offen offset:3072 sc1
    v_mfma_f32_16x16x32_bf16 v[100:103], a[68:71], v[248:251], v[100:103]
    v_mfma_f32_16x16x32_bf16 v[104:107], a[72:75], v[248:251], v[104:107]
    v_mfma_f32_16x16x32_bf16 v[108:111], a[76:79], v[248:251], v[108:111]
    v_mfma_f32_16x16x32_bf16 v[92:95], a[80:83], v[252:255], v[92:95]
    v_mfma_f32_16x16x32_bf16 v[96:99], a[84:87], v[252:255], v[96:99]
    s_add_u32 s42, s20, 12288
    buffer_load_dwordx4 v[176:179], v1, s[4:7], s42 offen offset:0 sc1
    v_mfma_f32_16x16x32_bf16 v[100:103], a[88:91], v[252:255], v[100:103]
    v_mfma_f32_16x16x32_bf16 v[104:107], a[92:95], v[252:255], v[104:107]
    v_mfma_f32_16x16x32_bf16 v[108:111], a[96:99], v[252:255], v[108:111]
    v_mfma_f32_16x16x32_bf16 v[92:95], a[100:103], a[224:227], v[92:95]
    buffer_load_dwordx4 v[180:183], v1, s[4:7], s42 offen offset:1024 sc1
    v_mfma_f32_16x16x32_bf16 v[96:99], a[104:107], a[224:227], v[96:99]
    v_mfma_f32_16x16x32_bf16 v[100:103], a[108:111], a[224:227], v[100:103]
    v_mfma_f32_16x16x32_bf16 v[104:107], a[112:115], a[224:227], v[104:107]
    v_mfma_f32_16x16x32_bf16 v[108:111], a[116:119], a[224:227], v[108:111]
    v_mfma_f32_16x16x32_bf16 v[92:95], a[120:123], a[228:231], v[92:95]
    s_add_u32 s42, s21, 8192
    buffer_load_dwordx4 v[184:187], v1, s[4:7], s42 offen offset:0 sc1
    v_mfma_f32_16x16x32_bf16 v[96:99], a[124:127], a[228:231], v[96:99]
    v_mfma_f32_16x16x32_bf16 v[100:103], a[128:131], a[228:231], v[100:103]
    v_mfma_f32_16x16x32_bf16 v[104:107], a[132:135], a[228:231], v[104:107]
    v_mfma_f32_16x16x32_bf16 v[108:111], a[136:139], a[228:231], v[108:111]
    buffer_load_dwordx4 v[188:191], v1, s[4:7], s42 offen offset:1024 sc1
    v_mfma_f32_16x16x32_bf16 v[92:95], a[140:143], a[232:235], v[92:95]
    v_mfma_f32_16x16x32_bf16 v[96:99], a[144:147], a[232:235], v[96:99]
    v_mfma_f32_16x16x32_bf16 v[100:103], a[148:151], a[232:235], v[100:103]
    v_mfma_f32_16x16x32_bf16 v[104:107], a[152:155], a[232:235], v[104:107]
    v_mfma_f32_16x16x32_bf16 v[108:111], a[156:159], a[232:235], v[108:111]
    buffer_load_dwordx4 v[192:195], v1, s[4:7], s42 offen offset:2048 sc1
    s_waitcnt vmcnt(8)
    v_mfma_f32_16x16x32_bf16 v[52:55], a[160:163], a[236:239], v[52:55]
    v_mfma_f32_16x16x32_bf16 v[56:59], a[164:167], a[236:239], v[56:59]
    v_mfma_f32_16x16x32_bf16 v[60:63], a[168:171], a[236:239], v[60:63]
    v_mfma_f32_16x16x32_bf16 v[64:67], a[172:175], a[236:239], v[64:67]
    buffer_load_dwordx4 v[196:199], v1, s[4:7], s42 offen offset:3072 sc1
    v_mfma_f32_16x16x32_bf16 v[68:71], a[176:179], a[236:239], v[68:71]
    s_waitcnt vmcnt(8)
    v_mfma_f32_16x16x32_bf16 v[52:55], a[180:183], a[240:243], v[52:55]
    v_mfma_f32_16x16x32_bf16 v[56:59], a[184:187], a[240:243], v[56:59]
    v_mfma_f32_16x16x32_bf16 v[60:63], a[188:191], a[240:243], v[60:63]
    v_mfma_f32_16x16x32_bf16 v[64:67], a[192:195], a[240:243], v[64:67]
    s_add_u32 s42, s21, 12288
    buffer_load_dwordx4 v[200:203], v1, s[4:7], s42 offen offset:0 sc1
    v_mfma_f32_16x16x32_bf16 v[68:71], a[196:199], a[240:243], v[68:71]
    s_waitcnt vmcnt(8)
    v_mfma_f32_16x16x32_bf16 v[52:55], a[200:203], a[244:247], v[52:55]
    v_mfma_f32_16x16x32_bf16 v[56:59], a[204:207], a[244:247], v[56:59]
    v_mfma_f32_16x16x32_bf16 v[60:63], a[208:211], a[244:247], v[60:63]
    buffer_load_dwordx4 v[204:207], v1, s[4:7], s42 offen offset:1024 sc1
    v_mfma_f32_16x16x32_bf16 v[64:67], a[212:215], a[244:247], v[64:67]
    v_mfma_f32_16x16x32_bf16 v[68:71], a[216:219], a[244:247], v[68:71]
    s_waitcnt vmcnt(8)
    v_mfma_f32_16x16x32_bf16 v[52:55], a[220:223], v[172:175], v[52:55]
    v_mfma_f32_16x16x32_bf16 v[56:59], v[116:119], v[172:175], v[56:59]
    v_mfma_f32_16x16x32_bf16 v[60:63], v[120:123], v[172:175], v[60:63]
    s_add_u32 s42, s22, 8192
    buffer_load_dwordx4 v[208:211], v1, s[4:7], s42 offen offset:0 sc1
    v_mfma_f32_16x16x32_bf16 v[64:67], v[124:127], v[172:175], v[64:67]
    v_mfma_f32_16x16x32_bf16 v[68:71], v[128:131], v[172:175], v[68:71]
    s_waitcnt vmcnt(8)
    v_mfma_f32_16x16x32_bf16 v[52:55], v[132:135], v[176:179], v[52:55]
    v_mfma_f32_16x16x32_bf16 v[56:59], v[136:139], v[176:179], v[56:59]
    buffer_load_dwordx4 v[212:215], v1, s[4:7], s42 offen offset:1024 sc1
    v_mfma_f32_16x16x32_bf16 v[60:63], v[140:143], v[176:179], v[60:63]
    v_mfma_f32_16x16x32_bf16 v[64:67], v[144:147], v[176:179], v[64:67]
    v_mfma_f32_16x16x32_bf16 v[68:71], v[148:151], v[176:179], v[68:71]
    s_waitcnt vmcnt(8)
    v_mfma_f32_16x16x32_bf16 v[52:55], v[152:155], v[180:183], v[52:55]
    v_mfma_f32_16x16x32_bf16 v[56:59], v[156:159], v[180:183], v[56:59]
    buffer_load_dwordx4 v[216:219], v1, s[4:7], s42 offen offset:2048 sc1
    v_mfma_f32_16x16x32_bf16 v[60:63], v[160:163], v[180:183], v[60:63]
    v_mfma_f32_16x16x32_bf16 v[64:67], v[164:167], v[180:183], v[64:67]
    v_mfma_f32_16x16x32_bf16 v[68:71], v[168:171], v[180:183], v[68:71]
    s_waitcnt vmcnt(8)
    v_mfma_f32_16x16x32_bf16 v[72:75], a[160:163], v[184:187], v[72:75]
    buffer_load_dwordx4 v[220:223], v1, s[4:7], s42 offen offset:3072 sc1
    s_mul_i32 s41, s16, 15360
    s_add_u32 s41, s41, 102400
    v_mfma_f32_16x16x32_bf16 v[76:79], a[164:167], v[184:187], v[76:79]
    s_mov_b32 exec_lo, 0xff0fff
    s_mov_b32 exec_hi, 1
    buffer_load_dword v51, v10, s[4:7], 0 offen sc1
    s_mov_b64 exec, -1
    v_add_u32 v8, s41, v1
    v_mfma_f32_16x16x32_bf16 v[80:83], a[168:171], v[184:187], v[80:83]
    ds_write_b128 v8, v[52:55] offset:0
    v_mfma_f32_16x16x32_bf16 v[84:87], a[172:175], v[184:187], v[84:87]
    v_mfma_f32_16x16x32_bf16 v[88:91], a[176:179], v[184:187], v[88:91]
    s_waitcnt vmcnt(9)
    v_mfma_f32_16x16x32_bf16 v[72:75], a[180:183], v[188:191], v[72:75]
    s_add_u32 s42, s22, 12288
    buffer_load_dwordx4 v[224:227], v1, s[4:7], s42 offen offset:0 sc1
    v_mfma_f32_16x16x32_bf16 v[76:79], a[184:187], v[188:191], v[76:79]
    ds_write_b128 v8, v[56:59] offset:1024
    v_mfma_f32_16x16x32_bf16 v[80:83], a[188:191], v[188:191], v[80:83]
    v_mfma_f32_16x16x32_bf16 v[84:87], a[192:195], v[188:191], v[84:87]
    v_mfma_f32_16x16x32_bf16 v[88:91], a[196:199], v[188:191], v[88:91]
    buffer_load_dwordx4 v[228:231], v1, s[4:7], s42 offen offset:1024 sc1
    s_waitcnt vmcnt(10)
    v_mfma_f32_16x16x32_bf16 v[72:75], a[200:203], v[192:195], v[72:75]
    ds_write_b128 v8, v[60:63] offset:2048
    v_mfma_f32_16x16x32_bf16 v[76:79], a[204:207], v[192:195], v[76:79]
    v_mfma_f32_16x16x32_bf16 v[80:83], a[208:211], v[192:195], v[80:83]
    v_mfma_f32_16x16x32_bf16 v[84:87], a[212:215], v[192:195], v[84:87]
    v_mfma_f32_16x16x32_bf16 v[88:91], a[216:219], v[192:195], v[88:91]
    s_add_u32 s42, s23, 0
    buffer_load_dwordx4 v[232:235], v1, s[4:7], s42 offen offset:0 sc1
    ds_write_b128 v8, v[64:67] offset:3072
    s_waitcnt vmcnt(10)
    v_mfma_f32_16x16x32_bf16 v[72:75], a[220:223], v[196:199], v[72:75]
    s_add_u32 m0, s74, 32768
    s_add_u32 s44, s51, 32768
    buffer_load_dwordx4 v1, s[4:7], s44 offen offset:0 sc1 lds
    v_mfma_f32_16x16x32_bf16 v[76:79], v[116:119], v[196:199], v[76:79]
    v_mfma_f32_16x16x32_bf16 v[80:83], v[120:123], v[196:199], v[80:83]
    v_mfma_f32_16x16x32_bf16 v[84:87], v[124:127], v[196:199], v[84:87]
    buffer_load_dwordx4 v[236:239], v1, s[4:7], s42 offen offset:1024 sc1
    ds_write_b128 v8, v[68:71] offset:4096
    v_mfma_f32_16x16x32_bf16 v[88:91], v[128:131], v[196:199], v[88:91]
    s_waitcnt vmcnt(11)
    v_mfma_f32_16x16x32_bf16 v[72:75], v[132:135], v[200:203], v[72:75]
    v_mfma_f32_16x16x32_bf16 v[76:79], v[136:139], v[200:203], v[76:79]
    buffer_load_dwordx4 v1, s[4:7], s44 offen offset:1024 sc1 lds
    v_mfma_f32_16x16x32_bf16 v[80:83], v[140:143], v[200:203], v[80:83]
    v_mfma_f32_16x16x32_bf16 v[84:87], v[144:147], v[200:203], v[84:87]
    buffer_load_dwordx4 v[240:243], v1, s[4:7], s42 offen offset:2048 sc1
    v_mfma_f32_16x16x32_bf16 v[88:91], v[148:151], v[200:203], v[88:91]
    s_waitcnt vmcnt(12)
    v_mfma_f32_16x16x32_bf16 v[72:75], v[152:155], v[204:207], v[72:75]
    v_mfma_f32_16x16x32_bf16 v[76:79], v[156:159], v[204:207], v[76:79]
    v_mfma_f32_16x16x32_bf16 v[80:83], v[160:163], v[204:207], v[80:83]
    buffer_load_dwordx4 v[244:247], v1, s[4:7], s42 offen offset:3072 sc1
    v_mfma_f32_16x16x32_bf16 v[84:87], v[164:167], v[204:207], v[84:87]
    buffer_load_dwordx4 v1, s[4:7], s44 offen offset:2048 sc1 lds
    v_mfma_f32_16x16x32_bf16 v[88:91], v[168:171], v[204:207], v[88:91]
    s_waitcnt vmcnt(13)
    v_mfma_f32_16x16x32_bf16 v[92:95], a[160:163], v[208:211], v[92:95]
    s_mul_i32 s41, s17, 15360
    s_add_u32 s41, s41, 107520
    v_mfma_f32_16x16x32_bf16 v[96:99], a[164:167], v[208:211], v[96:99]
    v_add_u32 v8, s41, v1
    v_mfma_f32_16x16x32_bf16 v[100:103], a[168:171], v[208:211], v[100:103]
    s_add_u32 s42, s23, 4096
    buffer_load_dwordx4 v[248:251], v1, s[4:7], s42 offen offset:0 sc1
    ds_write_b128 v8, v[72:75] offset:0
    v_mfma_f32_16x16x32_bf16 v[104:107], a[172:175], v[208:211], v[104:107]
    buffer_load_dwordx4 v1, s[4:7], s44 offen offset:3072 sc1 lds
    v_mfma_f32_16x16x32_bf16 v[108:111], a[176:179], v[208:211], v[108:111]
    s_waitcnt vmcnt(14)
    v_mfma_f32_16x16x32_bf16 v[92:95], a[180:183], v[212:215], v[92:95]
    v_mfma_f32_16x16x32_bf16 v[96:99], a[184:187], v[212:215], v[96:99]
    buffer_load_dwordx4 v[252:255], v1, s[4:7], s42 offen offset:1024 sc1
    ds_write_b128 v8, v[76:79] offset:1024
    v_mfma_f32_16x16x32_bf16 v[100:103], a[188:191], v[212:215], v[100:103]
    v_mfma_f32_16x16x32_bf16 v[104:107], a[192:195], v[212:215], v[104:107]
    v_mfma_f32_16x16x32_bf16 v[108:111], a[196:199], v[212:215], v[108:111]
    s_add_u32 m0, s74, 49152
    s_add_u32 s44, s51, 49152
    buffer_load_dwordx4 v1, s[4:7], s44 offen offset:0 sc1 lds
    s_waitcnt vmcnt(15)
    v_mfma_f32_16x16x32_bf16 v[92:95], a[200:203], v[216:219], v[92:95]
    ds_write_b128 v8, v[80:83] offset:2048
    v_mfma_f32_16x16x32_bf16 v[96:99], a[204:207], v[216:219], v[96:99]
    buffer_load_dwordx4 a[224:227], v1, s[4:7], s42 offen offset:2048 sc1
    v_mfma_f32_16x16x32_bf16 v[100:103], a[208:211], v[216:219], v[100:103]
    v_mfma_f32_16x16x32_bf16 v[104:107], a[212:215], v[216:219], v[104:107]
    v_mfma_f32_16x16x32_bf16 v[108:111], a[216:219], v[216:219], v[108:111]
    ds_write_b128 v8, v[84:87] offset:3072
    s_waitcnt vmcnt(15)
    v_mfma_f32_16x16x32_bf16 v[92:95], a[220:223], v[220:223], v[92:95]
    buffer_load_dwordx4 a[228:231], v1, s[4:7], s42 offen offset:3072 sc1
    v_mfma_f32_16x16x32_bf16 v[96:99], v[116:119], v[220:223], v[96:99]
    buffer_load_dwordx4 v1, s[4:7], s44 offen offset:1024 sc1 lds
    v_mfma_f32_16x16x32_bf16 v[100:103], v[120:123], v[220:223], v[100:103]
    v_mfma_f32_16x16x32_bf16 v[104:107], v[124:127], v[220:223], v[104:107]
    ds_write_b128 v8, v[88:91] offset:4096
    v_mfma_f32_16x16x32_bf16 v[108:111], v[128:131], v[220:223], v[108:111]
    s_waitcnt vmcnt(15)
    v_mfma_f32_16x16x32_bf16 v[92:95], v[132:135], v[224:227], v[92:95]
    s_add_u32 s42, s23, 8192
    buffer_load_dwordx4 a[232:235], v1, s[4:7], s42 offen offset:0 sc1
    v_mfma_f32_16x16x32_bf16 v[96:99], v[136:139], v[224:227], v[96:99]
    buffer_load_dwordx4 v1, s[4:7], s44 offen offset:2048 sc1 lds
    v_mfma_f32_16x16x32_bf16 v[100:103], v[140:143], v[224:227], v[100:103]
    v_mfma_f32_16x16x32_bf16 v[104:107], v[144:147], v[224:227], v[104:107]
    v_mfma_f32_16x16x32_bf16 v[108:111], v[148:151], v[224:227], v[108:111]
    buffer_load_dwordx4 a[236:239], v1, s[4:7], s42 offen offset:1024 sc1
    s_waitcnt vmcnt(17)
    v_mfma_f32_16x16x32_bf16 v[92:95], v[152:155], v[228:231], v[92:95]
    v_mfma_f32_16x16x32_bf16 v[96:99], v[156:159], v[228:231], v[96:99]
    v_mfma_f32_16x16x32_bf16 v[100:103], v[160:163], v[228:231], v[100:103]
    buffer_load_dwordx4 v1, s[4:7], s44 offen offset:3072 sc1 lds
    v_mfma_f32_16x16x32_bf16 v[104:107], v[164:167], v[228:231], v[104:107]
    v_mfma_f32_16x16x32_bf16 v[108:111], v[168:171], v[228:231], v[108:111]
    buffer_load_dwordx4 a[240:243], v1, s[4:7], s42 offen offset:2048 sc1
    s_waitcnt vmcnt(18)
    v_mfma_f32_16x16x32_bf16 v[26:29], a[0:3], v[232:235], v[26:29]
    s_mul_i32 s41, s18, 15360
    s_add_u32 s41, s41, 112640
    v_mfma_f32_16x16x32_bf16 v[30:33], a[4:7], v[232:235], v[30:33]
    v_add_u32 v8, s41, v1
    v_mfma_f32_16x16x32_bf16 v[34:37], a[8:11], v[232:235], v[34:37]
    ds_write_b128 v8, v[92:95] offset:0
    v_mfma_f32_16x16x32_bf16 v[38:41], a[12:15], v[232:235], v[38:41]
    buffer_load_dwordx4 a[244:247], v1, s[4:7], s42 offen offset:3072 sc1
    v_mfma_f32_16x16x32_bf16 v[42:45], a[16:19], v[232:235], v[42:45]
    s_add_u32 m0, s74, 65536
    s_add_u32 s44, s51, 65536
    buffer_load_dwordx4 v1, s[4:7], s44 offen offset:0 sc1 lds
    s_waitcnt vmcnt(18)
    v_mfma_f32_16x16x32_bf16 v[26:29], a[20:23], v[236:239], v[26:29]
    v_mfma_f32_16x16x32_bf16 v[30:33], a[24:27], v[236:239], v[30:33]
    ds_write_b128 v8, v[96:99] offset:1024
    v_mfma_f32_16x16x32_bf16 v[34:37], a[28:31], v[236:239], v[34:37]
    v_mfma_f32_16x16x32_bf16 v[38:41], a[32:35], v[236:239], v[38:41]
    s_add_u32 s42, s23, 12288
    buffer_load_dwordx4 v[172:175], v1, s[4:7], s42 offen offset:0 sc1
    v_mfma_f32_16x16x32_bf16 v[42:45], a[36:39], v[236:239], v[42:45]
    buffer_load_dwordx4 v1, s[4:7], s44 offen offset:1024 sc1 lds
    s_waitcnt vmcnt(18)
    v_mfma_f32_16x16x32_bf16 v[26:29], a[40:43], v[240:243], v[26:29]
    ds_write_b128 v8, v[100:103] offset:2048
    v_mfma_f32_16x16x32_bf16 v[30:33], a[44:47], v[240:243], v[30:33]
    v_mfma_f32_16x16x32_bf16 v[34:37], a[48:51], v[240:243], v[34:37]
    buffer_load_dwordx4 v[176:179], v1, s[4:7], s42 offen offset:1024 sc1
    v_mfma_f32_16x16x32_bf16 v[38:41], a[52:55], v[240:243], v[38:41]
    v_mfma_f32_16x16x32_bf16 v[42:45], a[56:59], v[240:243], v[42:45]
    ds_write_b128 v8, v[104:107] offset:3072
    s_waitcnt vmcnt(18)
    v_mfma_f32_16x16x32_bf16 v[26:29], a[60:63], v[244:247], v[26:29]
    buffer_load_dwordx4 v1, s[4:7], s44 offen offset:2048 sc1 lds
    v_mfma_f32_16x16x32_bf16 v[30:33], a[64:67], v[244:247], v[30:33]
    v_mfma_f32_16x16x32_bf16 v[34:37], a[68:71], v[244:247], v[34:37]
    v_mfma_f32_16x16x32_bf16 v[38:41], a[72:75], v[244:247], v[38:41]
    ds_write_b128 v8, v[108:111] offset:4096
    v_mfma_f32_16x16x32_bf16 v[42:45], a[76:79], v[244:247], v[42:45]
    s_waitcnt vmcnt(17)
    v_mfma_f32_16x16x32_bf16 v[26:29], a[80:83], v[248:251], v[26:29]
    v_mfma_f32_16x16x32_bf16 v[30:33], a[84:87], v[248:251], v[30:33]
    buffer_load_dwordx4 v1, s[4:7], s44 offen offset:3072 sc1 lds
    v_mfma_f32_16x16x32_bf16 v[34:37], a[88:91], v[248:251], v[34:37]
    s_waitcnt lgkmcnt(0)
    s_barrier
    ds_read_b128 v[52:55], v9 offset:0
    v_mfma_f32_16x16x32_bf16 v[38:41], a[92:95], v[248:251], v[38:41]
    ds_read_b128 v[56:59], v9 offset:1024
    v_mfma_f32_16x16x32_bf16 v[42:45], a[96:99], v[248:251], v[42:45]
    ds_read_b128 v[60:63], v9 offset:2048
    s_waitcnt vmcnt(16)
    v_mfma_f32_16x16x32_bf16 v[26:29], a[100:103], v[252:255], v[26:29]
    ds_read_b128 v[64:67], v9 offset:3072
    v_mfma_f32_16x16x32_bf16 v[30:33], a[104:107], v[252:255], v[30:33]
    ds_read_b128 v[68:71], v9 offset:4096
    v_mfma_f32_16x16x32_bf16 v[34:37], a[108:111], v[252:255], v[34:37]
    s_add_u32 m0, s74, 81920
    s_add_u32 s44, s51, 81920
    buffer_load_dwordx4 v1, s[4:7], s44 offen offset:0 sc1 lds
    v_mfma_f32_16x16x32_bf16 v[38:41], a[112:115], v[252:255], v[38:41]
    ds_read_b128 v[72:75], v9 offset:5120
    v_mfma_f32_16x16x32_bf16 v[42:45], a[116:119], v[252:255], v[42:45]
    ds_read_b128 v[76:79], v9 offset:6144
    s_waitcnt vmcnt(15)
    v_mfma_f32_16x16x32_bf16 v[26:29], a[120:123], a[224:227], v[26:29]
    ds_read_b128 v[80:83], v9 offset:7168
    v_mfma_f32_16x16x32_bf16 v[30:33], a[124:127], a[224:227], v[30:33]
    ds_read_b128 v[84:87], v9 offset:8192
    v_mfma_f32_16x16x32_bf16 v[34:37], a[128:131], a[224:227], v[34:37]
    ds_read_b128 v[88:91], v9 offset:9216
    v_mfma_f32_16x16x32_bf16 v[38:41], a[132:135], a[224:227], v[38:41]
    buffer_load_dwordx4 v1, s[4:7], s44 offen offset:1024 sc1 lds
    v_mfma_f32_16x16x32_bf16 v[42:45], a[136:139], a[224:227], v[42:45]
    ds_read_b128 v[92:95], v9 offset:10240
    s_waitcnt vmcnt(15)
    v_mfma_f32_16x16x32_bf16 v[26:29], a[140:143], a[228:231], v[26:29]
    ds_read_b128 v[96:99], v9 offset:11264
    v_mfma_f32_16x16x32_bf16 v[30:33], a[144:147], a[228:231], v[30:33]
    ds_read_b128 v[100:103], v9 offset:12288
    v_mfma_f32_16x16x32_bf16 v[34:37], a[148:151], a[228:231], v[34:37]
    ds_read_b128 v[104:107], v9 offset:13312
    v_mfma_f32_16x16x32_bf16 v[38:41], a[152:155], a[228:231], v[38:41]
    ds_read_b128 v[108:111], v9 offset:14336
    v_mfma_f32_16x16x32_bf16 v[42:45], a[156:159], a[228:231], v[42:45]
    buffer_load_dwordx4 v1, s[4:7], s44 offen offset:2048 sc1 lds
    s_waitcnt vmcnt(14)
    v_mfma_f32_16x16x32_bf16 v[26:29], a[160:163], a[232:235], v[26:29]
    s_waitcnt lgkmcnt(9)
    v_add_f32 v52, v52, v72
    v_add_f32 v53, v53, v73
    v_mfma_f32_16x16x32_bf16 v[30:33], a[164:167], a[232:235], v[30:33]
    v_add_f32 v54, v54, v74
    v_add_f32 v55, v55, v75
    v_mfma_f32_16x16x32_bf16 v[34:37], a[168:171], a[232:235], v[34:37]
    s_waitcnt lgkmcnt(8)
    v_add_f32 v56, v56, v76
    v_add_f32 v57, v57, v77
    v_mfma_f32_16x16x32_bf16 v[38:41], a[172:175], a[232:235], v[38:41]
    v_add_f32 v58, v58, v78
    v_add_f32 v59, v59, v79
    v_mfma_f32_16x16x32_bf16 v[42:45], a[176:179], a[232:235], v[42:45]
    s_waitcnt lgkmcnt(7)
    v_add_f32 v60, v60, v80
    v_add_f32 v61, v61, v81
    s_waitcnt vmcnt(12)
    v_mfma_f32_16x16x32_bf16 v[26:29], a[180:183], a[236:239], v[26:29]
    buffer_load_dwordx4 v1, s[4:7], s44 offen offset:3072 sc1 lds
    v_mfma_f32_16x16x32_bf16 v[30:33], a[184:187], a[236:239], v[30:33]
    v_add_f32 v62, v62, v82
    v_add_f32 v63, v63, v83
    v_mfma_f32_16x16x32_bf16 v[34:37], a[188:191], a[236:239], v[34:37]
    s_waitcnt lgkmcnt(6)
    v_add_f32 v64, v64, v84
    v_add_f32 v65, v65, v85
    v_mfma_f32_16x16x32_bf16 v[38:41], a[192:195], a[236:239], v[38:41]
    v_add_f32 v66, v66, v86
    v_add_f32 v67, v67, v87
    v_mfma_f32_16x16x32_bf16 v[42:45], a[196:199], a[236:239], v[42:45]
    s_waitcnt lgkmcnt(5)
    v_add_f32 v68, v68, v88
    v_add_f32 v69, v69, v89
    s_waitcnt vmcnt(11)
    v_mfma_f32_16x16x32_bf16 v[26:29], a[200:203], a[240:243], v[26:29]
    v_add_f32 v70, v70, v90
    v_add_f32 v71, v71, v91
    v_mfma_f32_16x16x32_bf16 v[30:33], a[204:207], a[240:243], v[30:33]
    s_waitcnt lgkmcnt(4)
    v_add_f32 v52, v52, v92
    v_add_f32 v53, v53, v93
    v_mfma_f32_16x16x32_bf16 v[34:37], a[208:211], a[240:243], v[34:37]
    v_add_f32 v54, v54, v94
    v_add_f32 v55, v55, v95
    v_mfma_f32_16x16x32_bf16 v[38:41], a[212:215], a[240:243], v[38:41]
    s_waitcnt lgkmcnt(3)
    v_add_f32 v56, v56, v96
    v_add_f32 v57, v57, v97
    v_mfma_f32_16x16x32_bf16 v[42:45], a[216:219], a[240:243], v[42:45]
    v_add_f32 v58, v58, v98
    v_add_f32 v59, v59, v99
    s_waitcnt vmcnt(10)
    v_mfma_f32_16x16x32_bf16 v[26:29], a[220:223], a[244:247], v[26:29]
    s_waitcnt lgkmcnt(2)
    v_add_f32 v60, v60, v100
    v_add_f32 v61, v61, v101
    v_mfma_f32_16x16x32_bf16 v[30:33], v[116:119], a[244:247], v[30:33]
    v_add_f32 v62, v62, v102
    v_add_f32 v63, v63, v103
    v_mfma_f32_16x16x32_bf16 v[34:37], v[120:123], a[244:247], v[34:37]
    s_waitcnt lgkmcnt(1)
    v_add_f32 v64, v64, v104
    v_add_f32 v65, v65, v105
    v_mfma_f32_16x16x32_bf16 v[38:41], v[124:127], a[244:247], v[38:41]
    v_add_f32 v66, v66, v106
    v_add_f32 v67, v67, v107
    v_mfma_f32_16x16x32_bf16 v[42:45], v[128:131], a[244:247], v[42:45]
    s_waitcnt lgkmcnt(0)
    v_add_f32 v68, v68, v108
    v_add_f32 v69, v69, v109
    s_waitcnt vmcnt(8)
    v_mfma_f32_16x16x32_bf16 v[26:29], v[132:135], v[172:175], v[26:29]
    v_add_f32 v70, v70, v110
    v_add_f32 v71, v71, v111
    v_mfma_f32_16x16x32_bf16 v[30:33], v[136:139], v[172:175], v[30:33]
    v_mfma_f32_16x16x32_bf16 v[34:37], v[140:143], v[172:175], v[34:37]
    v_mfma_f32_16x16x32_bf16 v[38:41], v[144:147], v[172:175], v[38:41]
    v_mfma_f32_16x16x32_bf16 v[42:45], v[148:151], v[172:175], v[42:45]
    s_waitcnt vmcnt(6)
    v_mfma_f32_16x16x32_bf16 v[26:29], v[152:155], v[176:179], v[26:29]
    v_mfma_f32_16x16x32_bf16 v[30:33], v[156:159], v[176:179], v[30:33]
    v_mfma_f32_16x16x32_bf16 v[34:37], v[160:163], v[176:179], v[34:37]
    v_mfma_f32_16x16x32_bf16 v[38:41], v[164:167], v[176:179], v[38:41]
    v_mfma_f32_16x16x32_bf16 v[42:45], v[168:171], v[176:179], v[42:45]
    s_waitcnt lgkmcnt(0)
    s_barrier
    s_nop 1
    v_pk_add_f32 v[26:27], v[26:27], v[52:53]
    v_pk_add_f32 v[28:29], v[28:29], v[54:55]
    v_pk_add_f32 v[30:31], v[30:31], v[56:57]
    v_pk_add_f32 v[32:33], v[32:33], v[58:59]
    v_pk_add_f32 v[34:35], v[34:35], v[60:61]
    v_pk_add_f32 v[36:37], v[36:37], v[62:63]
    v_pk_add_f32 v[38:39], v[38:39], v[64:65]
    v_pk_add_f32 v[40:41], v[40:41], v[66:67]
    v_pk_add_f32 v[42:43], v[42:43], v[68:69]
    v_pk_add_f32 v[44:45], v[44:45], v[70:71]
    v_cvt_pk_bf16_f32 v16, v26, v27
    v_cvt_pk_bf16_f32 v17, v28, v29
    v_cvt_pk_bf16_f32 v18, v30, v31
    v_cvt_pk_bf16_f32 v19, v32, v33
    v_cvt_pk_bf16_f32 v20, v34, v35
    v_cvt_pk_bf16_f32 v21, v36, v37
    v_cvt_pk_bf16_f32 v22, v38, v39
    v_cvt_pk_bf16_f32 v23, v40, v41
    v_cvt_pk_bf16_f32 v24, v42, v43
    v_cvt_pk_bf16_f32 v25, v44, v45
    s_cmp_lg_u32 s50, 0
    s_cbranch_scc1 L_wt_42
    buffer_store_dwordx4 v[16:19], v5, s[4:7], s82 offen
    buffer_store_dwordx4 v[20:23], v5, s[4:7], s82 offen offset:2048
    buffer_store_dwordx2 v[24:25], v6, s[4:7], s82 offen
L_bk_43:
    v_dot2_f32_bf16 v26, v16, s70, 0
    v_dot2_f32_bf16 v27, v16, v16, 0
    v_dot2_f32_bf16 v26, v17, s70, v26
    v_dot2_f32_bf16 v27, v17, v17, v27
    v_dot2_f32_bf16 v26, v18, s70, v26
    v_dot2_f32_bf16 v27, v18, v18, v27
    v_dot2_f32_bf16 v26, v19, s70, v26
    v_dot2_f32_bf16 v27, v19, v19, v27
    v_dot2_f32_bf16 v26, v20, s70, v26
    v_dot2_f32_bf16 v27, v20, v20, v27
    v_dot2_f32_bf16 v26, v21, s70, v26
    v_dot2_f32_bf16 v27, v21, v21, v27
    v_dot2_f32_bf16 v26, v22, s70, v26
    v_dot2_f32_bf16 v27, v22, v22, v27
    v_dot2_f32_bf16 v26, v23, s70, v26
    v_dot2_f32_bf16 v27, v23, v23, v27
    v_dot2_f32_bf16 v26, v24, s70, v26
    v_dot2_f32_bf16 v27, v24, v24, v27
    v_dot2_f32_bf16 v26, v25, s70, v26
    v_dot2_f32_bf16 v27, v25, v25, v27
    s_nop 2
    v_permlane32_swap_b32 v26, v27
    v_add_f32 v26, v26, v27
    v_mov_b32 v27, v26
    s_nop 1
    v_permlane16_swap_b32 v26, v27
    v_add_f32 v26, v26, v27
    s_cmp_lg_u32 s50, 0
    s_cbranch_scc1 L_wt_44
    buffer_store_dword v26, v7, s[4:7], s84 offen
L_bk_45:
    s_add_u32 m0, s74, 98304
    s_add_u32 s44, s51, 98304
    buffer_load_dwordx4 v1, s[4:7], s44 offen offset:0 sc1 lds
    buffer_load_dwordx4 v1, s[4:7], s44 offen offset:1024 sc1 lds
    buffer_load_dwordx4 v1, s[4:7], s44 offen offset:2048 sc1 lds
    buffer_load_dwordx4 v1, s[4:7], s44 offen offset:3072 sc1 lds
    v_mov_b32 v50, 3
    s_waitcnt vmcnt(5)
    s_mov_b64 exec, 1
    s_cmp_lg_u32 s50, 0
    s_cbranch_scc1 L_wt_46
    buffer_store_dword v50, v0, s[4:7], s98 offen offset:0
L_bk_47:
    s_mov_b64 exec, -1
    s_waitcnt vmcnt(5)
    v_mov_b32 v50, 4
    s_mov_b64 exec, 1
    s_cmp_lg_u32 s50, 0
    s_cbranch_scc1 L_wt_48
    buffer_store_dword v50, v0, s[4:7], s98 offen offset:0
L_bk_49:
    s_mov_b64 exec, -1
    s_barrier
L_p1_1:
    s_mov_b32 s59, L_p1_1+2048-L_pc
    s_load_dword s65, s[0:1], s59
    s_add_u32 s59, s59, 64
    s_load_dword s65, s[0:1], s59
    s_add_u32 s87, s87, 29573120
    s_add_u32 s89, s89, 29573120
    s_add_u32 s88, s88, 29573120
    v_lshlrev_b32 v34, 2, v0
    v_and_b32 v34, 63, v34
    v_and_b32 v46, 31, v0
    v_lshrrev_b32 v47, 5, v0
    v_lshrrev_b32 v48, 1, v0
    v_and_b32 v48, 28, v48
    v_and_or_b32 v13, v0, 3, v48
    v_lshlrev_b32 v13, 4, v13
    v_add_u32 v13, 104448, v13
    v_and_b32 v48, 4, v0
    v_lshl_add_u32 v13, v48, 16, v13
    v_lshlrev_b32 v14, 3, v0
    v_add_u32 v5, s79, v1
    v_add_u32 v6, s79, v14
    v_lshlrev_b32 v7, 2, v47
    v_xor_b32 v9, v0, v7
    v_lshlrev_b32 v9, 4, v9
    v_add_u32 v11, s79, v9
    v_add_u32 v8, s95, v9
    v_xor_b32 v10, 8, v46
    v_lshlrev_b32 v10, 4, v10
    v_add_u32 v12, s79, v10
    v_add_u32 v48, s95, v10
    v_subrev_u32 v48, 4096, v48
    v_cndmask_b32 v12, v12, v48, s[48:49]
    v_mad_u32_u24 v10, v47, s94, v10
    v_sub_u32 v7, v46, v7
    s_cmp_ge_u32 s58, 1
    s_cselect_b32 s38, 0, 1073741824
    s_cselect_b32 s36, 0, 128
    s_cmp_ge_u32 s58, 2
    s_cselect_b32 s39, 0, 1073741824
    s_cselect_b32 s37, 0, 256
    s_add_u32 s36, s36, 128
    s_sub_u32 s36, s36, s37
    s_add_u32 s37, s37, s97
    s_add_u32 s35, s93, 5767168
    s_add_u32 s34, s35, s94
    v_add_u32 v40, s38, v1
    v_add_u32 v41, s39, v1
    v_bfe_u32 v49, v0, 2, 1
    v_mul_lo_u32 v49, v49, s36
    v_and_b32 v46, 3, v0
    v_lshl_add_u32 v49, v46, 2, v49
    v_add_u32 v49, s37, v49
    v_and_b32 v26, 31, v0
    v_lshrrev_b32 v15, 5, v0
    v_lshlrev_b32 v15, 11, v15
    v_lshl_add_u32 v15, v26, 3, v15
    ds_read_b128 a[224:227], v1 offset:0
    ds_read_b128 a[228:231], v1 offset:1024
    ds_read_b128 a[232:235], v1 offset:2048
    ds_read_b128 a[236:239], v1 offset:3072
    ds_read_b128 a[240:243], v1 offset:5120
    ds_read_b128 a[244:247], v1 offset:6144
    s_mov_b32 s45, 200000
L_poll_50:
    buffer_load_dword v35, v34, s[4:7], s99 offen sc1
    s_sub_u32 s45, s45, 1
    s_cbranch_scc1 L_got_51
    s_waitcnt vmcnt(0)
    v_cmp_gt_u32 vcc, 3, v35
    s_nop 0
    s_cbranch_vccnz L_poll_50
L_got_51:
    s_waitcnt vmcnt(0)
    s_add_u32 s42, s80, 0
    buffer_load_dwordx4 a[204:207], v1, s[4:7], s42 offen offset:0 sc1
    buffer_load_dwordx4 a[208:211], v1, s[4:7], s42 offen offset:1024 sc1
    buffer_load_dwordx4 a[212:215], v1, s[4:7], s42 offen offset:2048 sc1
    buffer_load_dwordx4 a[216:219], v1, s[4:7], s42 offen offset:3072 sc1
    s_add_u32 s42, s80, 4096
    buffer_load_dwordx4 a[220:223], v1, s[4:7], s42 offen offset:0 sc1
    buffer_load_dwordx4 v[116:119], v1, s[4:7], s42 offen offset:1024 sc1
    buffer_load_dwordx4 v[120:123], v1, s[4:7], s42 offen offset:2048 sc1
    buffer_load_dwordx4 v[124:127], v1, s[4:7], s42 offen offset:3072 sc1
    s_waitcnt vmcnt(7) lgkmcnt(0)
    v_mfma_f32_16x16x32_bf16 v[52:55], a[224:227], a[204:207], 0
    buffer_load_dword v37, v34, s[4:7], s99 offen sc1
    s_add_u32 s42, s80, 8192
    buffer_load_dwordx4 v[128:131], v1, s[4:7], s42 offen offset:0 sc1
    s_waitcnt vmcnt(8)
    v_mfma_f32_16x16x32_bf16 v[56:59], a[224:227], a[208:211], 0
    ds_read_b128 a[224:227], v1 offset:7168
    v_mfma_f32_16x16x32_bf16 v[60:63], a[228:231], a[204:207], 0
    v_mfma_f32_16x16x32_bf16 v[64:67], a[228:231], a[208:211], 0
    ds_read_b128 a[228:231], v1 offset:8192
    v_mfma_f32_16x16x32_bf16 v[68:71], a[232:235], a[204:207], 0
    buffer_load_dwordx4 v[132:135], v1, s[4:7], s42 offen offset:1024 sc1
    v_mfma_f32_16x16x32_bf16 v[72:75], a[232:235], a[208:211], 0
    ds_read_b128 a[232:235], v1 offset:4096
    v_mfma_f32_16x16x32_bf16 v[76:79], a[236:239], a[204:207], 0
    v_mfma_f32_16x16x32_bf16 v[80:83], a[236:239], a[208:211], 0
    s_waitcnt vmcnt(7)
    ds_read_b128 a[236:239], v1 offset:10240
    v_mfma_f32_16x16x32_bf16 v[52:55], a[240:243], a[212:215], v[52:55]
    buffer_load_dwordx4 v[136:139], v1, s[4:7], s42 offen offset:2048 sc1
    v_mfma_f32_16x16x32_bf16 v[56:59], a[240:243], a[216:219], v[56:59]
    s_waitcnt lgkmcnt(3)
    ds_read_b128 a[240:243], v1 offset:11264
    v_mfma_f32_16x16x32_bf16 v[60:63], a[244:247], a[212:215], v[60:63]
    v_mfma_f32_16x16x32_bf16 v[64:67], a[244:247], a[216:219], v[64:67]
    ds_read_b128 a[244:247], v1 offset:12288
    v_mfma_f32_16x16x32_bf16 v[68:71], a[224:227], a[212:215], v[68:71]
    buffer_load_dwordx4 v[140:143], v1, s[4:7], s42 offen offset:3072 sc1
    v_mfma_f32_16x16x32_bf16 v[72:75], a[224:227], a[216:219], v[72:75]
    s_waitcnt lgkmcnt(3)
    ds_read_b128 a[224:227], v1 offset:13312
    v_mfma_f32_16x16x32_bf16 v[76:79], a[228:231], a[212:215], v[76:79]
    v_mfma_f32_16x16x32_bf16 v[80:83], a[228:231], a[216:219], v[80:83]
    ds_read_b128 a[228:231], v1 offset:15360
    v_mfma_f32_16x16x32_bf16 v[84:87], a[232:235], a[204:207], 0
    s_add_u32 s42, s80, 12288
    buffer_load_dwordx4 v[144:147], v1, s[4:7], s42 offen offset:0 sc1
    v_mfma_f32_16x16x32_bf16 v[88:91], a[232:235], a[208:211], 0
    s_waitcnt vmcnt(8) lgkmcnt(3)
    ds_read_b128 a[232:235], v1 offset:16384
    v_mfma_f32_16x16x32_bf16 v[52:55], a[236:239], a[220:223], v[52:55]
    v_mfma_f32_16x16x32_bf16 v[56:59], a[236:239], v[116:119], v[56:59]
    ds_read_b128 a[236:239], v1 offset:17408
    v_mfma_f32_16x16x32_bf16 v[60:63], a[240:243], a[220:223], v[60:63]
    buffer_load_dwordx4 v[148:151], v1, s[4:7], s42 offen offset:1024 sc1
    v_mfma_f32_16x16x32_bf16 v[64:67], a[240:243], v[116:119], v[64:67]
    s_waitcnt lgkmcnt(3)
    ds_read_b128 a[240:243], v1 offset:18432
    v_mfma_f32_16x16x32_bf16 v[68:71], a[244:247], a[220:223], v[68:71]
    v_mfma_f32_16x16x32_bf16 v[72:75], a[244:247], v[116:119], v[72:75]
    ds_read_b128 a[244:247], v1 offset:9216
    v_mfma_f32_16x16x32_bf16 v[76:79], a[224:227], a[220:223], v[76:79]
    buffer_load_dwordx4 v[152:155], v1, s[4:7], s42 offen offset:2048 sc1
    v_mfma_f32_16x16x32_bf16 v[80:83], a[224:227], v[116:119], v[80:83]
    s_waitcnt vmcnt(8) lgkmcnt(3)
    ds_read_b128 a[224:227], v1 offset:20480
    v_mfma_f32_16x16x32_bf16 v[52:55], a[228:231], v[120:123], v[52:55]
    v_mfma_f32_16x16x32_bf16 v[56:59], a[228:231], v[124:127], v[56:59]
    ds_read_b128 a[228:231], v1 offset:21504
    v_mfma_f32_16x16x32_bf16 v[60:63], a[232:235], v[120:123], v[60:63]
    buffer_load_dwordx4 v[156:159], v1, s[4:7], s42 offen offset:3072 sc1
    v_mfma_f32_16x16x32_bf16 v[64:67], a[232:235], v[124:127], v[64:67]
    s_waitcnt lgkmcnt(3)
    ds_read_b128 a[232:235], v1 offset:22528
    v_mfma_f32_16x16x32_bf16 v[68:71], a[236:239], v[120:123], v[68:71]
    v_mfma_f32_16x16x32_bf16 v[72:75], a[236:239], v[124:127], v[72:75]
    ds_read_b128 a[236:239], v1 offset:23552
    v_mfma_f32_16x16x32_bf16 v[76:79], a[240:243], v[120:123], v[76:79]
    s_add_u32 s42, s80, 16384
    buffer_load_dwordx4 v[160:163], v1, s[4:7], s42 offen offset:0 sc1
    v_mfma_f32_16x16x32_bf16 v[80:83], a[240:243], v[124:127], v[80:83]
    s_waitcnt lgkmcnt(3)
    ds_read_b128 a[240:243], v1 offset:14336
    v_mfma_f32_16x16x32_bf16 v[84:87], a[244:247], a[212:215], v[84:87]
    v_mfma_f32_16x16x32_bf16 v[88:91], a[244:247], a[216:219], v[88:91]
    s_waitcnt vmcnt(7)
    ds_read_b128 a[244:247], v1 offset:25600
    v_mfma_f32_16x16x32_bf16 v[52:55], a[224:227], v[128:131], v[52:55]
    buffer_load_dwordx4 v[164:167], v1, s[4:7], s42 offen offset:1024 sc1
    v_mfma_f32_16x16x32_bf16 v[56:59], a[224:227], v[132:135], v[56:59]
    s_waitcnt lgkmcnt(3)
    ds_read_b128 a[224:227], v1 offset:26624
    v_mfma_f32_16x16x32_bf16 v[60:63], a[228:231], v[128:131], v[60:63]
    v_mfma_f32_16x16x32_bf16 v[64:67], a[228:231], v[132:135], v[64:67]
    ds_read_b128 a[228:231], v1 offset:27648
    v_mfma_f32_16x16x32_bf16 v[68:71], a[232:235], v[128:131], v[68:71]
    v_cmp_gt_u32 vcc, 4, v37
    s_nop 0
    s_cbranch_vccnz L_sx_52
L_sx_52ed:
    buffer_load_dwordx2 v[26:27], v15, s[4:7], s81 offen offset:0 sc1
    v_mfma_f32_16x16x32_bf16 v[72:75], a[232:235], v[132:135], v[72:75]
    s_waitcnt lgkmcnt(3)
    ds_read_b128 a[232:235], v1 offset:28672
    v_mfma_f32_16x16x32_bf16 v[76:79], a[236:239], v[128:131], v[76:79]
    v_mfma_f32_16x16x32_bf16 v[80:83], a[236:239], v[132:135], v[80:83]
    ds_read_b128 a[236:239], v1 offset:30720
    v_mfma_f32_16x16x32_bf16 v[84:87], a[240:243], a[220:223], v[84:87]
    buffer_load_dwordx2 v[28:29], v15, s[4:7], s81 offen offset:512 sc1
    v_mfma_f32_16x16x32_bf16 v[88:91], a[240:243], v[116:119], v[88:91]
    s_waitcnt vmcnt(8) lgkmcnt(3)
    ds_read_b128 a[240:243], v1 offset:31744
    v_mfma_f32_16x16x32_bf16 v[52:55], a[244:247], v[136:139], v[52:55]
    v_mfma_f32_16x16x32_bf16 v[56:59], a[244:247], v[140:143], v[56:59]
    ds_read_b128 a[244:247], v1 offset:32768
    v_mfma_f32_16x16x32_bf16 v[60:63], a[224:227], v[136:139], v[60:63]
    buffer_load_dwordx2 v[30:31], v15, s[4:7], s81 offen offset:1024 sc1
    v_mfma_f32_16x16x32_bf16 v[64:67], a[224:227], v[140:143], v[64:67]
    s_waitcnt lgkmcnt(3)
    ds_read_b128 a[224:227], v1 offset:33792
    v_mfma_f32_16x16x32_bf16 v[68:71], a[228:231], v[136:139], v[68:71]
    v_mfma_f32_16x16x32_bf16 v[72:75], a[228:231], v[140:143], v[72:75]
    ds_read_b128 a[228:231], v1 offset:19456
    v_mfma_f32_16x16x32_bf16 v[76:79], a[232:235], v[136:139], v[76:79]
    buffer_load_dwordx2 v[32:33], v15, s[4:7], s81 offen offset:1536 sc1
    v_mfma_f32_16x16x32_bf16 v[80:83], a[232:235], v[140:143], v[80:83]
    s_waitcnt vmcnt(8) lgkmcnt(3)
    ds_read_b128 a[232:235], v1 offset:35840
    v_mfma_f32_16x16x32_bf16 v[52:55], a[236:239], v[144:147], v[52:55]
    v_mfma_f32_16x16x32_bf16 v[56:59], a[236:239], v[148:151], v[56:59]
    ds_read_b128 a[236:239], v1 offset:36864
    v_mfma_f32_16x16x32_bf16 v[60:63], a[240:243], v[144:147], v[60:63]
    buffer_load_dwordx4 v[168:171], v1, s[4:7], s42 offen offset:2048 sc1
    v_mfma_f32_16x16x32_bf16 v[64:67], a[240:243], v[148:151], v[64:67]
    s_waitcnt lgkmcnt(3)
    ds_read_b128 a[240:243], v1 offset:37888
    v_mfma_f32_16x16x32_bf16 v[68:71], a[244:247], v[144:147], v[68:71]
    v_mfma_f32_16x16x32_bf16 v[72:75], a[244:247], v[148:151], v[72:75]
    ds_read_b128 a[244:247], v1 offset:38912
    v_mfma_f32_16x16x32_bf16 v[76:79], a[224:227], v[144:147], v[76:79]
    buffer_load_dwordx4 v[172:175], v1, s[4:7], s42 offen offset:3072 sc1
    v_mfma_f32_16x16x32_bf16 v[80:83], a[224:227], v[148:151], v[80:83]
    s_waitcnt lgkmcnt(3)
    ds_read_b128 a[224:227], v1 offset:40960
    v_mfma_f32_16x16x32_bf16 v[84:87], a[228:231], v[120:123], v[84:87]
    v_mfma_f32_16x16x32_bf16 v[88:91], a[228:231], v[124:127], v[88:91]
    s_waitcnt vmcnt(8)
    ds_read_b128 a[228:231], v1 offset:41984
    v_mfma_f32_16x16x32_bf16 v[52:55], a[232:235], v[152:155], v[52:55]
    s_add_u32 s42, s80, 20480
    buffer_load_dwordx4 v[176:179], v1, s[4:7], s42 offen offset:0 sc1
    v_mfma_f32_16x16x32_bf16 v[56:59], a[232:235], v[156:159], v[56:59]
    s_waitcnt lgkmcnt(3)
    ds_read_b128 a[232:235], v1 offset:43008
    v_mfma_f32_16x16x32_bf16 v[60:63], a[236:239], v[152:155], v[60:63]
    v_mfma_f32_16x16x32_bf16 v[64:67], a[236:239], v[156:159], v[64:67]
    ds_read_b128 a[236:239], v1 offset:44032
    v_mfma_f32_16x16x32_bf16 v[68:71], a[240:243], v[152:155], v[68:71]
    buffer_load_dwordx4 v[180:183], v1, s[4:7], s42 offen offset:1024 sc1
    v_mfma_f32_16x16x32_bf16 v[72:75], a[240:243], v[156:159], v[72:75]
    s_waitcnt lgkmcnt(3)
    ds_read_b128 a[240:243], v1 offset:24576
    v_mfma_f32_16x16x32_bf16 v[76:79], a[244:247], v[152:155], v[76:79]
    v_mfma_f32_16x16x32_bf16 v[80:83], a[244:247], v[156:159], v[80:83]
    s_waitcnt vmcnt(8)
    ds_read_b128 a[244:247], v1 offset:46080
    v_mfma_f32_16x16x32_bf16 v[52:55], a[224:227], v[160:163], v[52:55]
    buffer_load_dwordx4 v[184:187], v1, s[4:7], s42 offen offset:2048 sc1
    v_mfma_f32_16x16x32_bf16 v[56:59], a[224:227], v[164:167], v[56:59]
    s_waitcnt lgkmcnt(3)
    ds_read_b128 a[224:227], v1 offset:47104
    v_mfma_f32_16x16x32_bf16 v[60:63], a[228:231], v[160:163], v[60:63]
    v_mfma_f32_16x16x32_bf16 v[64:67], a[228:231], v[164:167], v[64:67]
    ds_read_b128 a[228:231], v1 offset:48128
    v_mfma_f32_16x16x32_bf16 v[68:71], a[232:235], v[160:163], v[68:71]
    buffer_load_dwordx4 v[188:191], v1, s[4:7], s42 offen offset:3072 sc1
    v_mfma_f32_16x16x32_bf16 v[72:75], a[232:235], v[164:167], v[72:75]
    s_waitcnt lgkmcnt(3)
    ds_read_b128 a[232:235], v1 offset:49152
    v_mfma_f32_16x16x32_bf16 v[76:79], a[236:239], v[160:163], v[76:79]
    v_mfma_f32_16x16x32_bf16 v[80:83], a[236:239], v[164:167], v[80:83]
    ds_read_b128 a[236:239], v1 offset:29696
    v_mfma_f32_16x16x32_bf16 v[84:87], a[240:243], v[128:131], v[84:87]
    s_add_u32 s42, s80, 24576
    buffer_load_dwordx4 v[192:195], v1, s[4:7], s42 offen offset:0 sc1
    v_mfma_f32_16x16x32_bf16 v[88:91], a[240:243], v[132:135], v[88:91]
    s_waitcnt vmcnt(5) lgkmcnt(3)
    ds_read_b128 a[240:243], v1 offset:51200
    v_mfma_f32_16x16x32_bf16 v[52:55], a[244:247], v[168:171], v[52:55]
    v_mfma_f32_16x16x32_bf16 v[56:59], a[244:247], v[172:175], v[56:59]
    ds_read_b128 a[244:247], v1 offset:52224
    v_mfma_f32_16x16x32_bf16 v[60:63], a[224:227], v[168:171], v[60:63]
    buffer_load_dwordx4 v[196:199], v1, s[4:7], s42 offen offset:1024 sc1
    v_mfma_f32_16x16x32_bf16 v[64:67], a[224:227], v[172:175], v[64:67]
    s_waitcnt lgkmcnt(3)
    ds_read_b128 a[224:227], v1 offset:53248
    v_mfma_f32_16x16x32_bf16 v[68:71], a[228:231], v[168:171], v[68:71]
    v_mfma_f32_16x16x32_bf16 v[72:75], a[228:231], v[172:175], v[72:75]
    ds_read_b128 a[228:231], v1 offset:54272
    v_mfma_f32_16x16x32_bf16 v[76:79], a[232:235], v[168:171], v[76:79]
    buffer_load_dwordx4 v[200:203], v1, s[4:7], s42 offen offset:2048 sc1
    v_mfma_f32_16x16x32_bf16 v[80:83], a[232:235], v[172:175], v[80:83]
    s_waitcnt lgkmcnt(3)
    ds_read_b128 a[232:235], v1 offset:56320
    v_mfma_f32_16x16x32_bf16 v[84:87], a[236:239], v[136:139], v[84:87]
    v_mfma_f32_16x16x32_bf16 v[88:91], a[236:239], v[140:143], v[88:91]
    s_waitcnt vmcnt(5)
    ds_read_b128 a[236:239], v1 offset:57344
    v_add_f32 v26, v26, v28
    v_mfma_f32_16x16x32_bf16 v[52:55], a[240:243], v[176:179], v[52:55]
    buffer_load_dwordx4 v[204:207], v1, s[4:7], s42 offen offset:3072 sc1
    v_mfma_f32_16x16x32_bf16 v[56:59], a[240:243], v[180:183], v[56:59]
    s_waitcnt lgkmcnt(3)
    ds_read_b128 a[240:243], v1 offset:58368
    v_add_f32 v27, v27, v29
    v_mfma_f32_16x16x32_bf16 v[60:63], a[244:247], v[176:179], v[60:63]
    v_add_f32 v30, v30, v32
    v_add_f32 v31, v31, v33
    v_mfma_f32_16x16x32_bf16 v[64:67], a[244:247], v[180:183], v[64:67]
    ds_read_b128 a[244:247], v1 offset:59392
    v_add_f32 v26, v26, v30
    v_mfma_f32_16x16x32_bf16 v[68:71], a[224:227], v[176:179], v[68:71]
    s_add_u32 s42, s80, 28672
    buffer_load_dwordx4 v[208:211], v1, s[4:7], s42 offen offset:0 sc1
    v_mfma_f32_16x16x32_bf16 v[72:75], a[224:227], v[180:183], v[72:75]
    s_waitcnt lgkmcnt(3)
    ds_read_b128 a[224:227], v1 offset:34816
    v_add_f32 v27, v27, v31
    v_mfma_f32_16x16x32_bf16 v[76:79], a[228:231], v[176:179], v[76:79]
    v_mov_b32 v28, v26
    v_mov_b32 v29, v27
    v_mfma_f32_16x16x32_bf16 v[80:83], a[228:231], v[180:183], v[80:83]
    s_waitcnt vmcnt(5)
    ds_read_b128 a[228:231], v1 offset:61440
    v_mfma_f32_16x16x32_bf16 v[52:55], a[232:235], v[184:187], v[52:55]
    buffer_load_dwordx4 v[212:215], v1, s[4:7], s42 offen offset:1024 sc1
    v_mfma_f32_16x16x32_bf16 v[56:59], a[232:235], v[188:191], v[56:59]
    s_waitcnt lgkmcnt(3)
    ds_read_b128 a[232:235], v1 offset:62464
    v_mfma_f32_16x16x32_bf16 v[60:63], a[236:239], v[184:187], v[60:63]
    v_permlane32_swap_b32 v26, v28
    v_mfma_f32_16x16x32_bf16 v[64:67], a[236:239], v[188:191], v[64:67]
    ds_read_b128 a[236:239], v1 offset:63488
    v_mfma_f32_16x16x32_bf16 v[68:71], a[240:243], v[184:187], v[68:71]
    buffer_load_dwordx4 v[216:219], v1, s[4:7], s42 offen offset:2048 sc1
    v_mfma_f32_16x16x32_bf16 v[72:75], a[240:243], v[188:191], v[72:75]
    s_waitcnt lgkmcnt(3)
    ds_read_b128 a[240:243], v1 offset:64512
    v_mfma_f32_16x16x32_bf16 v[76:79], a[244:247], v[184:187], v[76:79]
    v_permlane32_swap_b32 v27, v29
    v_mfma_f32_16x16x32_bf16 v[80:83], a[244:247], v[188:191], v[80:83]
    ds_read_b128 a[244:247], v2 offset:1024
    v_add_f32 v26, v26, v28
    v_mfma_f32_16x16x32_bf16 v[84:87], a[224:227], v[144:147], v[84:87]
    buffer_load_dwordx4 v[220:223], v1, s[4:7], s42 offen offset:3072 sc1
    v_mfma_f32_16x16x32_bf16 v[88:91], a[224:227], v[148:151], v[88:91]
    s_waitcnt vmcnt(6) lgkmcnt(3)
    ds_read_b128 a[224:227], v2 offset:2048
    v_add_f32 v27, v27, v29
    v_mfma_f32_16x16x32_bf16 v[52:55], a[228:231], v[192:195], v[52:55]
    v_mul_f32 v26, 0xbacccccd, v26
    v_mul_f32 v27, 0x3acccccd, v27
    v_mfma_f32_16x16x32_bf16 v[56:59], a[228:231], v[196:199], v[56:59]
    ds_read_b128 a[228:231], v2 offset:3072
    v_mov_b32 v28, v26
    v_mfma_f32_16x16x32_bf16 v[60:63], a[232:235], v[192:195], v[60:63]
    s_add_u32 s42, s80, 32768
    buffer_load_dwordx4 v[224:227], v1, s[4:7], s42 offen offset:0 sc1
    v_mfma_f32_16x16x32_bf16 v[64:67], a[232:235], v[196:199], v[64:67]
    s_waitcnt lgkmcnt(3)
    ds_read_b128 a[232:235], v2 offset:4096
    v_fma_f32 v27, -v26, v26, v27
    v_mfma_f32_16x16x32_bf16 v[68:71], a[236:239], v[192:195], v[68:71]
    v_max_f32 v27, 0, v27
    v_add_f32 v27, 0x3727c5ac, v27
    v_mfma_f32_16x16x32_bf16 v[72:75], a[236:239], v[196:199], v[72:75]
    ds_read_b128 a[236:239], v1 offset:39936
    v_mfma_f32_16x16x32_bf16 v[76:79], a[240:243], v[192:195], v[76:79]
    buffer_load_dwordx4 v[228:231], v1, s[4:7], s42 offen offset:1024 sc1
    v_mfma_f32_16x16x32_bf16 v[80:83], a[240:243], v[196:199], v[80:83]
    s_waitcnt vmcnt(6) lgkmcnt(3)
    ds_read_b128 a[240:243], v2 offset:6144
    v_mfma_f32_16x16x32_bf16 v[52:55], a[244:247], v[200:203], v[52:55]
    v_permlane16_swap_b32 v26, v28
    v_mfma_f32_16x16x32_bf16 v[56:59], a[244:247], v[204:207], v[56:59]
    ds_read_b128 a[244:247], v2 offset:7168
    v_mfma_f32_16x16x32_bf16 v[60:63], a[224:227], v[200:203], v[60:63]
    buffer_load_dwordx4 v[232:235], v1, s[4:7], s42 offen offset:2048 sc1
    v_mfma_f32_16x16x32_bf16 v[64:67], a[224:227], v[204:207], v[64:67]
    s_waitcnt lgkmcnt(3)
    ds_read_b128 a[224:227], v2 offset:8192
    v_mfma_f32_16x16x32_bf16 v[68:71], a[228:231], v[200:203], v[68:71]
    v_rsq_f32 v38, v27
    v_mfma_f32_16x16x32_bf16 v[72:75], a[228:231], v[204:207], v[72:75]
    ds_read_b128 a[228:231], v2 offset:9216
    v_cvt_pk_bf16_f32 v42, v26, v26
    v_mfma_f32_16x16x32_bf16 v[76:79], a[232:235], v[200:203], v[76:79]
    buffer_load_dwordx4 v[236:239], v1, s[4:7], s42 offen offset:3072 sc1
    v_mfma_f32_16x16x32_bf16 v[80:83], a[232:235], v[204:207], v[80:83]
    s_waitcnt lgkmcnt(3)
    ds_read_b128 a[232:235], v1 offset:45056
    v_and_b32 v43, 0xffff0000, v42
    v_mfma_f32_16x16x32_bf16 v[84:87], a[236:239], v[152:155], v[84:87]
    v_sub_f32 v43, v26, v43
    v_cvt_pk_bf16_f32 v43, v43, v43
    v_mfma_f32_16x16x32_bf16 v[88:91], a[236:239], v[156:159], v[88:91]
    s_waitcnt vmcnt(6)
    ds_read_b128 a[236:239], v2 offset:11264
    v_cvt_pk_bf16_f32 v44, v28, v28
    v_mfma_f32_16x16x32_bf16 v[52:55], a[240:243], v[208:211], v[52:55]
    s_add_u32 s42, s80, 36864
    buffer_load_dwordx4 v[240:243], v1, s[4:7], s42 offen offset:0 sc1
    v_mfma_f32_16x16x32_bf16 v[56:59], a[240:243], v[212:215], v[56:59]
    s_waitcnt lgkmcnt(3)
    ds_read_b128 a[240:243], v2 offset:12288
    v_and_b32 v45, 0xffff0000, v44
    v_mfma_f32_16x16x32_bf16 v[60:63], a[244:247], v[208:211], v[60:63]
    v_sub_f32 v45, v28, v45
    v_cvt_pk_bf16_f32 v45, v45, v45
    v_mfma_f32_16x16x32_bf16 v[64:67], a[244:247], v[212:215], v[64:67]
    ds_read_b128 a[244:247], v2 offset:13312
    v_mov_b32 v39, v38
    s_nop 1
    v_permlane16_swap_b32 v38, v39
    v_mfma_f32_16x16x32_bf16 v[68:71], a[224:227], v[208:211], v[68:71]
    s_bfm_b64 vcc, 16, 0
    v_cndmask_b32 v30, 0, v42, vcc
    v_cndmask_b32 v31, 0, v43, vcc
    buffer_load_dwordx4 v[244:247], v1, s[4:7], s42 offen offset:1024 sc1
    v_mfma_f32_16x16x32_bf16 v[72:75], a[224:227], v[212:215], v[72:75]
    s_waitcnt lgkmcnt(3)
    ds_read_b128 a[224:227], v2 offset:14336
    v_mov_b32 v32, 0
    v_mov_b32 v33, 0
    v_mfma_f32_16x16x32_bf16 v[76:79], a[228:231], v[208:211], v[76:79]
    s_bfm_b64 vcc, 16, 0
    v_cndmask_b32 v34, 0, v44, vcc
    v_cndmask_b32 v35, 0, v45, vcc
    v_mfma_f32_16x16x32_bf16 v[80:83], a[228:231], v[212:215], v[80:83]
    ds_read_b128 a[228:231], v2 offset:16384
    v_mov_b32 v36, 0
    v_mov_b32 v37, 0
    v_mfma_f32_16x16x32_bf16 v[84:87], a[232:235], v[160:163], v[84:87]
    buffer_load_dwordx4 v[248:251], v1, s[4:7], s42 offen offset:2048 sc1
    v_mfma_f32_16x16x32_bf16 v[88:91], a[232:235], v[164:167], v[88:91]
    s_waitcnt lgkmcnt(3)
    ds_read_b128 a[232:235], v2 offset:17408
    v_mfma_f32_16x16x32_bf16 v[52:55], a[248:251], v[30:33], v[52:55]
    v_mfma_f32_16x16x32_bf16 v[56:59], a[248:251], v[34:37], v[56:59]
    s_waitcnt vmcnt(7)
    v_mfma_f32_16x16x32_bf16 v[52:55], a[236:239], v[216:219], v[52:55]
    buffer_load_dwordx4 v[252:255], v1, s[4:7], s42 offen offset:3072 sc1
    v_mfma_f32_16x16x32_bf16 v[56:59], a[236:239], v[220:223], v[56:59]
    ds_read_b128 a[236:239], v2 offset:18432
    v_mfma_f32_16x16x32_bf16 v[60:63], a[240:243], v[216:219], v[60:63]
    s_bfm_b64 vcc, 16, 32
    v_cndmask_b32 v30, 0, v42, vcc
    v_cndmask_b32 v31, 0, v43, vcc
    v_mfma_f32_16x16x32_bf16 v[64:67], a[240:243], v[220:223], v[64:67]
    s_waitcnt lgkmcnt(3)
    ds_read_b128 a[240:243], v2 offset:19456
    v_mfma_f32_16x16x32_bf16 v[68:71], a[244:247], v[216:219], v[68:71]
    s_bfm_b64 vcc, 16, 32
    v_cndmask_b32 v34, 0, v44, vcc
    v_cndmask_b32 v35, 0, v45, vcc
    s_add_u32 m0, s74, 114688
    s_add_u32 s44, s51, 114688
    buffer_load_dwordx4 v1, s[4:7], s44 offen offset:0 sc1 lds
    v_mfma_f32_16x16x32_bf16 v[72:75], a[244:247], v[220:223], v[72:75]
    ds_read_b128 a[244:247], v1 offset:50176
    v_mfma_f32_16x16x32_bf16 v[76:79], a[224:227], v[216:219], v[76:79]
    v_mfma_f32_16x16x32_bf16 v[80:83], a[224:227], v[220:223], v[80:83]
    s_waitcnt lgkmcnt(3)
    ds_read_b128 a[224:227], v2 offset:21504
    v_mfma_f32_16x16x32_bf16 v[60:63], a[248:251], v[30:33], v[60:63]
    buffer_load_dwordx4 v1, s[4:7], s44 offen offset:1024 sc1 lds
    v_mfma_f32_16x16x32_bf16 v[64:67], a[248:251], v[34:37], v[64:67]
    s_waitcnt vmcnt(8)
    v_mfma_f32_16x16x32_bf16 v[52:55], a[228:231], v[224:227], v[52:55]
    v_mfma_f32_16x16x32_bf16 v[56:59], a[228:231], v[228:231], v[56:59]
    ds_read_b128 a[228:231], v2 offset:22528
    v_mfma_f32_16x16x32_bf16 v[60:63], a[232:235], v[224:227], v[60:63]
    buffer_load_dwordx4 v1, s[4:7], s44 offen offset:2048 sc1 lds
    v_mfma_f32_16x16x32_bf16 v[64:67], a[232:235], v[228:231], v[64:67]
    s_waitcnt lgkmcnt(3)
    ds_read_b128 a[232:235], v2 offset:23552
    v_mfma_f32_16x16x32_bf16 v[68:71], a[236:239], v[224:227], v[68:71]
    s_bfm_b64 vcc, 16, 16
    v_cndmask_b32 v30, 0, v42, vcc
    v_cndmask_b32 v31, 0, v43, vcc
    v_mfma_f32_16x16x32_bf16 v[72:75], a[236:239], v[228:231], v[72:75]
    ds_read_b128 a[236:239], v2 offset:24576
    v_mfma_f32_16x16x32_bf16 v[76:79], a[240:243], v[224:227], v[76:79]
    s_bfm_b64 vcc, 16, 16
    v_cndmask_b32 v34, 0, v44, vcc
    v_cndmask_b32 v35, 0, v45, vcc
    buffer_load_dwordx4 v1, s[4:7], s44 offen offset:3072 sc1 lds
    v_mfma_f32_16x16x32_bf16 v[80:83], a[240:243], v[228:231], v[80:83]
    s_waitcnt lgkmcnt(3)
    ds_read_b128 a[240:243], v2 offset:26624
    v_mfma_f32_16x16x32_bf16 v[84:87], a[244:247], v[168:171], v[84:87]
    v_mfma_f32_16x16x32_bf16 v[88:91], a[244:247], v[172:175], v[88:91]
    ds_read_b128 a[244:247], v2 offset:27648
    v_mfma_f32_16x16x32_bf16 v[68:71], a[248:251], v[30:33], v[68:71]
    s_add_u32 m0, s74, 131072
    s_add_u32 s44, s51, 131072
    buffer_load_dwordx4 v1, s[4:7], s44 offen offset:0 sc1 lds
    v_mfma_f32_16x16x32_bf16 v[72:75], a[248:251], v[34:37], v[72:75]
    s_waitcnt vmcnt(9)
    v_mfma_f32_16x16x32_bf16 v[52:55], a[224:227], v[232:235], v[52:55]
    v_mfma_f32_16x16x32_bf16 v[56:59], a[224:227], v[236:239], v[56:59]
    s_waitcnt lgkmcnt(3)
    ds_read_b128 a[224:227], v2 offset:28672
    v_mfma_f32_16x16x32_bf16 v[60:63], a[228:231], v[232:235], v[60:63]
    s_bfm_b64 vcc, 16, 48
    v_cndmask_b32 v30, 0, v42, vcc
    v_cndmask_b32 v31, 0, v43, vcc
    buffer_load_dwordx4 v1, s[4:7], s44 offen offset:1024 sc1 lds
    v_mfma_f32_16x16x32_bf16 v[64:67], a[228:231], v[236:239], v[64:67]
    ds_read_b128 a[228:231], v2 offset:29696
    v_mfma_f32_16x16x32_bf16 v[68:71], a[232:235], v[232:235], v[68:71]
    s_bfm_b64 vcc, 16, 48
    v_cndmask_b32 v34, 0, v44, vcc
    v_cndmask_b32 v35, 0, v45, vcc
    v_mfma_f32_16x16x32_bf16 v[72:75], a[232:235], v[236:239], v[72:75]
    s_waitcnt lgkmcnt(3)
    ds_read_b128 a[232:235], v1 offset:55296
    v_mfma_f32_16x16x32_bf16 v[76:79], a[236:239], v[232:235], v[76:79]
    buffer_load_dwordx4 v1, s[4:7], s44 offen offset:2048 sc1 lds
    v_mfma_f32_16x16x32_bf16 v[80:83], a[236:239], v[236:239], v[80:83]
    ds_read_b128 a[236:239], v2 offset:31744
    v_mfma_f32_16x16x32_bf16 v[76:79], a[248:251], v[30:33], v[76:79]
    v_mfma_f32_16x16x32_bf16 v[80:83], a[248:251], v[34:37], v[80:83]
    s_waitcnt vmcnt(9)
    v_mfma_f32_16x16x32_bf16 v[52:55], a[240:243], v[240:243], v[52:55]
    s_barrier
    buffer_load_dwordx4 v1, s[4:7], s44 offen offset:3072 sc1 lds
    v_mfma_f32_16x16x32_bf16 v[56:59], a[240:243], v[244:247], v[56:59]
    s_waitcnt lgkmcnt(3)
    ds_read_b128 a[240:243], v2 offset:32768
    v_mfma_f32_16x16x32_bf16 v[60:63], a[244:247], v[240:243], v[60:63]
    v_mfma_f32_16x16x32_bf16 v[64:67], a[244:247], v[244:247], v[64:67]
    ds_read_b128 a[244:247], v2 offset:33792
    v_mfma_f32_16x16x32_bf16 v[68:71], a[224:227], v[240:243], v[68:71]
    s_bfm_b64 vcc, 16, 0
    v_cndmask_b32 v32, 0, v42, vcc
    v_cndmask_b32 v33, 0, v43, vcc
    s_add_u32 m0, s74, 147456
    s_add_u32 s44, s51, 147456
    s_mul_i32 s59, s3, 2048
    s_sub_u32 m0, m0, s59
    s_sub_u32 s44, s44, s59
    buffer_load_dwordx4 v1, s[4:7], s44 offen offset:0 sc1 lds
    v_mfma_f32_16x16x32_bf16 v[72:75], a[224:227], v[244:247], v[72:75]
    s_waitcnt lgkmcnt(3)
    ds_read_b128 a[224:227], v2 offset:34816
    v_mov_b32 v30, 0
    v_mov_b32 v31, 0
    v_mfma_f32_16x16x32_bf16 v[76:79], a[228:231], v[240:243], v[76:79]
    s_bfm_b64 vcc, 16, 0
    v_cndmask_b32 v36, 0, v44, vcc
    v_cndmask_b32 v37, 0, v45, vcc
    v_mfma_f32_16x16x32_bf16 v[80:83], a[228:231], v[244:247], v[80:83]
    ds_read_b128 a[228:231], v1 offset:60416
    v_mov_b32 v34, 0
    v_mov_b32 v35, 0
    v_mfma_f32_16x16x32_bf16 v[84:87], a[232:235], v[176:179], v[84:87]
    buffer_load_dwordx4 v1, s[4:7], s44 offen offset:1024 sc1 lds
    v_mfma_f32_16x16x32_bf16 v[88:91], a[232:235], v[180:183], v[88:91]
    s_waitcnt lgkmcnt(3)
    ds_read_b128 a[232:235], v2 offset:0
    v_mfma_f32_16x16x32_bf16 v[84:87], a[248:251], v[30:33], v[84:87]
    v_mfma_f32_16x16x32_bf16 v[88:91], a[248:251], v[34:37], v[88:91]
    s_waitcnt vmcnt(10)
    v_mfma_f32_16x16x32_bf16 v[52:55], a[236:239], v[248:251], v[52:55]
    v_mfma_f32_16x16x32_bf16 v[56:59], a[236:239], v[252:255], v[56:59]
    ds_read_b128 a[236:239], v2 offset:5120
    v_mfma_f32_16x16x32_bf16 v[60:63], a[240:243], v[248:251], v[60:63]
    v_mfma_f32_16x16x32_bf16 v[64:67], a[240:243], v[252:255], v[64:67]
    s_waitcnt lgkmcnt(3)
    ds_read_b128 a[240:243], v2 offset:10240
    v_mfma_f32_16x16x32_bf16 v[68:71], a[244:247], v[248:251], v[68:71]
    v_mfma_f32_16x16x32_bf16 v[72:75], a[244:247], v[252:255], v[72:75]
    ds_read_b128 a[244:247], v2 offset:15360
    v_mfma_f32_16x16x32_bf16 v[76:79], a[224:227], v[248:251], v[76:79]
    v_mfma_f32_16x16x32_bf16 v[80:83], a[224:227], v[252:255], v[80:83]
    s_waitcnt lgkmcnt(3)
    ds_read_b128 a[224:227], v2 offset:20480
    v_mfma_f32_16x16x32_bf16 v[84:87], a[228:231], v[184:187], v[84:87]
    v_mfma_f32_16x16x32_bf16 v[88:91], a[228:231], v[188:191], v[88:91]
    ds_read_b128 a[228:231], v2 offset:25600
    v_mfma_f32_16x16x32_bf16 v[84:87], a[232:235], v[192:195], v[84:87]
    v_mfma_f32_16x16x32_bf16 v[88:91], a[232:235], v[196:199], v[88:91]
    s_waitcnt lgkmcnt(3)
    ds_read_b128 a[232:235], v2 offset:30720
    v_mul_f32 v52, v38, v52
    v_mul_f32 v53, v38, v53
    v_mul_f32 v54, v38, v54
    v_mfma_f32_16x16x32_bf16 v[84:87], a[236:239], v[200:203], v[84:87]
    v_mul_f32 v55, v38, v55
    v_cvt_pk_bf16_f32 v52, v52, v53
    v_cvt_pk_bf16_f32 v53, v54, v55
    v_mul_f32 v56, v39, v56
    v_mfma_f32_16x16x32_bf16 v[88:91], a[236:239], v[204:207], v[88:91]
    ds_read_b128 a[236:239], v2 offset:35840
    v_mul_f32 v57, v39, v57
    v_mul_f32 v58, v39, v58
    v_mul_f32 v59, v39, v59
    v_mfma_f32_16x16x32_bf16 v[84:87], a[240:243], v[208:211], v[84:87]
    v_cvt_pk_bf16_f32 v54, v56, v57
    v_cvt_pk_bf16_f32 v55, v58, v59
    s_nop 0
    v_permlane16_swap_b32 v52, v54
    v_mfma_f32_16x16x32_bf16 v[88:91], a[240:243], v[212:215], v[88:91]
    s_waitcnt lgkmcnt(3)
    ds_read_b128 a[240:243], v2 offset:36864
    v_permlane16_swap_b32 v53, v55
    v_mfma_f32_16x16x32_bf16 v[84:87], a[244:247], v[216:219], v[84:87]
    buffer_store_dwordx4 v[52:55], v1, s[4:7], s35 offen sc1
    v_mul_f32 v60, v38, v60
    v_mul_f32 v61, v38, v61
    v_mfma_f32_16x16x32_bf16 v[88:91], a[244:247], v[220:223], v[88:91]
    ds_read_b128 a[244:247], v2 offset:37888
    v_mul_f32 v62, v38, v62
    v_mul_f32 v63, v38, v63
    v_cvt_pk_bf16_f32 v60, v60, v61
    v_mfma_f32_16x16x32_bf16 v[84:87], a[224:227], v[224:227], v[84:87]
    s_barrier
    v_cvt_pk_bf16_f32 v61, v62, v63
    v_mul_f32 v64, v39, v64
    v_mul_f32 v65, v39, v65
    v_mfma_f32_16x16x32_bf16 v[88:91], a[224:227], v[228:231], v[88:91]
    s_waitcnt lgkmcnt(3)
    ds_read_b128 a[224:227], v13 offset:0
    v_mul_f32 v66, v39, v66
    v_mul_f32 v67, v39, v67
    v_cvt_pk_bf16_f32 v62, v64, v65
    v_mfma_f32_16x16x32_bf16 v[84:87], a[228:231], v[232:235], v[84:87]
    v_cvt_pk_bf16_f32 v63, v66, v67
    v_permlane16_swap_b32 v60, v62
    v_mfma_f32_16x16x32_bf16 v[88:91], a[228:231], v[236:239], v[88:91]
    ds_read_b128 a[228:231], v2 offset:39424
    v_permlane16_swap_b32 v61, v63
    v_mfma_f32_16x16x32_bf16 v[84:87], a[232:235], v[240:243], v[84:87]
    v_mul_f32 v76, v38, v76
    v_mul_f32 v77, v38, v77
    v_mul_f32 v78, v38, v78
    v_mul_f32 v79, v38, v79
    v_mfma_f32_16x16x32_bf16 v[88:91], a[232:235], v[244:247], v[88:91]
    s_waitcnt lgkmcnt(3)
    ds_read_b128 a[232:235], v2 offset:40448
    v_cvt_pk_bf16_f32 v76, v76, v77
    v_cvt_pk_bf16_f32 v77, v78, v79
    v_mul_f32 v80, v39, v80
    v_mfma_f32_16x16x32_bf16 v[84:87], a[236:239], v[248:251], v[84:87]
    buffer_store_dwordx4 v[60:63], v9, s[4:7], s35 offen offset:1024 sc1
    v_mul_f32 v81, v39, v81
    v_mul_f32 v82, v39, v82
    v_mfma_f32_16x16x32_bf16 v[88:91], a[236:239], v[252:255], v[88:91]
    ds_read_b128 a[236:239], v13 offset:2560
    v_mul_f32 v83, v39, v83
    v_cvt_pk_bf16_f32 v78, v80, v81
    v_cvt_pk_bf16_f32 v79, v82, v83
    v_mfma_f32_16x16x32_bf16 v[92:95], a[240:243], a[204:207], 0
    v_mov_b32 v80, s70
    v_mov_b32 v81, s70
    v_permlane16_swap_b32 v76, v78
    v_mfma_f32_16x16x32_bf16 v[96:99], a[240:243], a[208:211], 0
    s_waitcnt lgkmcnt(3)
    ds_read_b128 a[240:243], v2 offset:41984
    v_permlane16_swap_b32 v77, v79
    v_mfma_f32_16x16x32_bf16 v[100:103], a[244:247], a[204:207], 0
    v_mfma_f32_16x16x32_bf16 v[104:107], a[244:247], a[208:211], 0
    ds_read_b128 a[244:247], v2 offset:43008
    v_mul_f32 v68, v38, v68
    v_mfma_f32_16x16x32_bf16 v[108:111], a[224:227], a[204:207], 0
    v_mul_f32 v69, v38, v69
    v_mul_f32 v70, v38, v70
    v_mfma_f32_16x16x32_bf16 v[112:115], a[224:227], a[208:211], 0
    s_waitcnt lgkmcnt(3)
    ds_read_b128 a[224:227], v13 offset:5120
    v_mul_f32 v71, v38, v71
    v_mfma_f32_16x16x32_bf16 v[92:95], a[228:231], a[212:215], v[92:95]
    buffer_store_dwordx4 v[78:81], v10, s[4:7], s35 offen offset:2048 sc1
    v_mfma_f32_16x16x32_bf16 v[96:99], a[228:231], a[216:219], v[96:99]
    ds_read_b128 a[228:231], v2 offset:44544
    v_cvt_pk_bf16_f32 v68, v68, v69
    v_mfma_f32_16x16x32_bf16 v[100:103], a[232:235], a[212:215], v[100:103]
    v_cvt_pk_bf16_f32 v69, v70, v71
    v_mul_f32 v72, v39, v72
    v_mfma_f32_16x16x32_bf16 v[104:107], a[232:235], a[216:219], v[104:107]
    s_waitcnt lgkmcnt(3)
    ds_read_b128 a[232:235], v2 offset:45568
    v_mul_f32 v73, v39, v73
    v_mfma_f32_16x16x32_bf16 v[108:111], a[236:239], a[212:215], v[108:111]
    v_mul_f32 v74, v39, v74
    v_mul_f32 v75, v39, v75
    v_mfma_f32_16x16x32_bf16 v[112:115], a[236:239], a[216:219], v[112:115]
    ds_read_b128 a[236:239], v13 offset:7680
    v_cvt_pk_bf16_f32 v70, v72, v73
    v_mfma_f32_16x16x32_bf16 v[92:95], a[240:243], a[220:223], v[92:95]
    v_cvt_pk_bf16_f32 v71, v74, v75
    v_mfma_f32_16x16x32_bf16 v[96:99], a[240:243], v[116:119], v[96:99]
    s_waitcnt lgkmcnt(3)
    ds_read_b128 a[240:243], v2 offset:47104
    v_mfma_f32_16x16x32_bf16 v[100:103], a[244:247], a[220:223], v[100:103]
    buffer_store_dwordx2 v[76:77], v14, s[4:7], s35 offen offset:2560 sc1
    v_mfma_f32_16x16x32_bf16 v[104:107], a[244:247], v[116:119], v[104:107]
    ds_read_b128 a[244:247], v2 offset:48128
    v_mfma_f32_16x16x32_bf16 v[108:111], a[224:227], a[220:223], v[108:111]
    s_waitcnt vmcnt(10)
    s_barrier
    v_mfma_f32_16x16x32_bf16 v[112:115], a[224:227], v[116:119], v[112:115]
    s_waitcnt lgkmcnt(3)
    ds_read_b128 a[224:227], v13 offset:10240
    v_mfma_f32_16x16x32_bf16 v[92:95], a[228:231], v[120:123], v[92:95]
    v_permlane16_swap_b32 v68, v70
    v_mfma_f32_16x16x32_bf16 v[96:99], a[228:231], v[124:127], v[96:99]
    ds_read_b128 a[228:231], v2 offset:49664
    v_mfma_f32_16x16x32_bf16 v[100:103], a[232:235], v[120:123], v[100:103]
    v_permlane16_swap_b32 v69, v71
    v_mfma_f32_16x16x32_bf16 v[104:107], a[232:235], v[124:127], v[104:107]
    s_waitcnt lgkmcnt(3)
    ds_read_b128 a[232:235], v2 offset:50688
    v_mul_f32 v84, v38, v84
    v_mfma_f32_16x16x32_bf16 v[108:111], a[236:239], v[120:123], v[108:111]
    v_mul_f32 v85, v38, v85
    v_mul_f32 v86, v38, v86
    v_mfma_f32_16x16x32_bf16 v[112:115], a[236:239], v[124:127], v[112:115]
    ds_read_b128 a[236:239], v13 offset:12800
    v_mul_f32 v87, v38, v87
    v_mfma_f32_16x16x32_bf16 v[92:95], a[240:243], v[128:131], v[92:95]
    v_cvt_pk_bf16_f32 v84, v84, v85
    v_cvt_pk_bf16_f32 v85, v86, v87
    v_mfma_f32_16x16x32_bf16 v[96:99], a[240:243], v[132:135], v[96:99]
    s_waitcnt lgkmcnt(3)
    ds_read_b128 a[240:243], v2 offset:52224
    v_mul_f32 v88, v39, v88
    v_mfma_f32_16x16x32_bf16 v[100:103], a[244:247], v[128:131], v[100:103]
    buffer_store_dwordx4 v[68:71], v1, s[4:7], s34 offen sc1
    v_mfma_f32_16x16x32_bf16 v[104:107], a[244:247], v[132:135], v[104:107]
    ds_read_b128 a[244:247], v2 offset:53248
    v_mul_f32 v89, v39, v89
    v_mfma_f32_16x16x32_bf16 v[108:111], a[224:227], v[128:131], v[108:111]
    v_mul_f32 v90, v39, v90
    v_mul_f32 v91, v39, v91
    v_mfma_f32_16x16x32_bf16 v[112:115], a[224:227], v[132:135], v[112:115]
    s_waitcnt lgkmcnt(3)
    ds_read_b128 a[224:227], v13 offset:15360
    v_cvt_pk_bf16_f32 v86, v88, v89
    v_mfma_f32_16x16x32_bf16 v[92:95], a[228:231], v[136:139], v[92:95]
    v_cvt_pk_bf16_f32 v87, v90, v91
    v_mul_f32 v38, 0x3ea52b5c, v38
    v_mfma_f32_16x16x32_bf16 v[96:99], a[228:231], v[140:143], v[96:99]
    ds_read_b128 a[228:231], v2 offset:54784
    v_mul_f32 v39, 0x3ea52b5c, v39
    v_mfma_f32_16x16x32_bf16 v[100:103], a[232:235], v[136:139], v[100:103]
    v_permlane16_swap_b32 v84, v86
    v_mfma_f32_16x16x32_bf16 v[104:107], a[232:235], v[140:143], v[104:107]
    s_waitcnt lgkmcnt(3)
    ds_read_b128 a[232:235], v2 offset:55808
    v_mfma_f32_16x16x32_bf16 v[108:111], a[236:239], v[136:139], v[108:111]
    v_permlane16_swap_b32 v85, v87
    v_mfma_f32_16x16x32_bf16 v[112:115], a[236:239], v[140:143], v[112:115]
    ds_read_b128 a[236:239], v13 offset:17920
    v_mfma_f32_16x16x32_bf16 v[92:95], a[240:243], v[144:147], v[92:95]
    v_mfma_f32_16x16x32_bf16 v[96:99], a[240:243], v[148:151], v[96:99]
    s_waitcnt lgkmcnt(3)
    ds_read_b128 a[240:243], v2 offset:57344
    v_mfma_f32_16x16x32_bf16 v[100:103], a[244:247], v[144:147], v[100:103]
    v_mfma_f32_16x16x32_bf16 v[104:107], a[244:247], v[148:151], v[104:107]
    ds_read_b128 a[244:247], v2 offset:58368
    v_mfma_f32_16x16x32_bf16 v[108:111], a[224:227], v[144:147], v[108:111]
    v_mfma_f32_16x16x32_bf16 v[112:115], a[224:227], v[148:151], v[112:115]
    s_waitcnt lgkmcnt(3)
    ds_read_b128 a[224:227], v13 offset:20480
    v_mfma_f32_16x16x32_bf16 v[92:95], a[228:231], v[152:155], v[92:95]
    buffer_store_dwordx4 v[84:87], v9, s[4:7], s34 offen offset:1024 sc1
    v_mfma_f32_16x16x32_bf16 v[96:99], a[228:231], v[156:159], v[96:99]
    ds_read_b128 a[228:231], v2 offset:59904
    v_mfma_f32_16x16x32_bf16 v[100:103], a[232:235], v[152:155], v[100:103]
    v_mfma_f32_16x16x32_bf16 v[104:107], a[232:235], v[156:159], v[104:107]
    s_waitcnt lgkmcnt(3)
    ds_read_b128 a[232:235], v2 offset:60928
    v_mfma_f32_16x16x32_bf16 v[108:111], a[236:239], v[152:155], v[108:111]
    v_mov_b32 v50, 3
    s_waitcnt vmcnt(2)
    s_mov_b64 exec, 1
    buffer_store_dword v50, v0, s[4:7], s73 offen offset:0 sc1
    s_mov_b64 exec, -1
    v_mfma_f32_16x16x32_bf16 v[112:115], a[236:239], v[156:159], v[112:115]
    ds_read_b128 a[236:239], v13 offset:23040
    v_mfma_f32_16x16x32_bf16 v[92:95], a[240:243], v[160:163], v[92:95]
    v_mfma_f32_16x16x32_bf16 v[96:99], a[240:243], v[164:167], v[96:99]
    s_waitcnt lgkmcnt(3)
    ds_read_b128 a[240:243], v2 offset:62464
    v_mfma_f32_16x16x32_bf16 v[100:103], a[244:247], v[160:163], v[100:103]
    s_add_u32 m0, s74, 0
    s_add_u32 s44, s52, 0
    buffer_load_dwordx4 v1, s[4:7], s44 offen offset:0 sc1 lds
    v_mfma_f32_16x16x32_bf16 v[104:107], a[244:247], v[164:167], v[104:107]
    ds_read_b128 a[244:247], v2 offset:63488
    v_mfma_f32_16x16x32_bf16 v[108:111], a[224:227], v[160:163], v[108:111]
    v_mfma_f32_16x16x32_bf16 v[112:115], a[224:227], v[164:167], v[112:115]
    s_waitcnt lgkmcnt(3)
    ds_read_b128 a[224:227], v13 offset:25600
    v_mfma_f32_16x16x32_bf16 v[92:95], a[228:231], v[168:171], v[92:95]
    s_barrier
    v_mfma_f32_16x16x32_bf16 v[96:99], a[228:231], v[172:175], v[96:99]
    ds_read_b128 a[228:231], v2 offset:65024
    v_add_u32 v15, s95, v1
    v_mfma_f32_16x16x32_bf16 v[100:103], a[232:235], v[168:171], v[100:103]
    buffer_load_dwordx4 v1, s[4:7], s44 offen offset:1024 sc1 lds
    ds_write_b64 v5, v[52:53] offset:24576
    v_mfma_f32_16x16x32_bf16 v[104:107], a[232:235], v[172:175], v[104:107]
    s_waitcnt lgkmcnt(4)
    ds_read_b128 a[232:235], v3 offset:512
    v_subrev_u32 v124, 0, v7
    v_mfma_f32_16x16x32_bf16 v[108:111], a[236:239], v[168:171], v[108:111]
    ds_write_b64 v5, v[54:55] offset:24584
    v_mfma_f32_16x16x32_bf16 v[112:115], a[236:239], v[172:175], v[112:115]
    ds_read_b128 a[236:239], v13 offset:28160
    v_and_b32 v124, s77, v124
    v_mfma_f32_16x16x32_bf16 v[92:95], a[240:243], v[176:179], v[92:95]
    ds_write_b64 v6, v[76:77] offset:27136
    v_mfma_f32_16x16x32_bf16 v[96:99], a[240:243], v[180:183], v[96:99]
    s_waitcnt lgkmcnt(6)
    ds_read_b128 a[240:243], v3 offset:2048
    v_subrev_u32 v125, 1, v7
    v_mfma_f32_16x16x32_bf16 v[100:103], a[244:247], v[176:179], v[100:103]
    buffer_load_dwordx4 v1, s[4:7], s44 offen offset:2048 sc1 lds
    ds_write_b64 v11, v[60:61] offset:25600
    v_mfma_f32_16x16x32_bf16 v[104:107], a[244:247], v[180:183], v[104:107]
    ds_read_b128 a[244:247], v3 offset:3072
    v_and_b32 v125, s77, v125
    v_mfma_f32_16x16x32_bf16 v[108:111], a[224:227], v[176:179], v[108:111]
    ds_write_b64 v11, v[62:63] offset:25608
    v_mfma_f32_16x16x32_bf16 v[112:115], a[224:227], v[180:183], v[112:115]
    s_waitcnt lgkmcnt(7)
    ds_read_b128 a[224:227], v13 offset:30720
    v_subrev_u32 v126, 2, v7
    v_mfma_f32_16x16x32_bf16 v[92:95], a[228:231], v[184:187], v[92:95]
    ds_write_b64 v12, v[78:79] offset:26624
    v_mfma_f32_16x16x32_bf16 v[96:99], a[228:231], v[188:191], v[96:99]
    ds_read_b128 a[228:231], v3 offset:4608
    v_and_b32 v126, s77, v126
    v_mfma_f32_16x16x32_bf16 v[100:103], a[232:235], v[184:187], v[100:103]
    buffer_load_dwordx4 v1, s[4:7], s44 offen offset:3072 sc1 lds
    ds_write_b64 v12, v[80:81] offset:26632
    v_mfma_f32_16x16x32_bf16 v[104:107], a[232:235], v[188:191], v[104:107]
    s_waitcnt lgkmcnt(7)
    ds_read_b128 a[232:235], v3 offset:5632
    v_subrev_u32 v127, 3, v7
    v_mfma_f32_16x16x32_bf16 v[108:111], a[236:239], v[184:187], v[108:111]
    ds_write_b64 v15, v[68:69] offset:20480
    v_mfma_f32_16x16x32_bf16 v[112:115], a[236:239], v[188:191], v[112:115]
    ds_read_b128 a[236:239], v13 offset:33280
    v_and_b32 v127, s77, v127
    v_mfma_f32_16x16x32_bf16 v[92:95], a[240:243], v[192:195], v[92:95]
    ds_write_b64 v15, v[70:71] offset:20488
    v_mfma_f32_16x16x32_bf16 v[96:99], a[240:243], v[196:199], v[96:99]
    s_waitcnt lgkmcnt(7)
    ds_read_b128 a[240:243], v3 offset:7168
    v_subrev_u32 v128, 8, v7
    v_mfma_f32_16x16x32_bf16 v[100:103], a[244:247], v[192:195], v[100:103]
    s_add_u32 m0, s74, 16384
    s_add_u32 s44, s52, 16384
    buffer_load_dwordx4 v1, s[4:7], s44 offen offset:0 sc1 lds
    ds_write_b64 v8, v[84:85] offset:21504
    v_mfma_f32_16x16x32_bf16 v[104:107], a[244:247], v[196:199], v[104:107]
    ds_read_b128 a[244:247], v3 offset:8192
    v_and_b32 v128, s77, v128
    v_mfma_f32_16x16x32_bf16 v[108:111], a[224:227], v[192:195], v[108:111]
    ds_write_b64 v8, v[86:87] offset:21512
    v_mfma_f32_16x16x32_bf16 v[112:115], a[224:227], v[196:199], v[112:115]
    s_waitcnt lgkmcnt(7)
    ds_read_b128 a[224:227], v13 offset:35840
    v_subrev_u32 v129, 9, v7
    v_mfma_f32_16x16x32_bf16 v[92:95], a[228:231], v[200:203], v[92:95]
    s_bfm_b64 vcc, 16, 32
    v_cndmask_b32 v32, 0, v42, vcc
    v_cndmask_b32 v33, 0, v43, vcc
    v_mfma_f32_16x16x32_bf16 v[96:99], a[228:231], v[204:207], v[96:99]
    ds_read_b128 a[228:231], v3 offset:9728
    v_and_b32 v129, s77, v129
    v_mfma_f32_16x16x32_bf16 v[100:103], a[232:235], v[200:203], v[100:103]
    s_bfm_b64 vcc, 16, 32
    v_cndmask_b32 v36, 0, v44, vcc
    v_cndmask_b32 v37, 0, v45, vcc
    buffer_load_dwordx4 v1, s[4:7], s44 offen offset:1024 sc1 lds
    v_mfma_f32_16x16x32_bf16 v[104:107], a[232:235], v[204:207], v[104:107]
    s_waitcnt lgkmcnt(5)
    ds_read_b128 a[232:235], v3 offset:10752
    v_subrev_u32 v130, 10, v7
    v_mfma_f32_16x16x32_bf16 v[108:111], a[236:239], v[200:203], v[108:111]
    v_and_b32 v130, s77, v130
    v_subrev_u32 v131, 11, v7
    v_mfma_f32_16x16x32_bf16 v[112:115], a[236:239], v[204:207], v[112:115]
    ds_read_b128 a[236:239], v13 offset:38400
    v_and_b32 v131, s77, v131
    v_mfma_f32_16x16x32_bf16 v[92:95], a[248:251], v[30:33], v[92:95]
    v_subrev_u32 v132, 16, v7
    v_and_b32 v132, s77, v132
    v_mfma_f32_16x16x32_bf16 v[96:99], a[248:251], v[34:37], v[96:99]
    v_subrev_u32 v133, 17, v7
    v_and_b32 v133, s77, v133
    v_mfma_f32_16x16x32_bf16 v[92:95], a[240:243], v[208:211], v[92:95]
    buffer_load_dwordx4 v1, s[4:7], s44 offen offset:2048 sc1 lds
    v_mfma_f32_16x16x32_bf16 v[96:99], a[240:243], v[212:215], v[96:99]
    s_waitcnt lgkmcnt(3)
    ds_read_b128 a[240:243], v3 offset:12288
    v_subrev_u32 v134, 18, v7
    v_mfma_f32_16x16x32_bf16 v[100:103], a[244:247], v[208:211], v[100:103]
    v_and_b32 v134, s77, v134
    v_subrev_u32 v135, 19, v7
    v_mfma_f32_16x16x32_bf16 v[104:107], a[244:247], v[212:215], v[104:107]
    ds_read_b128 a[244:247], v3 offset:13312
    v_and_b32 v135, s77, v135
    v_mfma_f32_16x16x32_bf16 v[108:111], a[224:227], v[208:211], v[108:111]
    v_subrev_u32 v136, 24, v7
    v_and_b32 v136, s77, v136
    v_mfma_f32_16x16x32_bf16 v[112:115], a[224:227], v[212:215], v[112:115]
    s_waitcnt lgkmcnt(3)
    ds_read_b128 a[224:227], v13 offset:40960
    v_subrev_u32 v137, 25, v7
    v_mfma_f32_16x16x32_bf16 v[92:95], a[228:231], v[216:219], v[92:95]
    s_bfm_b64 vcc, 16, 16
    v_cndmask_b32 v32, 0, v42, vcc
    v_cndmask_b32 v33, 0, v43, vcc
    buffer_load_dwordx4 v1, s[4:7], s44 offen offset:3072 sc1 lds
    v_mfma_f32_16x16x32_bf16 v[96:99], a[228:231], v[220:223], v[96:99]
    ds_read_b128 a[228:231], v3 offset:14848
    v_and_b32 v137, s77, v137
    v_mfma_f32_16x16x32_bf16 v[100:103], a[232:235], v[216:219], v[100:103]
    s_bfm_b64 vcc, 16, 16
    v_cndmask_b32 v36, 0, v44, vcc
    v_cndmask_b32 v37, 0, v45, vcc
    buffer_load_dword v140, v49, s[4:7], 0 offen sc1
    v_mfma_f32_16x16x32_bf16 v[104:107], a[232:235], v[220:223], v[104:107]
    s_waitcnt lgkmcnt(3)
    ds_read_b128 a[232:235], v3 offset:15872
    v_subrev_u32 v138, 26, v7
    v_mfma_f32_16x16x32_bf16 v[108:111], a[236:239], v[216:219], v[108:111]
    v_and_b32 v138, s77, v138
    v_subrev_u32 v139, 27, v7
    v_mfma_f32_16x16x32_bf16 v[112:115], a[236:239], v[220:223], v[112:115]
    ds_read_b128 a[236:239], v13 offset:43520
    v_and_b32 v139, s77, v139
    v_mfma_f32_16x16x32_bf16 v[100:103], a[248:251], v[30:33], v[100:103]
    v_mfma_f32_16x16x32_bf16 v[104:107], a[248:251], v[34:37], v[104:107]
    v_mfma_f32_16x16x32_bf16 v[92:95], a[240:243], v[224:227], v[92:95]
    v_mfma_f32_16x16x32_bf16 v[96:99], a[240:243], v[228:231], v[96:99]
    s_waitcnt lgkmcnt(3)
    ds_read_b128 a[240:243], v3 offset:17408
    v_mfma_f32_16x16x32_bf16 v[100:103], a[244:247], v[224:227], v[100:103]
    v_mfma_f32_16x16x32_bf16 v[104:107], a[244:247], v[228:231], v[104:107]
    ds_read_b128 a[244:247], v3 offset:18432
    v_mfma_f32_16x16x32_bf16 v[108:111], a[224:227], v[224:227], v[108:111]
    v_mfma_f32_16x16x32_bf16 v[112:115], a[224:227], v[228:231], v[112:115]
    s_waitcnt lgkmcnt(3)
    ds_read_b128 a[224:227], v13 offset:46080
    v_mfma_f32_16x16x32_bf16 v[92:95], a[228:231], v[232:235], v[92:95]
    s_bfm_b64 vcc, 16, 48
    v_cndmask_b32 v32, 0, v42, vcc
    v_cndmask_b32 v33, 0, v43, vcc
    v_mfma_f32_16x16x32_bf16 v[96:99], a[228:231], v[236:239], v[96:99]
    ds_read_b128 a[228:231], v3 offset:19968
    v_mfma_f32_16x16x32_bf16 v[100:103], a[232:235], v[232:235], v[100:103]
    s_bfm_b64 vcc, 16, 48
    v_cndmask_b32 v36, 0, v44, vcc
    v_cndmask_b32 v37, 0, v45, vcc
    v_mfma_f32_16x16x32_bf16 v[104:107], a[232:235], v[236:239], v[104:107]
    s_waitcnt lgkmcnt(3)
    ds_read_b128 a[232:235], v3 offset:20992
    v_mfma_f32_16x16x32_bf16 v[108:111], a[236:239], v[232:235], v[108:111]
    v_mfma_f32_16x16x32_bf16 v[112:115], a[236:239], v[236:239], v[112:115]
    ds_read_b128 a[236:239], v13 offset:48640
    v_mfma_f32_16x16x32_bf16 v[108:111], a[248:251], v[30:33], v[108:111]
    v_mfma_f32_16x16x32_bf16 v[112:115], a[248:251], v[34:37], v[112:115]
    v_mfma_f32_16x16x32_bf16 v[92:95], a[240:243], v[240:243], v[92:95]
    v_mfma_f32_16x16x32_bf16 v[96:99], a[240:243], v[244:247], v[96:99]
    s_waitcnt lgkmcnt(3)
    v_mfma_f32_16x16x32_bf16 v[100:103], a[244:247], v[240:243], v[100:103]
    v_mfma_f32_16x16x32_bf16 v[104:107], a[244:247], v[244:247], v[104:107]
    v_mfma_f32_16x16x32_bf16 v[108:111], a[224:227], v[240:243], v[108:111]
    v_mfma_f32_16x16x32_bf16 v[112:115], a[224:227], v[244:247], v[112:115]
    s_waitcnt lgkmcnt(1)
    v_mfma_f32_16x16x32_bf16 v[92:95], a[228:231], v[248:251], v[92:95]
    v_mfma_f32_16x16x32_bf16 v[96:99], a[228:231], v[252:255], v[96:99]
    v_mfma_f32_16x16x32_bf16 v[100:103], a[232:235], v[248:251], v[100:103]
    v_mov_b32 v50, 4
    s_waitcnt vmcnt(10)
    s_mov_b64 exec, 1
    buffer_store_dword v50, v0, s[4:7], s73 offen offset:0 sc1
    s_mov_b64 exec, -1
    v_mfma_f32_16x16x32_bf16 v[104:107], a[232:235], v[252:255], v[104:107]
    s_waitcnt lgkmcnt(0)
    v_mfma_f32_16x16x32_bf16 v[108:111], a[236:239], v[248:251], v[108:111]
    v_mfma_f32_16x16x32_bf16 v[112:115], a[236:239], v[252:255], v[112:115]
L_p2_1:
    v_and_b32 v46, 3, v0
    v_bfe_u32 v47, v0, 4, 1
    v_cmp_ne_u32 vcc, 0, v47
    v_lshrrev_b32 v48, 1, v46
    v_bfe_u32 v47, v0, 2, 2
    v_cndmask_b32 v48, v48, 2, vcc
    v_lshrrev_b32 v8, 5, v0
    v_lshl_add_u32 v47, v8, 2, v47
    v_lshlrev_b32 v8, 2, v48
    v_xor_b32 v47, v47, v8
    v_lshlrev_b32 v47, 4, v47
    v_lshl_add_u32 v47, v48, 9, v47
    v_and_b32 v48, 1, v46
    v_min_u32 v8, 1, v46
    v_cndmask_b32 v8, v48, v8, vcc
    v_xor_b32 v10, 1, v46
    v_min_u32 v10, 1, v10
    v_cndmask_b32 v10, v48, v10, vcc
    v_lshl_add_u32 v8, v8, 3, v47
    v_lshl_add_u32 v10, v10, 3, v47
    v_xor_b32 v9, 0x80, v8
    v_xor_b32 v11, 0x80, v10
    v_add_u32 v8, s79, v8
    v_add_u32 v9, s79, v9
    v_add_u32 v10, s95, v10
    v_add_u32 v11, s95, v11
    v_pk_mul_f32 v[92:93], v[92:93], v[38:39] op_sel:[0,0] op_sel_hi:[1,0]
    v_pk_mul_f32 v[94:95], v[94:95], v[38:39] op_sel:[0,0] op_sel_hi:[1,0]
    v_cvt_pk_bf16_f32 v26, v92, v93
    v_cvt_pk_bf16_f32 v27, v94, v95
    v_pk_mul_f32 v[96:97], v[96:97], v[38:39] op_sel:[0,1] op_sel_hi:[1,1]
    v_pk_mul_f32 v[98:99], v[98:99], v[38:39] op_sel:[0,1] op_sel_hi:[1,1]
    v_cvt_pk_bf16_f32 v28, v96, v97
    v_cvt_pk_bf16_f32 v29, v98, v99
    v_pk_mul_f32 v[108:109], v[108:109], v[38:39] op_sel:[0,0] op_sel_hi:[1,0]
    v_pk_mul_f32 v[110:111], v[110:111], v[38:39] op_sel:[0,0] op_sel_hi:[1,0]
    v_cvt_pk_bf16_f32 v30, v108, v109
    v_cvt_pk_bf16_f32 v31, v110, v111
    v_pk_mul_f32 v[112:113], v[112:113], v[38:39] op_sel:[0,1] op_sel_hi:[1,1]
    v_pk_mul_f32 v[114:115], v[114:115], v[38:39] op_sel:[0,1] op_sel_hi:[1,1]
    v_cvt_pk_bf16_f32 v32, v112, v113
    v_cvt_pk_bf16_f32 v33, v114, v115
    v_permlane16_swap_b32 v26, v28
    v_permlane16_swap_b32 v27, v29
    v_pk_mul_f32 v[100:101], v[100:101], v[38:39] op_sel:[0,0] op_sel_hi:[1,0]
    v_pk_mul_f32 v[102:103], v[102:103], v[38:39] op_sel:[0,0] op_sel_hi:[1,0]
    v_cvt_pk_bf16_f32 v34, v100, v101
    v_cvt_pk_bf16_f32 v35, v102, v103
    v_pk_mul_f32 v[104:105], v[104:105], v[38:39] op_sel:[0,1] op_sel_hi:[1,1]
    v_pk_mul_f32 v[106:107], v[106:107], v[38:39] op_sel:[0,1] op_sel_hi:[1,1]
    v_cvt_pk_bf16_f32 v36, v104, v105
    v_cvt_pk_bf16_f32 v37, v106, v107
    v_permlane16_swap_b32 v30, v32
    v_permlane16_swap_b32 v31, v33
    v_permlane16_swap_b32 v34, v36
    v_permlane16_swap_b32 v35, v37
    v_cndmask_b32 v32, 0, v30, s[48:49]
    v_cndmask_b32 v33, 0, v31, s[48:49]
    v_cndmask_b32 v30, v30, 0, s[48:49]
    v_cndmask_b32 v31, v31, 0, s[48:49]
    s_waitcnt vmcnt(1)
    v_cmp_gt_u32 vcc, 3, v140
    s_nop 0
    s_cbranch_vccz L_ka1ed
L_ka1:
    s_mov_b32 s45, 200000
L_ka1_b:
    buffer_load_dword v140, v49, s[4:7], 0 offen sc1
    s_sub_u32 s45, s45, 1
    s_cbranch_scc1 L_ka1_c
    s_waitcnt vmcnt(0)
    v_cmp_gt_u32 vcc, 3, v140
    s_nop 0
    s_cbranch_vccnz L_ka1_b
L_ka1_c:
    s_waitcnt vmcnt(0)
    s_branch L_ka1ed
L_ka1ed:
    s_add_u32 m0, s79, 12288
    s_add_u32 s42, s93, 5754880
    buffer_load_dwordx4 v40, s[4:7], s42 offen offset:0 sc1 lds
    buffer_load_dwordx4 v40, s[4:7], s42 offen offset:1024 sc1 lds
    buffer_load_dwordx4 v40, s[4:7], s42 offen offset:2048 sc1 lds
    s_add_u32 m0, s79, 0
    s_add_u32 s42, s93, 5742592
    buffer_load_dwordx4 v41, s[4:7], s42 offen offset:0 sc1 lds
    buffer_load_dwordx4 v41, s[4:7], s42 offen offset:1024 sc1 lds
    buffer_load_dwordx4 v41, s[4:7], s42 offen offset:2048 sc1 lds
    s_cmp_ge_u32 s3, 2
    s_cselect_b32 s38, s38, s39
    v_add_u32 v40, s38, v1
    ds_read_b128 a[204:207], v5 offset:24576
    ds_read_b64 a[208:209], v6 offset:27136
    ds_read_b64_tr_b16 a[212:213], v8 offset:25600
    ds_read_b64_tr_b16 a[214:215], v9 offset:25600
    s_waitcnt lgkmcnt(3)
    v_mfma_f32_32x32x16_bf16 v[52:67], a[204:207], v[26:29], v[124:139]
    ds_read_b128 a[204:207], v15 offset:20480
    s_waitcnt lgkmcnt(3)
    v_mfma_f32_32x32x8_bf16 v[52:67], a[208:209], v[30:31], v[52:67]
    v_and_b32 v46, 31, v0
    v_lshrrev_b32 v47, 5, v0
    v_lshrrev_b32 v13, 4, v46
    v_mul_u32_u24 v13, 57344, v13
    v_and_b32 v46, 15, v46
    v_lshl_add_u32 v13, v46, 4, v13
    v_lshl_add_u32 v12, v47, 8, v13
    v_lshl_add_u32 v13, v47, 3, v13
    s_waitcnt lgkmcnt(0)
    v_mfma_f32_32x32x16_bf16 v[68:83], a[204:207], v[34:37], v[124:139]
    s_nop 1
    v_exp_f32 v52, v52
    v_exp_f32 v53, v53
    v_exp_f32 v54, v54
    v_exp_f32 v55, v55
    v_cvt_pk_bf16_f32 v116, v52, v53
    v_cvt_pk_bf16_f32 v117, v54, v55
    v_mfma_f32_32x32x8_bf16 v[68:83], a[208:209], v[32:33], v[68:83]
    v_exp_f32 v56, v56
    v_exp_f32 v57, v57
    v_exp_f32 v58, v58
    v_exp_f32 v59, v59
    v_cvt_pk_bf16_f32 v118, v56, v57
    v_cvt_pk_bf16_f32 v119, v58, v59
    ds_read_b64_tr_b16 a[216:217], v8 offset:25856
    ds_read_b64_tr_b16 a[218:219], v9 offset:25856
    v_exp_f32 v60, v60
    v_exp_f32 v61, v61
    v_exp_f32 v62, v62
    v_exp_f32 v63, v63
    v_cvt_pk_bf16_f32 v120, v60, v61
    v_cvt_pk_bf16_f32 v121, v62, v63
    v_mfma_f32_32x32x16_bf16 v[84:99], a[212:215], v[116:119], 0
    ds_read_b64_tr_b16 a[212:213], v10 offset:21504
    ds_read_b64_tr_b16 a[214:215], v11 offset:21504
    v_exp_f32 v64, v64
    v_exp_f32 v65, v65
    v_exp_f32 v66, v66
    v_exp_f32 v67, v67
    v_cvt_pk_bf16_f32 v122, v64, v65
    v_cvt_pk_bf16_f32 v123, v66, v67
    v_exp_f32 v68, v68
    v_exp_f32 v69, v69
    v_exp_f32 v70, v70
    v_exp_f32 v71, v71
    v_cvt_pk_bf16_f32 v116, v68, v69
    v_cvt_pk_bf16_f32 v117, v70, v71
    v_exp_f32 v72, v72
    v_exp_f32 v73, v73
    v_exp_f32 v74, v74
    v_exp_f32 v75, v75
    v_cvt_pk_bf16_f32 v118, v72, v73
    v_cvt_pk_bf16_f32 v119, v74, v75
    s_waitcnt lgkmcnt(2)
    v_mfma_f32_32x32x16_bf16 v[84:99], a[216:219], v[120:123], v[84:99]
    ds_read_b64_tr_b16 a[216:217], v10 offset:21760
    ds_read_b64_tr_b16 a[218:219], v11 offset:21760
    v_exp_f32 v76, v76
    v_exp_f32 v77, v77
    v_exp_f32 v78, v78
    v_exp_f32 v79, v79
    v_cvt_pk_bf16_f32 v120, v76, v77
    v_cvt_pk_bf16_f32 v121, v78, v79
    s_waitcnt lgkmcnt(2)
    v_mfma_f32_32x32x16_bf16 v[100:115], a[212:215], v[116:119], 0
    v_exp_f32 v80, v80
    v_exp_f32 v81, v81
    v_exp_f32 v82, v82
    v_exp_f32 v83, v83
    v_cvt_pk_bf16_f32 v122, v80, v81
    v_cvt_pk_bf16_f32 v123, v82, v83
    v_xor_b32 v124, s77, v124
    v_xor_b32 v125, s77, v125
    v_xor_b32 v126, s77, v126
    v_xor_b32 v127, s77, v127
    v_xor_b32 v128, s77, v128
    v_xor_b32 v129, s77, v129
    v_xor_b32 v130, s77, v130
    v_xor_b32 v131, s77, v131
    v_xor_b32 v132, s77, v132
    v_xor_b32 v133, s77, v133
    v_xor_b32 v134, s77, v134
    v_xor_b32 v135, s77, v135
    v_xor_b32 v136, s77, v136
    v_xor_b32 v137, s77, v137
    v_xor_b32 v138, s77, v138
    v_xor_b32 v139, s77, v139
    v_bfe_u32 v148, v0, 2, 1
    v_lshlrev_b32 v148, 4, v148
    v_and_or_b32 v148, v0, 3, v148
    v_lshl_add_u32 v148, v148, 7, s85
    v_and_b32 v47, 1, v0
    v_lshl_add_u32 v47, v47, 7, s86
    v_cndmask_b32 v148, v148, v47, s[48:49]
    v_bfe_u32 v47, v0, 3, 1
    v_mul_u32_u24 v47, 57344, v47
    v_add_u32 v148, v148, v47
    v_mov_b32 v47, s63
    v_mul_u32_u24 v149, 48, v47
    v_lshl_add_u32 v47, v47, 2, 32
    v_sub_u32 v47, v47, v149
    v_bfe_i32 v51, v0, 3, 1
    v_and_b32 v47, v47, v51
    v_add_u32 v149, v149, v47
    v_and_b32 v47, 23, v0
    v_add_u32 v149, v149, v47
    v_lshl_add_u32 v149, v149, 7, s82
    v_mov_b32 v47, s84
    v_cndmask_b32 v149, v149, v47, s[48:49]
    s_add_u32 s41, s3, 1
    s_and_b32 s41, s41, 3
    s_mov_b32 s16, s41
    s_mul_i32 s20, s41, 57344
    s_add_u32 s20, s20, s90
    s_add_u32 s41, s3, 2
    s_and_b32 s41, s41, 3
    s_mov_b32 s17, s41
    s_mul_i32 s21, s41, 57344
    s_add_u32 s21, s21, s90
    s_add_u32 s41, s3, 3
    s_and_b32 s41, s41, 3
    s_mov_b32 s18, s41
    s_mul_i32 s22, s41, 57344
    s_add_u32 s22, s22, s90
    s_mul_i32 s23, s3, 57344
    s_add_u32 s23, s23, s90
    v_lshlrev_b32 v48, 2, v0
    v_and_b32 v48, 31, v48
    v_add_u32 v48, s100, v48
    s_waitcnt vmcnt(3)
    s_waitcnt lgkmcnt(0)
    s_barrier
    ds_read_b128 a[204:207], v5 offset:21504
    ds_read_b64 a[208:209], v6 offset:24064
    ds_read_b64_tr_b16 a[212:213], v8 offset:22528
    ds_read_b64_tr_b16 a[214:215], v9 offset:22528
    s_waitcnt lgkmcnt(3)
    v_mfma_f32_32x32x16_bf16 v[52:67], a[204:207], v[26:29], 0
    ds_read_b128 a[204:207], v5 offset:18432
    s_waitcnt lgkmcnt(3)
    v_mfma_f32_32x32x8_bf16 v[52:67], a[208:209], v[30:31], v[52:67]
    ds_read_b64 a[208:209], v6 offset:20992
    s_waitcnt lgkmcnt(1)
    v_mfma_f32_32x32x16_bf16 v[68:83], a[204:207], v[26:29], 0
    ds_read_b128 a[204:207], v5 offset:15360
    buffer_load_dword v46, v49, s[4:7], 0 offen sc1
    s_nop 6
    v_exp_f32 v52, v52
    v_exp_f32 v53, v53
    v_exp_f32 v54, v54
    v_exp_f32 v55, v55
    v_cvt_pk_bf16_f32 v116, v52, v53
    v_cvt_pk_bf16_f32 v117, v54, v55
    s_waitcnt lgkmcnt(1)
    v_mfma_f32_32x32x8_bf16 v[68:83], a[208:209], v[30:31], v[68:83]
    v_exp_f32 v56, v56
    v_exp_f32 v57, v57
    v_exp_f32 v58, v58
    v_exp_f32 v59, v59
    v_cvt_pk_bf16_f32 v118, v56, v57
    v_cvt_pk_bf16_f32 v119, v58, v59
    v_mfma_f32_32x32x16_bf16 v[100:115], a[216:219], v[120:123], v[100:115]
    s_waitcnt lgkmcnt(0)
    ds_read_b64 a[208:209], v6 offset:17920
    ds_read_b64_tr_b16 a[216:217], v8 offset:22784
    ds_read_b64_tr_b16 a[218:219], v9 offset:22784
    v_exp_f32 v60, v60
    v_exp_f32 v61, v61
    v_exp_f32 v62, v62
    v_exp_f32 v63, v63
    v_cvt_pk_bf16_f32 v120, v60, v61
    v_cvt_pk_bf16_f32 v121, v62, v63
    v_mfma_f32_32x32x16_bf16 v[84:99], a[212:215], v[116:119], v[84:99]
    ds_read_b64_tr_b16 a[212:213], v8 offset:19456
    ds_read_b64_tr_b16 a[214:215], v9 offset:19456
    v_exp_f32 v64, v64
    v_exp_f32 v65, v65
    v_exp_f32 v66, v66
    v_exp_f32 v67, v67
    v_cvt_pk_bf16_f32 v122, v64, v65
    v_cvt_pk_bf16_f32 v123, v66, v67
    v_mfma_f32_32x32x16_bf16 v[52:67], a[204:207], v[26:29], 0
    s_waitcnt lgkmcnt(2)
    ds_read_b128 a[204:207], v5 offset:12288
    s_mov_b32 exec_lo, 0xffff
    s_mov_b32 exec_hi, 0x303
    buffer_load_dword v51, v148, s[4:7], 0 offen sc1
    s_mov_b64 exec, -1
    v_exp_f32 v68, v68
    v_exp_f32 v69, v69
    v_exp_f32 v70, v70
    v_exp_f32 v71, v71
    v_cvt_pk_bf16_f32 v116, v68, v69
    v_cvt_pk_bf16_f32 v117, v70, v71
    v_mfma_f32_32x32x8_bf16 v[52:67], a[208:209], v[30:31], v[52:67]
    v_exp_f32 v72, v72
    v_exp_f32 v73, v73
    v_exp_f32 v74, v74
    v_exp_f32 v75, v75
    v_cvt_pk_bf16_f32 v118, v72, v73
    v_cvt_pk_bf16_f32 v119, v74, v75
    v_mfma_f32_32x32x16_bf16 v[84:99], a[216:219], v[120:123], v[84:99]
    s_waitcnt lgkmcnt(0)
    ds_read_b64 a[208:209], v6 offset:14848
    ds_read_b64_tr_b16 a[216:217], v8 offset:19712
    ds_read_b64_tr_b16 a[218:219], v9 offset:19712
    v_exp_f32 v76, v76
    v_exp_f32 v77, v77
    v_exp_f32 v78, v78
    v_exp_f32 v79, v79
    v_cvt_pk_bf16_f32 v120, v76, v77
    v_cvt_pk_bf16_f32 v121, v78, v79
    v_mfma_f32_32x32x16_bf16 v[84:99], a[212:215], v[116:119], v[84:99]
    ds_read_b64_tr_b16 a[212:213], v8 offset:16384
    ds_read_b64_tr_b16 a[214:215], v9 offset:16384
    s_mov_b32 exec_lo, 0xff0fff
    s_mov_b32 exec_hi, 1
    buffer_load_dword v51, v149, s[4:7], 0 offen sc1
    s_mov_b64 exec, -1
    v_exp_f32 v80, v80
    v_exp_f32 v81, v81
    v_exp_f32 v82, v82
    v_exp_f32 v83, v83
    v_cvt_pk_bf16_f32 v122, v80, v81
    v_cvt_pk_bf16_f32 v123, v82, v83
    v_mfma_f32_32x32x16_bf16 v[68:83], a[204:207], v[26:29], 0
    s_waitcnt lgkmcnt(2)
    s_add_u32 s43, s91, 0
    buffer_load_dwordx4 v[156:159], v1, s[4:7], s43 offen offset:0 sc1
    v_exp_f32 v52, v52
    v_exp_f32 v53, v53
    v_exp_f32 v54, v54
    v_exp_f32 v55, v55
    v_cvt_pk_bf16_f32 v116, v52, v53
    v_cvt_pk_bf16_f32 v117, v54, v55
    v_mfma_f32_32x32x8_bf16 v[68:83], a[208:209], v[30:31], v[68:83]
    v_exp_f32 v56, v56
    v_exp_f32 v57, v57
    v_exp_f32 v58, v58
    v_exp_f32 v59, v59
    v_cvt_pk_bf16_f32 v118, v56, v57
    v_cvt_pk_bf16_f32 v119, v58, v59
    v_mfma_f32_32x32x16_bf16 v[84:99], a[216:219], v[120:123], v[84:99]
    s_waitcnt vmcnt(4)
    s_barrier
    ds_read_b128 a[204:207], v5 offset:9216
    ds_read_b64 a[208:209], v6 offset:11776
    ds_read_b64_tr_b16 a[216:217], v8 offset:16640
    ds_read_b64_tr_b16 a[218:219], v9 offset:16640
    s_waitcnt vmcnt(3)
    v_cmp_gt_u32 vcc, 4, v46
    s_nop 0
    s_cbranch_vccnz L_kb1
L_kb1ed:
    s_mul_i32 m0, s3, 5120
    s_add_u32 m0, m0, 133120
    s_add_u32 s42, s96, 5746688
    buffer_load_dwordx4 v40, s[4:7], s42 offen offset:0 sc1 lds
    buffer_load_dwordx4 v40, s[4:7], s42 offen offset:1024 sc1 lds
    buffer_load_dwordx4 v40, s[4:7], s42 offen offset:2048 sc1 lds
    buffer_load_dwordx4 v40, s[4:7], s42 offen offset:3072 sc1 lds
    s_mul_i32 m0, s3, 5120
    s_add_u32 m0, m0, 137216
    s_add_u32 s42, s96, 5750784
    buffer_load_dwordx4 v40, s[4:7], s42 offen offset:0 sc1 lds
    v_exp_f32 v60, v60
    v_exp_f32 v61, v61
    v_exp_f32 v62, v62
    v_exp_f32 v63, v63
    v_cvt_pk_bf16_f32 v120, v60, v61
    v_cvt_pk_bf16_f32 v121, v62, v63
    s_waitcnt lgkmcnt(4)
    v_mfma_f32_32x32x16_bf16 v[84:99], a[212:215], v[116:119], v[84:99]
    ds_read_b64_tr_b16 a[212:213], v8 offset:13312
    ds_read_b64_tr_b16 a[214:215], v9 offset:13312
    buffer_load_dwordx4 v[160:163], v1, s[4:7], s43 offen offset:1024 sc1
    v_exp_f32 v64, v64
    v_exp_f32 v65, v65
    v_exp_f32 v66, v66
    v_exp_f32 v67, v67
    v_cvt_pk_bf16_f32 v122, v64, v65
    v_cvt_pk_bf16_f32 v123, v66, v67
    s_waitcnt lgkmcnt(5)
    v_mfma_f32_32x32x16_bf16 v[52:67], a[204:207], v[26:29], 0
    s_waitcnt lgkmcnt(2)
    ds_read_b128 a[204:207], v5 offset:6144
    buffer_load_dwordx4 v[164:167], v1, s[4:7], s43 offen offset:2048 sc1
    v_exp_f32 v68, v68
    v_exp_f32 v69, v69
    v_exp_f32 v70, v70
    v_exp_f32 v71, v71
    v_cvt_pk_bf16_f32 v116, v68, v69
    v_cvt_pk_bf16_f32 v117, v70, v71
    v_mfma_f32_32x32x8_bf16 v[52:67], a[208:209], v[30:31], v[52:67]
    v_exp_f32 v72, v72
    v_exp_f32 v73, v73
    v_exp_f32 v74, v74
    v_exp_f32 v75, v75
    v_cvt_pk_bf16_f32 v118, v72, v73
    v_cvt_pk_bf16_f32 v119, v74, v75
    v_mfma_f32_32x32x16_bf16 v[84:99], a[216:219], v[120:123], v[84:99]
    s_waitcnt lgkmcnt(0)
    ds_read_b64 a[208:209], v6 offset:8704
    ds_read_b64_tr_b16 a[216:217], v8 offset:13568
    ds_read_b64_tr_b16 a[218:219], v9 offset:13568
    v_exp_f32 v76, v76
    v_exp_f32 v77, v77
    v_exp_f32 v78, v78
    v_exp_f32 v79, v79
    v_cvt_pk_bf16_f32 v120, v76, v77
    v_cvt_pk_bf16_f32 v121, v78, v79
    v_mfma_f32_32x32x16_bf16 v[84:99], a[212:215], v[116:119], v[84:99]
    ds_read_b64_tr_b16 a[212:213], v8 offset:10240
    ds_read_b64_tr_b16 a[214:215], v9 offset:10240
    buffer_load_dwordx4 v[168:171], v1, s[4:7], s43 offen offset:3072 sc1
    v_exp_f32 v80, v80
    v_exp_f32 v81, v81
    v_exp_f32 v82, v82
    v_exp_f32 v83, v83
    v_cvt_pk_bf16_f32 v122, v80, v81
    v_cvt_pk_bf16_f32 v123, v82, v83
    v_mfma_f32_32x32x16_bf16 v[68:83], a[204:207], v[26:29], 0
    s_waitcnt lgkmcnt(2)
    ds_read_b128 a[204:207], v5 offset:3072
    s_add_u32 s43, s91, 4096
    buffer_load_dwordx4 v[172:175], v1, s[4:7], s43 offen offset:0 sc1
    v_exp_f32 v52, v52
    v_exp_f32 v53, v53
    v_exp_f32 v54, v54
    v_exp_f32 v55, v55
    v_cvt_pk_bf16_f32 v116, v52, v53
    v_cvt_pk_bf16_f32 v117, v54, v55
    v_mfma_f32_32x32x8_bf16 v[68:83], a[208:209], v[30:31], v[68:83]
    v_exp_f32 v56, v56
    v_exp_f32 v57, v57
    v_exp_f32 v58, v58
    v_exp_f32 v59, v59
    v_cvt_pk_bf16_f32 v118, v56, v57
    v_cvt_pk_bf16_f32 v119, v58, v59
    v_mfma_f32_32x32x16_bf16 v[84:99], a[216:219], v[120:123], v[84:99]
    s_waitcnt lgkmcnt(0)
    ds_read_b64 a[208:209], v6 offset:5632
    ds_read_b64_tr_b16 a[216:217], v8 offset:10496
    ds_read_b64_tr_b16 a[218:219], v9 offset:10496
    v_exp_f32 v60, v60
    v_exp_f32 v61, v61
    v_exp_f32 v62, v62
    v_exp_f32 v63, v63
    v_cvt_pk_bf16_f32 v120, v60, v61
    v_cvt_pk_bf16_f32 v121, v62, v63
    v_mfma_f32_32x32x16_bf16 v[84:99], a[212:215], v[116:119], v[84:99]
    ds_read_b64_tr_b16 a[212:213], v8 offset:7168
    ds_read_b64_tr_b16 a[214:215], v9 offset:7168
    buffer_load_dwordx4 v[176:179], v1, s[4:7], s43 offen offset:1024 sc1
    v_exp_f32 v64, v64
    v_exp_f32 v65, v65
    v_exp_f32 v66, v66
    v_exp_f32 v67, v67
    v_cvt_pk_bf16_f32 v122, v64, v65
    v_cvt_pk_bf16_f32 v123, v66, v67
    v_mfma_f32_32x32x16_bf16 v[52:67], a[204:207], v[26:29], 0
    s_waitcnt lgkmcnt(2)
    ds_read_b128 a[204:207], v5 offset:0
    buffer_load_dwordx4 v[180:183], v1, s[4:7], s43 offen offset:2048 sc1
    v_exp_f32 v68, v68
    v_exp_f32 v69, v69
    v_exp_f32 v70, v70
    v_exp_f32 v71, v71
    v_cvt_pk_bf16_f32 v116, v68, v69
    v_cvt_pk_bf16_f32 v117, v70, v71
    v_mfma_f32_32x32x8_bf16 v[52:67], a[208:209], v[30:31], v[52:67]
    v_exp_f32 v72, v72
    v_exp_f32 v73, v73
    v_exp_f32 v74, v74
    v_exp_f32 v75, v75
    v_cvt_pk_bf16_f32 v118, v72, v73
    v_cvt_pk_bf16_f32 v119, v74, v75
    v_mfma_f32_32x32x16_bf16 v[84:99], a[216:219], v[120:123], v[84:99]
    s_waitcnt lgkmcnt(0)
    ds_read_b64 a[208:209], v6 offset:2560
    ds_read_b64_tr_b16 a[216:217], v8 offset:7424
    ds_read_b64_tr_b16 a[218:219], v9 offset:7424
    v_exp_f32 v76, v76
    v_exp_f32 v77, v77
    v_exp_f32 v78, v78
    v_exp_f32 v79, v79
    v_cvt_pk_bf16_f32 v120, v76, v77
    v_cvt_pk_bf16_f32 v121, v78, v79
    v_mfma_f32_32x32x16_bf16 v[84:99], a[212:215], v[116:119], v[84:99]
    ds_read_b64_tr_b16 a[212:213], v8 offset:4096
    ds_read_b64_tr_b16 a[214:215], v9 offset:4096
    buffer_load_dwordx4 v[184:187], v1, s[4:7], s43 offen offset:3072 sc1
    v_exp_f32 v80, v80
    v_exp_f32 v81, v81
    v_exp_f32 v82, v82
    v_exp_f32 v83, v83
    v_cvt_pk_bf16_f32 v122, v80, v81
    v_cvt_pk_bf16_f32 v123, v82, v83
    v_mfma_f32_32x32x16_bf16 v[68:83], a[204:207], v[26:29], v[124:139]
    s_waitcnt lgkmcnt(2)
    s_add_u32 s43, s91, 8192
    buffer_load_dwordx4 v[188:191], v1, s[4:7], s43 offen offset:0 sc1
    v_exp_f32 v52, v52
    v_exp_f32 v53, v53
    v_exp_f32 v54, v54
    v_exp_f32 v55, v55
    v_cvt_pk_bf16_f32 v116, v52, v53
    v_cvt_pk_bf16_f32 v117, v54, v55
    v_mfma_f32_32x32x8_bf16 v[68:83], a[208:209], v[30:31], v[68:83]
    v_exp_f32 v56, v56
    v_exp_f32 v57, v57
    v_exp_f32 v58, v58
    v_exp_f32 v59, v59
    v_cvt_pk_bf16_f32 v118, v56, v57
    v_cvt_pk_bf16_f32 v119, v58, v59
    v_mfma_f32_32x32x16_bf16 v[84:99], a[216:219], v[120:123], v[84:99]
    s_waitcnt vmcnt(8)
    s_barrier
    ds_read_b128 a[204:207], v15 offset:17920
    ds_read_b64 a[208:209], v6 offset:24064
    ds_read_b64_tr_b16 a[216:217], v8 offset:4352
    ds_read_b64_tr_b16 a[218:219], v9 offset:4352
    v_exp_f32 v60, v60
    v_exp_f32 v61, v61
    v_exp_f32 v62, v62
    v_exp_f32 v63, v63
    v_cvt_pk_bf16_f32 v120, v60, v61
    v_cvt_pk_bf16_f32 v121, v62, v63
    s_waitcnt lgkmcnt(4)
    v_mfma_f32_32x32x16_bf16 v[84:99], a[212:215], v[116:119], v[84:99]
    ds_read_b64_tr_b16 a[212:213], v8 offset:1024
    ds_read_b64_tr_b16 a[214:215], v9 offset:1024
    buffer_load_dwordx4 v[192:195], v1, s[4:7], s43 offen offset:1024 sc1
    v_exp_f32 v64, v64
    v_exp_f32 v65, v65
    v_exp_f32 v66, v66
    v_exp_f32 v67, v67
    v_cvt_pk_bf16_f32 v122, v64, v65
    v_cvt_pk_bf16_f32 v123, v66, v67
    s_waitcnt lgkmcnt(5)
    v_mfma_f32_32x32x16_bf16 v[52:67], a[204:207], v[34:37], 0
    s_waitcnt lgkmcnt(2)
    ds_read_b128 a[204:207], v15 offset:15360
    buffer_load_dwordx4 v[196:199], v1, s[4:7], s43 offen offset:2048 sc1
    v_exp_f32 v68, v68
    v_exp_f32 v69, v69
    v_exp_f32 v70, v70
    v_exp_f32 v71, v71
    v_cvt_pk_bf16_f32 v116, v68, v69
    v_cvt_pk_bf16_f32 v117, v70, v71
    v_mfma_f32_32x32x8_bf16 v[52:67], a[208:209], v[32:33], v[52:67]
    v_exp_f32 v72, v72
    v_exp_f32 v73, v73
    v_exp_f32 v74, v74
    v_exp_f32 v75, v75
    v_cvt_pk_bf16_f32 v118, v72, v73
    v_cvt_pk_bf16_f32 v119, v74, v75
    v_mfma_f32_32x32x16_bf16 v[84:99], a[216:219], v[120:123], v[84:99]
    s_waitcnt lgkmcnt(0)
    ds_read_b64 a[208:209], v6 offset:20992
    ds_read_b64_tr_b16 a[216:217], v8 offset:1280
    ds_read_b64_tr_b16 a[218:219], v9 offset:1280
    v_exp_f32 v76, v76
    v_exp_f32 v77, v77
    v_exp_f32 v78, v78
    v_exp_f32 v79, v79
    v_cvt_pk_bf16_f32 v120, v76, v77
    v_cvt_pk_bf16_f32 v121, v78, v79
    v_mfma_f32_32x32x16_bf16 v[84:99], a[212:215], v[116:119], v[84:99]
    ds_read_b64_tr_b16 a[212:213], v10 offset:18944
    ds_read_b64_tr_b16 a[214:215], v11 offset:18944
    buffer_load_dwordx4 v[200:203], v1, s[4:7], s43 offen offset:3072 sc1
    v_exp_f32 v80, v80
    v_exp_f32 v81, v81
    v_exp_f32 v82, v82
    v_exp_f32 v83, v83
    v_cvt_pk_bf16_f32 v122, v80, v81
    v_cvt_pk_bf16_f32 v123, v82, v83
    v_mfma_f32_32x32x16_bf16 v[68:83], a[204:207], v[34:37], 0
    s_waitcnt lgkmcnt(2)
    ds_read_b128 a[204:207], v15 offset:12800
    s_add_u32 s43, s91, 12288
    buffer_load_dwordx4 v[204:207], v1, s[4:7], s43 offen offset:0 sc1
    v_exp_f32 v52, v52
    v_exp_f32 v53, v53
    v_exp_f32 v54, v54
    v_exp_f32 v55, v55
    v_cvt_pk_bf16_f32 v116, v52, v53
    v_cvt_pk_bf16_f32 v117, v54, v55
    v_mfma_f32_32x32x8_bf16 v[68:83], a[208:209], v[32:33], v[68:83]
    v_exp_f32 v56, v56
    v_exp_f32 v57, v57
    v_exp_f32 v58, v58
    v_exp_f32 v59, v59
    v_cvt_pk_bf16_f32 v118, v56, v57
    v_cvt_pk_bf16_f32 v119, v58, v59
    v_mfma_f32_32x32x16_bf16 v[84:99], a[216:219], v[120:123], v[84:99]
    s_waitcnt lgkmcnt(0)
    ds_read_b64 a[208:209], v6 offset:17920
    ds_read_b64_tr_b16 a[216:217], v10 offset:19200
    ds_read_b64_tr_b16 a[218:219], v11 offset:19200
    v_exp_f32 v60, v60
    v_exp_f32 v61, v61
    v_exp_f32 v62, v62
    v_exp_f32 v63, v63
    v_cvt_pk_bf16_f32 v120, v60, v61
    v_cvt_pk_bf16_f32 v121, v62, v63
    v_mfma_f32_32x32x16_bf16 v[100:115], a[212:215], v[116:119], v[100:115]
    ds_read_b64_tr_b16 a[212:213], v10 offset:16384
    ds_read_b64_tr_b16 a[214:215], v11 offset:16384
    buffer_load_dwordx4 v[208:211], v1, s[4:7], s43 offen offset:1024 sc1
    v_exp_f32 v64, v64
    v_exp_f32 v65, v65
    v_exp_f32 v66, v66
    v_exp_f32 v67, v67
    v_cvt_pk_bf16_f32 v122, v64, v65
    v_cvt_pk_bf16_f32 v123, v66, v67
    s_mov_b32 s34, 671088640
    v_subrev_u32 v46, 729808896, v96
    v_cmp_lt_u32 vcc, s34, v46
    s_nop 0
    s_cmp_eq_u64 vcc, 0
    s_cselect_b32 s55, -1, 0
    v_rcp_f32 v44, v96
    s_nop 0
    v_mul_f32 v84, v44, v84
    v_mul_f32 v85, v44, v85
    v_mul_f32 v86, v44, v86
    v_mul_f32 v87, v44, v87
    v_mul_f32 v88, v44, v88
    v_mul_f32 v89, v44, v89
    v_mul_f32 v90, v44, v90
    v_mul_f32 v91, v44, v91
    v_mul_f32 v92, v44, v92
    v_mul_f32 v93, v44, v93
    v_mul_f32 v94, v44, v94
    v_mul_f32 v95, v44, v95
    v_cvt_pk_bf16_f32 v142, v84, v85
    v_cvt_pk_bf16_f32 v143, v86, v87
    v_cvt_pk_bf16_f32 v144, v88, v89
    v_cvt_pk_bf16_f32 v145, v90, v91
    v_cvt_pk_bf16_f32 v146, v92, v93
    v_cvt_pk_bf16_f32 v147, v94, v95
    v_mfma_f32_32x32x16_bf16 v[52:67], a[204:207], v[34:37], 0
    s_waitcnt lgkmcnt(2)
    ds_read_b128 a[204:207], v15 offset:10240
    s_mov_b32 exec_lo, s55
    s_mov_b32 exec_hi, s55
    s_cmp_lg_u32 s50, 0
    s_cbranch_scc1 L_wt_53
    buffer_store_dwordx4 v[142:145], v12, s[4:7], s85 offen
L_bk_54:
    s_mov_b64 exec, -1
    buffer_load_dwordx4 v[212:215], v1, s[4:7], s43 offen offset:2048 sc1
    v_exp_f32 v68, v68
    v_exp_f32 v69, v69
    v_exp_f32 v70, v70
    v_exp_f32 v71, v71
    v_cvt_pk_bf16_f32 v116, v68, v69
    v_cvt_pk_bf16_f32 v117, v70, v71
    v_mfma_f32_32x32x8_bf16 v[52:67], a[208:209], v[32:33], v[52:67]
    v_exp_f32 v72, v72
    v_exp_f32 v73, v73
    v_exp_f32 v74, v74
    v_exp_f32 v75, v75
    v_cvt_pk_bf16_f32 v118, v72, v73
    v_cvt_pk_bf16_f32 v119, v74, v75
    v_mfma_f32_32x32x16_bf16 v[100:115], a[216:219], v[120:123], v[100:115]
    s_waitcnt lgkmcnt(0)
    ds_read_b64 a[208:209], v6 offset:14848
    ds_read_b64_tr_b16 a[216:217], v10 offset:16640
    ds_read_b64_tr_b16 a[218:219], v11 offset:16640
    v_exp_f32 v76, v76
    v_exp_f32 v77, v77
    v_exp_f32 v78, v78
    v_exp_f32 v79, v79
    v_cvt_pk_bf16_f32 v120, v76, v77
    v_cvt_pk_bf16_f32 v121, v78, v79
    v_mfma_f32_32x32x16_bf16 v[100:115], a[212:215], v[116:119], v[100:115]
    ds_read_b64_tr_b16 a[212:213], v10 offset:13824
    ds_read_b64_tr_b16 a[214:215], v11 offset:13824
    buffer_load_dwordx4 v[216:219], v1, s[4:7], s43 offen offset:3072 sc1
    v_exp_f32 v80, v80
    v_exp_f32 v81, v81
    v_exp_f32 v82, v82
    v_exp_f32 v83, v83
    v_cvt_pk_bf16_f32 v122, v80, v81
    v_cvt_pk_bf16_f32 v123, v82, v83
    v_mfma_f32_32x32x16_bf16 v[68:83], a[204:207], v[34:37], 0
    s_waitcnt lgkmcnt(2)
    ds_read_b128 a[204:207], v15 offset:7680
    s_add_u32 s43, s91, 16384
    buffer_load_dwordx4 v[220:223], v1, s[4:7], s43 offen offset:0 sc1
    v_exp_f32 v52, v52
    v_exp_f32 v53, v53
    v_exp_f32 v54, v54
    v_exp_f32 v55, v55
    v_cvt_pk_bf16_f32 v116, v52, v53
    v_cvt_pk_bf16_f32 v117, v54, v55
    v_mfma_f32_32x32x8_bf16 v[68:83], a[208:209], v[32:33], v[68:83]
    v_exp_f32 v56, v56
    v_exp_f32 v57, v57
    v_exp_f32 v58, v58
    v_exp_f32 v59, v59
    v_cvt_pk_bf16_f32 v118, v56, v57
    v_cvt_pk_bf16_f32 v119, v58, v59
    v_mfma_f32_32x32x16_bf16 v[100:115], a[216:219], v[120:123], v[100:115]
    s_waitcnt lgkmcnt(0)
    ds_read_b64 a[208:209], v6 offset:11776
    ds_read_b64_tr_b16 a[216:217], v10 offset:14080
    ds_read_b64_tr_b16 a[218:219], v11 offset:14080
    v_exp_f32 v60, v60
    v_exp_f32 v61, v61
    v_exp_f32 v62, v62
    v_exp_f32 v63, v63
    v_cvt_pk_bf16_f32 v120, v60, v61
    v_cvt_pk_bf16_f32 v121, v62, v63
    v_mfma_f32_32x32x16_bf16 v[100:115], a[212:215], v[116:119], v[100:115]
    ds_read_b64_tr_b16 a[212:213], v10 offset:11264
    ds_read_b64_tr_b16 a[214:215], v11 offset:11264
    buffer_load_dwordx4 v[224:227], v1, s[4:7], s43 offen offset:1024 sc1
    v_exp_f32 v64, v64
    v_exp_f32 v65, v65
    v_exp_f32 v66, v66
    v_exp_f32 v67, v67
    v_cvt_pk_bf16_f32 v122, v64, v65
    v_cvt_pk_bf16_f32 v123, v66, v67
    v_mfma_f32_32x32x16_bf16 v[52:67], a[204:207], v[34:37], 0
    s_waitcnt lgkmcnt(2)
    ds_read_b128 a[204:207], v15 offset:5120
    v_mov_b32 v50, 5
    s_waitcnt vmcnt(4)
    s_mov_b32 s46, s55
    s_and_b64 exec, s[46:47], 1
    s_cmp_lg_u32 s50, 0
    s_cbranch_scc1 L_wt_55
    buffer_store_dword v50, v0, s[4:7], s101 offen offset:0
L_bk_56:
    s_mov_b64 exec, -1
    buffer_load_dwordx4 v[228:231], v1, s[4:7], s43 offen offset:2048 sc1
    v_exp_f32 v68, v68
    v_exp_f32 v69, v69
    v_exp_f32 v70, v70
    v_exp_f32 v71, v71
    v_cvt_pk_bf16_f32 v116, v68, v69
    v_cvt_pk_bf16_f32 v117, v70, v71
    v_mfma_f32_32x32x8_bf16 v[52:67], a[208:209], v[32:33], v[52:67]
    v_exp_f32 v72, v72
    v_exp_f32 v73, v73
    v_exp_f32 v74, v74
    v_exp_f32 v75, v75
    v_cvt_pk_bf16_f32 v118, v72, v73
    v_cvt_pk_bf16_f32 v119, v74, v75
    v_mfma_f32_32x32x16_bf16 v[100:115], a[216:219], v[120:123], v[100:115]
    s_waitcnt lgkmcnt(0)
    ds_read_b64 a[208:209], v6 offset:8704
    ds_read_b64_tr_b16 a[216:217], v10 offset:11520
    ds_read_b64_tr_b16 a[218:219], v11 offset:11520
    v_exp_f32 v76, v76
    v_exp_f32 v77, v77
    v_exp_f32 v78, v78
    v_exp_f32 v79, v79
    v_cvt_pk_bf16_f32 v120, v76, v77
    v_cvt_pk_bf16_f32 v121, v78, v79
    v_mfma_f32_32x32x16_bf16 v[100:115], a[212:215], v[116:119], v[100:115]
    ds_read_b64_tr_b16 a[212:213], v10 offset:8704
    ds_read_b64_tr_b16 a[214:215], v11 offset:8704
    buffer_load_dwordx4 v[232:235], v1, s[4:7], s43 offen offset:3072 sc1
    v_exp_f32 v80, v80
    v_exp_f32 v81, v81
    v_exp_f32 v82, v82
    v_exp_f32 v83, v83
    v_cvt_pk_bf16_f32 v122, v80, v81
    v_cvt_pk_bf16_f32 v123, v82, v83
    v_mfma_f32_32x32x16_bf16 v[68:83], a[204:207], v[34:37], 0
    s_waitcnt lgkmcnt(2)
    ds_read_b128 a[204:207], v15 offset:2560
    s_add_u32 s43, s91, 20480
    buffer_load_dwordx4 v[236:239], v1, s[4:7], s43 offen offset:0 sc1
    v_exp_f32 v52, v52
    v_exp_f32 v53, v53
    v_exp_f32 v54, v54
    v_exp_f32 v55, v55
    v_cvt_pk_bf16_f32 v116, v52, v53
    v_cvt_pk_bf16_f32 v117, v54, v55
    v_mfma_f32_32x32x8_bf16 v[68:83], a[208:209], v[32:33], v[68:83]
    v_exp_f32 v56, v56
    v_exp_f32 v57, v57
    v_exp_f32 v58, v58
    v_exp_f32 v59, v59
    v_cvt_pk_bf16_f32 v118, v56, v57
    v_cvt_pk_bf16_f32 v119, v58, v59
    v_mfma_f32_32x32x16_bf16 v[100:115], a[216:219], v[120:123], v[100:115]
    s_waitcnt lgkmcnt(0)
    ds_read_b64 a[208:209], v6 offset:5632
    ds_read_b64_tr_b16 a[216:217], v10 offset:8960
    ds_read_b64_tr_b16 a[218:219], v11 offset:8960
    v_exp_f32 v60, v60
    v_exp_f32 v61, v61
    v_exp_f32 v62, v62
    v_exp_f32 v63, v63
    v_cvt_pk_bf16_f32 v120, v60, v61
    v_cvt_pk_bf16_f32 v121, v62, v63
    v_mfma_f32_32x32x16_bf16 v[100:115], a[212:215], v[116:119], v[100:115]
    ds_read_b64_tr_b16 a[212:213], v10 offset:6144
    ds_read_b64_tr_b16 a[214:215], v11 offset:6144
    buffer_load_dwordx4 v[240:243], v1, s[4:7], s43 offen offset:1024 sc1
    v_exp_f32 v64, v64
    v_exp_f32 v65, v65
    v_exp_f32 v66, v66
    v_exp_f32 v67, v67
    v_cvt_pk_bf16_f32 v122, v64, v65
    v_cvt_pk_bf16_f32 v123, v66, v67
    v_mfma_f32_32x32x16_bf16 v[52:67], a[204:207], v[34:37], 0
    s_waitcnt lgkmcnt(2)
    ds_read_b128 a[204:207], v15 offset:0
    buffer_load_dwordx4 v[244:247], v1, s[4:7], s43 offen offset:2048 sc1
    v_exp_f32 v68, v68
    v_exp_f32 v69, v69
    v_exp_f32 v70, v70
    v_exp_f32 v71, v71
    v_cvt_pk_bf16_f32 v116, v68, v69
    v_cvt_pk_bf16_f32 v117, v70, v71
    v_mfma_f32_32x32x8_bf16 v[52:67], a[208:209], v[32:33], v[52:67]
    v_exp_f32 v72, v72
    v_exp_f32 v73, v73
    v_exp_f32 v74, v74
    v_exp_f32 v75, v75
    v_cvt_pk_bf16_f32 v118, v72, v73
    v_cvt_pk_bf16_f32 v119, v74, v75
    v_mfma_f32_32x32x16_bf16 v[100:115], a[216:219], v[120:123], v[100:115]
    s_waitcnt lgkmcnt(0)
    ds_read_b64 a[208:209], v6 offset:2560
    ds_read_b64_tr_b16 a[216:217], v10 offset:6400
    ds_read_b64_tr_b16 a[218:219], v11 offset:6400
    v_exp_f32 v76, v76
    v_exp_f32 v77, v77
    v_exp_f32 v78, v78
    v_exp_f32 v79, v79
    v_cvt_pk_bf16_f32 v120, v76, v77
    v_cvt_pk_bf16_f32 v121, v78, v79
    v_mfma_f32_32x32x16_bf16 v[100:115], a[212:215], v[116:119], v[100:115]
    ds_read_b64_tr_b16 a[212:213], v10 offset:3584
    ds_read_b64_tr_b16 a[214:215], v11 offset:3584
    buffer_load_dwordx4 v[248:251], v1, s[4:7], s43 offen offset:3072 sc1
    v_exp_f32 v80, v80
    v_exp_f32 v81, v81
    v_exp_f32 v82, v82
    v_exp_f32 v83, v83
    v_cvt_pk_bf16_f32 v122, v80, v81
    v_cvt_pk_bf16_f32 v123, v82, v83
    v_mfma_f32_32x32x16_bf16 v[68:83], a[204:207], v[34:37], v[124:139]
    s_waitcnt lgkmcnt(2)
    s_add_u32 s43, s91, 24576
    buffer_load_dwordx4 v[252:255], v1, s[4:7], s43 offen offset:0 sc1
    v_exp_f32 v52, v52
    v_exp_f32 v53, v53
    v_exp_f32 v54, v54
    v_exp_f32 v55, v55
    v_cvt_pk_bf16_f32 v116, v52, v53
    v_cvt_pk_bf16_f32 v117, v54, v55
    v_mfma_f32_32x32x8_bf16 v[68:83], a[208:209], v[32:33], v[68:83]
    v_exp_f32 v56, v56
    v_exp_f32 v57, v57
    v_exp_f32 v58, v58
    v_exp_f32 v59, v59
    v_cvt_pk_bf16_f32 v118, v56, v57
    v_cvt_pk_bf16_f32 v119, v58, v59
    v_mfma_f32_32x32x16_bf16 v[100:115], a[216:219], v[120:123], v[100:115]
    ds_read_b64_tr_b16 a[216:217], v10 offset:3840
    ds_read_b64_tr_b16 a[218:219], v11 offset:3840
    v_exp_f32 v60, v60
    v_exp_f32 v61, v61
    v_exp_f32 v62, v62
    v_exp_f32 v63, v63
    v_cvt_pk_bf16_f32 v120, v60, v61
    v_cvt_pk_bf16_f32 v121, v62, v63
    s_waitcnt lgkmcnt(2)
    v_mfma_f32_32x32x16_bf16 v[100:115], a[212:215], v[116:119], v[100:115]
    ds_read_b64_tr_b16 a[212:213], v10 offset:1024
    ds_read_b64_tr_b16 a[214:215], v11 offset:1024
    buffer_load_dword v47, v48, s[4:7], 0 offen sc1
    v_exp_f32 v64, v64
    v_exp_f32 v65, v65
    v_exp_f32 v66, v66
    v_exp_f32 v67, v67
    v_cvt_pk_bf16_f32 v122, v64, v65
    v_cvt_pk_bf16_f32 v123, v66, v67
    v_exp_f32 v68, v68
    v_exp_f32 v69, v69
    v_exp_f32 v70, v70
    v_exp_f32 v71, v71
    v_cvt_pk_bf16_f32 v116, v68, v69
    v_cvt_pk_bf16_f32 v117, v70, v71
    v_exp_f32 v72, v72
    v_exp_f32 v73, v73
    v_exp_f32 v74, v74
    v_exp_f32 v75, v75
    v_cvt_pk_bf16_f32 v118, v72, v73
    v_cvt_pk_bf16_f32 v119, v74, v75
    s_waitcnt lgkmcnt(2)
    v_mfma_f32_32x32x16_bf16 v[100:115], a[216:219], v[120:123], v[100:115]
    ds_read_b64_tr_b16 a[216:217], v10 offset:1280
    ds_read_b64_tr_b16 a[218:219], v11 offset:1280
    v_exp_f32 v76, v76
    v_exp_f32 v77, v77
    v_exp_f32 v78, v78
    v_exp_f32 v79, v79
    v_cvt_pk_bf16_f32 v120, v76, v77
    v_cvt_pk_bf16_f32 v121, v78, v79
    s_waitcnt lgkmcnt(2)
    v_mfma_f32_32x32x16_bf16 v[100:115], a[212:215], v[116:119], v[100:115]
    v_exp_f32 v80, v80
    v_exp_f32 v81, v81
    v_exp_f32 v82, v82
    v_exp_f32 v83, v83
    v_cvt_pk_bf16_f32 v122, v80, v81
    v_cvt_pk_bf16_f32 v123, v82, v83
    s_waitcnt lgkmcnt(0)
    s_nop 0
    v_mfma_f32_32x32x16_bf16 v[100:115], a[216:219], v[120:123], v[100:115]
    s_mov_b32 s34, 671088640
    s_mov_b32 s40, 1
    s_nop 9
    v_subrev_u32 v46, 729808896, v112
    v_cmp_lt_u32 vcc, s34, v46
    s_nop 0
    s_cmp_eq_u64 vcc, 0
    s_cselect_b32 s34, s55, 0
    s_cmp_eq_u32 s34, 0
    s_cbranch_scc1 L_truemax
L_norm1:
    v_rcp_f32 v44, v112
    s_nop 0
    v_pk_mul_f32 v[100:101], v[100:101], v[44:45] op_sel_hi:[1,0]
    v_pk_mul_f32 v[102:103], v[102:103], v[44:45] op_sel_hi:[1,0]
    v_pk_mul_f32 v[104:105], v[104:105], v[44:45] op_sel_hi:[1,0]
    v_pk_mul_f32 v[106:107], v[106:107], v[44:45] op_sel_hi:[1,0]
    v_pk_mul_f32 v[108:109], v[108:109], v[44:45] op_sel_hi:[1,0]
    v_pk_mul_f32 v[110:111], v[110:111], v[44:45] op_sel_hi:[1,0]
    v_cvt_pk_bf16_f32 v116, v100, v101
    v_cvt_pk_bf16_f32 v117, v102, v103
    v_cvt_pk_bf16_f32 v118, v104, v105
    v_cvt_pk_bf16_f32 v119, v106, v107
    v_cvt_pk_bf16_f32 v120, v108, v109
    v_cvt_pk_bf16_f32 v121, v110, v111
    v_cndmask_b32 v146, v146, v120, s[48:49]
    v_cndmask_b32 v147, v147, v121, s[48:49]
    s_cmp_lg_u32 s50, 0
    s_cbranch_scc1 L_wt_57
    buffer_store_dwordx4 v[116:119], v12, s[4:7], s85 offen offset:2048
    buffer_store_dwordx2 v[146:147], v13, s[4:7], s86 offen
L_bk_58:
    s_waitcnt vmcnt(2)
    v_cmp_gt_u32 vcc, 5, v47
    s_nop 0
    s_cbranch_vccz L_ck_59ed
L_ck_59:
    s_mov_b32 s45, 200000
L_ck_59_b:
    buffer_load_dword v47, v48, s[4:7], 0 offen sc1
    s_sub_u32 s45, s45, 1
    s_cbranch_scc1 L_ck_59_c
    s_waitcnt vmcnt(0)
    v_cmp_gt_u32 vcc, 5, v47
    s_nop 0
    s_cbranch_vccnz L_ck_59_b
L_ck_59_c:
    s_waitcnt vmcnt(0)
    s_branch L_ck_59ed
L_ck_59ed:
    s_add_u32 s42, s20, 0
    buffer_load_dwordx4 a[224:227], v1, s[4:7], s42 offen offset:0 sc1
    buffer_load_dwordx4 a[228:231], v1, s[4:7], s42 offen offset:1024 sc1
    s_add_u32 s42, s21, 0
    buffer_load_dwordx4 a[232:235], v1, s[4:7], s42 offen offset:0 sc1
    buffer_load_dwordx4 a[236:239], v1, s[4:7], s42 offen offset:1024 sc1
    s_add_u32 s42, s22, 0
    buffer_load_dwordx4 a[240:243], v1, s[4:7], s42 offen offset:0 sc1
    buffer_load_dwordx4 a[244:247], v1, s[4:7], s42 offen offset:1024 sc1
    v_mov_b32 v50, 6
    s_waitcnt vmcnt(6)
    s_mov_b64 exec, 1
    s_cmp_lg_u32 s50, 0
    s_cbranch_scc1 L_wt_60
    buffer_store_dword v50, v0, s[4:7], s101 offen offset:0
L_bk_61:
    s_mov_b64 exec, -1
L_p3_1:
    s_waitcnt vmcnt(6)
    v_mfma_f32_16x16x32_bf16 v[52:55], v[156:159], a[224:227], 0
    v_and_b32 v26, 15, v0
    v_lshrrev_b32 v27, 5, v0
    v_mfma_f32_16x16x32_bf16 v[56:59], v[160:163], a[224:227], 0
    s_barrier
    v_mov_b32 v5, s63
    v_mfma_f32_16x16x32_bf16 v[60:63], v[164:167], a[224:227], 0
    v_lshl_add_u32 v6, v5, 1, v27
    v_lshlrev_b32 v6, 8, v6
    v_mfma_f32_16x16x32_bf16 v[64:67], v[168:171], a[224:227], 0
    v_mul_u32_u24 v5, 6144, v5
    v_add_u32 v5, v5, v1
    v_mfma_f32_16x16x32_bf16 v[68:71], v[172:175], a[224:227], 0
    v_lshl_add_u32 v6, v26, 4, v6
    v_lshlrev_b32 v7, 2, v27
    s_waitcnt vmcnt(5)
    v_mfma_f32_16x16x32_bf16 v[52:55], v[176:179], a[228:231], v[52:55]
    v_lshl_add_u32 v7, v26, 3, v7
    v_bfe_u32 v27, v0, 4, 1
    v_mfma_f32_16x16x32_bf16 v[56:59], v[180:183], a[228:231], v[56:59]
    v_lshl_add_u32 v6, v27, 3, v6
    v_add_u32 v6, 0x1000, v6
    v_mfma_f32_16x16x32_bf16 v[60:63], v[184:187], a[228:231], v[60:63]
    v_mov_b32 v9, s3
    v_mul_u32_u24 v9, 15360, v9
    v_mfma_f32_16x16x32_bf16 v[64:67], v[188:191], a[228:231], v[64:67]
    v_add_u32 v9, 102400, v9
    v_add_u32 v9, v9, v1
    v_mfma_f32_16x16x32_bf16 v[68:71], v[192:195], a[228:231], v[68:71]
    v_lshlrev_b32 v26, 16, v16
    v_and_b32 v27, 0xffff0000, v16
    s_waitcnt vmcnt(4)
    v_mfma_f32_16x16x32_bf16 v[72:75], v[156:159], a[232:235], 0
    v_lshlrev_b32 v28, 16, v17
    v_and_b32 v29, 0xffff0000, v17
    v_mfma_f32_16x16x32_bf16 v[76:79], v[160:163], a[232:235], 0
    v_lshlrev_b32 v30, 16, v18
    v_and_b32 v31, 0xffff0000, v18
    v_mfma_f32_16x16x32_bf16 v[80:83], v[164:167], a[232:235], 0
    v_lshlrev_b32 v32, 16, v19
    v_and_b32 v33, 0xffff0000, v19
    v_mfma_f32_16x16x32_bf16 v[84:87], v[168:171], a[232:235], 0
    v_lshlrev_b32 v34, 16, v20
    v_and_b32 v35, 0xffff0000, v20
    v_mfma_f32_16x16x32_bf16 v[88:91], v[172:175], a[232:235], 0
    v_lshlrev_b32 v36, 16, v21
    v_and_b32 v37, 0xffff0000, v21
    s_waitcnt vmcnt(3)
    v_mfma_f32_16x16x32_bf16 v[72:75], v[176:179], a[236:239], v[72:75]
    v_lshlrev_b32 v38, 16, v22
    v_and_b32 v39, 0xffff0000, v22
    v_mfma_f32_16x16x32_bf16 v[76:79], v[180:183], a[236:239], v[76:79]
    v_lshlrev_b32 v40, 16, v23
    v_and_b32 v41, 0xffff0000, v23
    v_mfma_f32_16x16x32_bf16 v[80:83], v[184:187], a[236:239], v[80:83]
    v_lshlrev_b32 v42, 16, v24
    v_and_b32 v43, 0xffff0000, v24
    v_mfma_f32_16x16x32_bf16 v[84:87], v[188:191], a[236:239], v[84:87]
    buffer_load_dword v47, v48, s[4:7], 0 offen sc1
    v_mfma_f32_16x16x32_bf16 v[88:91], v[192:195], a[236:239], v[88:91]
    v_lshlrev_b32 v44, 16, v25
    v_and_b32 v45, 0xffff0000, v25
    s_waitcnt vmcnt(3)
    v_mfma_f32_16x16x32_bf16 v[92:95], v[156:159], a[240:243], 0
    v_mfma_f32_16x16x32_bf16 v[96:99], v[160:163], a[240:243], 0
    v_mfma_f32_16x16x32_bf16 v[100:103], v[164:167], a[240:243], 0
    v_mfma_f32_16x16x32_bf16 v[104:107], v[168:171], a[240:243], 0
    v_mfma_f32_16x16x32_bf16 v[108:111], v[172:175], a[240:243], 0
    s_waitcnt vmcnt(2)
    v_mfma_f32_16x16x32_bf16 v[92:95], v[176:179], a[244:247], v[92:95]
    s_waitcnt vmcnt(0)
    v_cmp_gt_u32 vcc, 6, v47
    s_nop 0
    s_cbranch_vccz L_ck_62ed
L_ck_62:
    s_mov_b32 s45, 200000
L_ck_62_b:
    buffer_load_dword v47, v48, s[4:7], 0 offen sc1
    s_sub_u32 s45, s45, 1
    s_cbranch_scc1 L_ck_62_c
    s_waitcnt vmcnt(0)
    v_cmp_gt_u32 vcc, 6, v47
    s_nop 0
    s_cbranch_vccnz L_ck_62_b
L_ck_62_c:
    s_waitcnt vmcnt(0)
    s_branch L_ck_62ed
L_ck_62ed:
    s_add_u32 s42, s20, 0
    buffer_load_dwordx4 a[204:207], v1, s[4:7], s42 offen offset:2048 sc1
    buffer_load_dwordx4 a[208:211], v1, s[4:7], s42 offen offset:3072 sc1
    s_add_u32 s42, s20, 4096
    buffer_load_dwordx4 a[212:215], v1, s[4:7], s42 offen offset:0 sc1
    s_add_u32 s42, s21, 0
    buffer_load_dwordx4 a[216:219], v1, s[4:7], s42 offen offset:2048 sc1
    buffer_load_dwordx4 a[220:223], v1, s[4:7], s42 offen offset:3072 sc1
    s_add_u32 s42, s21, 4096
    buffer_load_dwordx4 v[116:119], v1, s[4:7], s42 offen offset:0 sc1
    s_add_u32 s42, s22, 0
    buffer_load_dwordx4 v[120:123], v1, s[4:7], s42 offen offset:2048 sc1
    buffer_load_dwordx4 v[124:127], v1, s[4:7], s42 offen offset:3072 sc1
    v_mfma_f32_16x16x32_bf16 v[96:99], v[180:183], a[244:247], v[96:99]
    v_mfma_f32_16x16x32_bf16 v[100:103], v[184:187], a[244:247], v[100:103]
    s_add_u32 s42, s22, 4096
    buffer_load_dwordx4 v[128:131], v1, s[4:7], s42 offen offset:0 sc1
    v_mfma_f32_16x16x32_bf16 v[104:107], v[188:191], a[244:247], v[104:107]
    v_mfma_f32_16x16x32_bf16 v[108:111], v[192:195], a[244:247], v[108:111]
    s_waitcnt vmcnt(8)
    v_mfma_f32_16x16x32_bf16 v[52:55], v[196:199], a[204:207], v[52:55]
    v_mfma_f32_16x16x32_bf16 v[56:59], v[200:203], a[204:207], v[56:59]
    s_add_u32 s42, s23, 0
    buffer_load_dwordx4 v[132:135], v1, s[4:7], s42 offen offset:0 sc1
    v_mfma_f32_16x16x32_bf16 v[60:63], v[204:207], a[204:207], v[60:63]
    v_mfma_f32_16x16x32_bf16 v[64:67], v[208:211], a[204:207], v[64:67]
    v_mfma_f32_16x16x32_bf16 v[68:71], v[212:215], a[204:207], v[68:71]
    s_waitcnt vmcnt(8)
    v_mfma_f32_16x16x32_bf16 v[52:55], v[216:219], a[208:211], v[52:55]
    v_mfma_f32_16x16x32_bf16 v[56:59], v[220:223], a[208:211], v[56:59]
    buffer_load_dwordx4 v[136:139], v1, s[4:7], s42 offen offset:1024 sc1
    v_mfma_f32_16x16x32_bf16 v[60:63], v[224:227], a[208:211], v[60:63]
    v_mfma_f32_16x16x32_bf16 v[64:67], v[228:231], a[208:211], v[64:67]
    v_mfma_f32_16x16x32_bf16 v[68:71], v[232:235], a[208:211], v[68:71]
    s_waitcnt vmcnt(8)
    v_mfma_f32_16x16x32_bf16 v[52:55], v[236:239], a[212:215], v[52:55]
    buffer_load_dwordx4 v[140:143], v1, s[4:7], s42 offen offset:2048 sc1
    v_mfma_f32_16x16x32_bf16 v[56:59], v[240:243], a[212:215], v[56:59]
    s_add_u32 m0, s74, 32768
    s_add_u32 s44, s52, 32768
    buffer_load_dwordx4 v1, s[4:7], s44 offen offset:0 sc1 lds
    v_mfma_f32_16x16x32_bf16 v[60:63], v[244:247], a[212:215], v[60:63]
    buffer_load_dwordx4 v[144:147], v1, s[4:7], s42 offen offset:3072 sc1
    v_mfma_f32_16x16x32_bf16 v[64:67], v[248:251], a[212:215], v[64:67]
    v_mfma_f32_16x16x32_bf16 v[68:71], v[252:255], a[212:215], v[68:71]
    s_add_u32 s42, s23, 4096
    buffer_load_dwordx4 v[148:151], v1, s[4:7], s42 offen offset:0 sc1
    s_waitcnt vmcnt(11)
    v_mfma_f32_16x16x32_bf16 v[72:75], v[196:199], a[216:219], v[72:75]
    buffer_load_dwordx4 v1, s[4:7], s44 offen offset:1024 sc1 lds
    s_mul_i32 s41, s16, 15360
    s_add_u32 s41, s41, 102400
    s_waitcnt vmcnt(11)
    v_mfma_f32_16x16x32_bf16 v[72:75], v[216:219], a[220:223], v[72:75]
    v_add_u32 v8, s41, v1
    s_waitcnt vmcnt(10)
    v_mfma_f32_16x16x32_bf16 v[72:75], v[236:239], v[116:119], v[72:75]
    ds_write_b128 v8, v[52:55] offset:0
    v_mfma_f32_16x16x32_bf16 v[76:79], v[200:203], a[216:219], v[76:79]
    buffer_load_dwordx4 v1, s[4:7], s44 offen offset:2048 sc1 lds
    v_mfma_f32_16x16x32_bf16 v[76:79], v[220:223], a[220:223], v[76:79]
    v_mfma_f32_16x16x32_bf16 v[76:79], v[240:243], v[116:119], v[76:79]
    ds_write_b128 v8, v[56:59] offset:1024
    v_mfma_f32_16x16x32_bf16 v[80:83], v[204:207], a[216:219], v[80:83]
    v_mfma_f32_16x16x32_bf16 v[80:83], v[224:227], a[220:223], v[80:83]
    buffer_load_dwordx4 v1, s[4:7], s44 offen offset:3072 sc1 lds
    v_mfma_f32_16x16x32_bf16 v[80:83], v[244:247], v[116:119], v[80:83]
    ds_write_b128 v8, v[60:63] offset:2048
    v_mfma_f32_16x16x32_bf16 v[84:87], v[208:211], a[216:219], v[84:87]
    v_mfma_f32_16x16x32_bf16 v[84:87], v[228:231], a[220:223], v[84:87]
    v_mfma_f32_16x16x32_bf16 v[84:87], v[248:251], v[116:119], v[84:87]
    s_add_u32 m0, s74, 49152
    s_add_u32 s44, s52, 49152
    buffer_load_dwordx4 v1, s[4:7], s44 offen offset:0 sc1 lds
    ds_write_b128 v8, v[64:67] offset:3072
    v_mfma_f32_16x16x32_bf16 v[88:91], v[212:215], a[216:219], v[88:91]
    v_mfma_f32_16x16x32_bf16 v[88:91], v[232:235], a[220:223], v[88:91]
    v_mfma_f32_16x16x32_bf16 v[88:91], v[252:255], v[116:119], v[88:91]
    ds_write_b128 v8, v[68:71] offset:4096
    s_waitcnt vmcnt(12)
    v_mfma_f32_16x16x32_bf16 v[92:95], v[196:199], v[120:123], v[92:95]
    buffer_load_dwordx4 v1, s[4:7], s44 offen offset:1024 sc1 lds
    s_mul_i32 s41, s17, 15360
    s_add_u32 s41, s41, 107520
    s_waitcnt vmcnt(12)
    v_mfma_f32_16x16x32_bf16 v[92:95], v[216:219], v[124:127], v[92:95]
    v_add_u32 v8, s41, v1
    s_waitcnt vmcnt(11)
    v_mfma_f32_16x16x32_bf16 v[92:95], v[236:239], v[128:131], v[92:95]
    ds_write_b128 v8, v[72:75] offset:0
    v_mfma_f32_16x16x32_bf16 v[96:99], v[200:203], v[120:123], v[96:99]
    v_mfma_f32_16x16x32_bf16 v[96:99], v[220:223], v[124:127], v[96:99]
    buffer_load_dwordx4 v1, s[4:7], s44 offen offset:2048 sc1 lds
    v_mfma_f32_16x16x32_bf16 v[96:99], v[240:243], v[128:131], v[96:99]
    ds_write_b128 v8, v[76:79] offset:1024
    v_mfma_f32_16x16x32_bf16 v[100:103], v[204:207], v[120:123], v[100:103]
    v_mfma_f32_16x16x32_bf16 v[100:103], v[224:227], v[124:127], v[100:103]
    v_mfma_f32_16x16x32_bf16 v[100:103], v[244:247], v[128:131], v[100:103]
    buffer_load_dwordx4 v1, s[4:7], s44 offen offset:3072 sc1 lds
    ds_write_b128 v8, v[80:83] offset:2048
    v_mfma_f32_16x16x32_bf16 v[104:107], v[208:211], v[120:123], v[104:107]
    v_mfma_f32_16x16x32_bf16 v[104:107], v[228:231], v[124:127], v[104:107]
    v_mfma_f32_16x16x32_bf16 v[104:107], v[248:251], v[128:131], v[104:107]
    ds_write_b128 v8, v[84:87] offset:3072
    v_mfma_f32_16x16x32_bf16 v[108:111], v[212:215], v[120:123], v[108:111]
    s_add_u32 m0, s74, 65536
    s_add_u32 s44, s52, 65536
    buffer_load_dwordx4 v1, s[4:7], s44 offen offset:0 sc1 lds
    v_mfma_f32_16x16x32_bf16 v[108:111], v[232:235], v[124:127], v[108:111]
    v_mfma_f32_16x16x32_bf16 v[108:111], v[252:255], v[128:131], v[108:111]
    ds_write_b128 v8, v[88:91] offset:4096
    s_waitcnt vmcnt(13)
    v_mfma_f32_16x16x32_bf16 v[26:29], v[156:159], v[132:135], v[26:29]
    s_mul_i32 s41, s18, 15360
    s_add_u32 s41, s41, 112640
    s_waitcnt vmcnt(12)
    v_mfma_f32_16x16x32_bf16 v[26:29], v[176:179], v[136:139], v[26:29]
    buffer_load_dwordx4 v1, s[4:7], s44 offen offset:1024 sc1 lds
    v_add_u32 v8, s41, v1
    s_waitcnt vmcnt(12)
    v_mfma_f32_16x16x32_bf16 v[26:29], v[196:199], v[140:143], v[26:29]
    ds_write_b128 v8, v[92:95] offset:0
    s_waitcnt vmcnt(10)
    v_mfma_f32_16x16x32_bf16 v[26:29], v[216:219], v[144:147], v[26:29]
    s_waitcnt lgkmcnt(1)
    s_barrier
    ds_read_b128 v[52:55], v9 offset:0
    s_waitcnt vmcnt(9)
    v_mfma_f32_16x16x32_bf16 v[26:29], v[236:239], v[148:151], v[26:29]
    ds_read_b128 v[56:59], v9 offset:1024
    v_mfma_f32_16x16x32_bf16 v[30:33], v[160:163], v[132:135], v[30:33]
    buffer_load_dwordx4 v1, s[4:7], s44 offen offset:2048 sc1 lds
    ds_write_b128 v8, v[96:99] offset:1024
    v_mfma_f32_16x16x32_bf16 v[30:33], v[180:183], v[136:139], v[30:33]
    ds_read_b128 v[60:63], v9 offset:2048
    v_mfma_f32_16x16x32_bf16 v[30:33], v[200:203], v[140:143], v[30:33]
    ds_read_b128 v[64:67], v9 offset:3072
    v_mfma_f32_16x16x32_bf16 v[30:33], v[220:223], v[144:147], v[30:33]
    ds_write_b128 v8, v[100:103] offset:2048
    v_mfma_f32_16x16x32_bf16 v[30:33], v[240:243], v[148:151], v[30:33]
    buffer_load_dwordx4 v1, s[4:7], s44 offen offset:3072 sc1 lds
    v_mfma_f32_16x16x32_bf16 v[34:37], v[164:167], v[132:135], v[34:37]
    ds_read_b128 v[68:71], v9 offset:4096
    v_mfma_f32_16x16x32_bf16 v[34:37], v[184:187], v[136:139], v[34:37]
    ds_write_b128 v8, v[104:107] offset:3072
    v_mfma_f32_16x16x32_bf16 v[34:37], v[204:207], v[140:143], v[34:37]
    ds_read_b128 v[72:75], v9 offset:5120
    v_mfma_f32_16x16x32_bf16 v[34:37], v[224:227], v[144:147], v[34:37]
    s_add_u32 m0, s74, 81920
    s_add_u32 s44, s52, 81920
    buffer_load_dwordx4 v1, s[4:7], s44 offen offset:0 sc1 lds
    v_mfma_f32_16x16x32_bf16 v[34:37], v[244:247], v[148:151], v[34:37]
    ds_write_b128 v8, v[108:111] offset:4096
    v_mfma_f32_16x16x32_bf16 v[38:41], v[168:171], v[132:135], v[38:41]
    ds_read_b128 v[76:79], v9 offset:6144
    v_mfma_f32_16x16x32_bf16 v[38:41], v[188:191], v[136:139], v[38:41]
    ds_read_b128 v[80:83], v9 offset:7168
    v_mfma_f32_16x16x32_bf16 v[38:41], v[208:211], v[140:143], v[38:41]
    s_waitcnt lgkmcnt(2)
    s_barrier
    buffer_load_dwordx4 v1, s[4:7], s44 offen offset:1024 sc1 lds
    v_mfma_f32_16x16x32_bf16 v[38:41], v[228:231], v[144:147], v[38:41]
    ds_read_b128 v[92:95], v9 offset:10240
    ds_read_b128 v[84:87], v9 offset:8192
    v_mfma_f32_16x16x32_bf16 v[38:41], v[248:251], v[148:151], v[38:41]
    ds_read_b128 v[96:99], v9 offset:11264
    ds_read_b128 v[88:91], v9 offset:9216
    v_mfma_f32_16x16x32_bf16 v[42:45], v[172:175], v[132:135], v[42:45]
    ds_read_b128 v[100:103], v9 offset:12288
    v_mfma_f32_16x16x32_bf16 v[42:45], v[192:195], v[136:139], v[42:45]
    buffer_load_dwordx4 v1, s[4:7], s44 offen offset:2048 sc1 lds
    v_mfma_f32_16x16x32_bf16 v[42:45], v[212:215], v[140:143], v[42:45]
    ds_read_b128 v[104:107], v9 offset:13312
    v_add_f32 v52, v52, v72
    v_mfma_f32_16x16x32_bf16 v[42:45], v[232:235], v[144:147], v[42:45]
    ds_read_b128 v[108:111], v9 offset:14336
    v_add_f32 v53, v53, v73
    v_mfma_f32_16x16x32_bf16 v[42:45], v[252:255], v[148:151], v[42:45]
    buffer_load_dwordx4 v1, s[4:7], s44 offen offset:3072 sc1 lds
    v_add_f32 v54, v54, v74
    v_add_f32 v55, v55, v75
    s_waitcnt lgkmcnt(8)
    v_add_f32 v56, v56, v76
    v_add_f32 v57, v57, v77
    v_add_f32 v58, v58, v78
    v_add_f32 v59, v59, v79
    s_waitcnt lgkmcnt(7)
    v_add_f32 v60, v60, v80
    v_add_f32 v61, v61, v81
    v_add_f32 v62, v62, v82
    v_add_f32 v63, v63, v83
    s_waitcnt lgkmcnt(5)
    v_add_f32 v64, v64, v84
    v_add_f32 v65, v65, v85
    v_add_f32 v66, v66, v86
    v_add_f32 v67, v67, v87
    s_waitcnt lgkmcnt(3)
    v_add_f32 v68, v68, v88
    v_add_f32 v69, v69, v89
    v_add_f32 v70, v70, v90
    v_add_f32 v71, v71, v91
    v_pk_add_f32 v[52:53], v[52:53], v[92:93]
    v_pk_add_f32 v[54:55], v[54:55], v[94:95]
    v_pk_add_f32 v[56:57], v[56:57], v[96:97]
    v_pk_add_f32 v[58:59], v[58:59], v[98:99]
    s_waitcnt lgkmcnt(2)
    v_pk_add_f32 v[60:61], v[60:61], v[100:101]
    v_pk_add_f32 v[62:63], v[62:63], v[102:103]
    s_waitcnt lgkmcnt(1)
    v_pk_add_f32 v[64:65], v[64:65], v[104:105]
    v_pk_add_f32 v[66:67], v[66:67], v[106:107]
    s_waitcnt lgkmcnt(0)
    v_pk_add_f32 v[68:69], v[68:69], v[108:109]
    v_pk_add_f32 v[70:71], v[70:71], v[110:111]
    v_pk_add_f32 v[26:27], v[26:27], v[52:53]
    v_pk_add_f32 v[28:29], v[28:29], v[54:55]
    v_pk_add_f32 v[30:31], v[30:31], v[56:57]
    v_pk_add_f32 v[32:33], v[32:33], v[58:59]
    v_pk_add_f32 v[34:35], v[34:35], v[60:61]
    v_pk_add_f32 v[36:37], v[36:37], v[62:63]
    v_pk_add_f32 v[38:39], v[38:39], v[64:65]
    v_pk_add_f32 v[40:41], v[40:41], v[66:67]
    v_pk_add_f32 v[42:43], v[42:43], v[68:69]
    v_pk_add_f32 v[44:45], v[44:45], v[70:71]
    v_cvt_pk_bf16_f32 v16, v26, v27
    v_cvt_pk_bf16_f32 v17, v28, v29
    v_cvt_pk_bf16_f32 v18, v30, v31
    v_cvt_pk_bf16_f32 v19, v32, v33
    v_cvt_pk_bf16_f32 v20, v34, v35
    v_cvt_pk_bf16_f32 v21, v36, v37
    v_cvt_pk_bf16_f32 v22, v38, v39
    v_cvt_pk_bf16_f32 v23, v40, v41
    v_cvt_pk_bf16_f32 v24, v42, v43
    v_cvt_pk_bf16_f32 v25, v44, v45
    s_cmp_lg_u32 s50, 0
    s_cbranch_scc1 L_wt_63
    buffer_store_dwordx4 v[16:19], v5, s[4:7], s82 offen
    buffer_store_dwordx4 v[20:23], v5, s[4:7], s82 offen offset:2048
    buffer_store_dwordx2 v[24:25], v6, s[4:7], s82 offen
L_bk_64:
    v_dot2_f32_bf16 v26, v16, s70, 0
    v_dot2_f32_bf16 v27, v16, v16, 0
    v_dot2_f32_bf16 v26, v17, s70, v26
    v_dot2_f32_bf16 v27, v17, v17, v27
    v_dot2_f32_bf16 v26, v18, s70, v26
    v_dot2_f32_bf16 v27, v18, v18, v27
    v_dot2_f32_bf16 v26, v19, s70, v26
    v_dot2_f32_bf16 v27, v19, v19, v27
    v_dot2_f32_bf16 v26, v20, s70, v26
    v_dot2_f32_bf16 v27, v20, v20, v27
    v_dot2_f32_bf16 v26, v21, s70, v26
    v_dot2_f32_bf16 v27, v21, v21, v27
    v_dot2_f32_bf16 v26, v22, s70, v26
    v_dot2_f32_bf16 v27, v22, v22, v27
    v_dot2_f32_bf16 v26, v23, s70, v26
    v_dot2_f32_bf16 v27, v23, v23, v27
    v_dot2_f32_bf16 v26, v24, s70, v26
    v_dot2_f32_bf16 v27, v24, v24, v27
    v_dot2_f32_bf16 v26, v25, s70, v26
    v_dot2_f32_bf16 v27, v25, v25, v27
    s_nop 2
    v_permlane32_swap_b32 v26, v27
    v_add_f32 v26, v26, v27
    v_mov_b32 v27, v26
    s_nop 1
    v_permlane16_swap_b32 v26, v27
    v_add_f32 v26, v26, v27
    s_cmp_lg_u32 s50, 0
    s_cbranch_scc1 L_wt_65
    buffer_store_dword v26, v7, s[4:7], s84 offen
L_bk_66:
    v_mov_b32 v50, 5
    s_waitcnt vmcnt(1)
    s_mov_b64 exec, 1
    s_cmp_lg_u32 s50, 0
    s_cbranch_scc1 L_wt_67
    buffer_store_dword v50, v0, s[4:7], s98 offen offset:0
L_bk_68:
    s_mov_b64 exec, -1
L_p4_1:
    s_mov_b32 s59, L_code_end-16384-L_pc
    s_load_dword s65, s[0:1], s59
    s_add_u32 s59, s59, 64
    s_load_dword s65, s[0:1], s59
    v_lshlrev_b32 v34, 2, v0
    v_and_b32 v34, 63, v34
    s_waitcnt vmcnt(1)
    v_mov_b32 v50, 6
    s_mov_b64 exec, 1
    s_cmp_lg_u32 s50, 0
    s_cbranch_scc1 L_wt_69
    buffer_store_dword v50, v0, s[4:7], s98 offen offset:0
L_bk_70:
    s_mov_b64 exec, -1
    v_and_b32 v26, 31, v0
    v_lshrrev_b32 v15, 5, v0
    v_lshlrev_b32 v15, 11, v15
    v_lshl_add_u32 v15, v26, 3, v15
    v_and_b32 v46, 31, v0
    v_lshrrev_b32 v47, 5, v0
    v_lshrrev_b32 v5, 4, v46
    v_mul_u32_u24 v5, 57344, v5
    v_and_b32 v46, 15, v46
    v_lshl_add_u32 v48, v47, 4, v46
    v_lshl_add_u32 v5, v48, 4, v5
    v_add_u32 v6, 57344, v1
    v_add_u32 v48, 4, v46
    v_and_b32 v48, 16, v48
    v_lshl_add_u32 v10, v48, 14, v1
    v_lshrrev_b32 v48, 4, v0
    v_lshlrev_b32 v48, 6, v48
    v_sub_u32 v10, v10, v48
    v_add_u32 v10, 83968, v10
    v_lshlrev_b32 v48, 2, v0
    v_and_b32 v48, 31, v48
    v_add_u32 v48, s100, v48
    s_add_u32 s41, s3, 1
    s_and_b32 s41, s41, 3
    s_mov_b32 s16, s41
    s_mul_i32 s20, s41, 57344
    s_add_u32 s20, s20, s90
    s_add_u32 s20, s20, 29573120
    s_add_u32 s41, s3, 2
    s_and_b32 s41, s41, 3
    s_mov_b32 s17, s41
    s_mul_i32 s21, s41, 57344
    s_add_u32 s21, s21, s90
    s_add_u32 s21, s21, 29573120
    s_add_u32 s41, s3, 3
    s_and_b32 s41, s41, 3
    s_mov_b32 s18, s41
    s_mul_i32 s22, s41, 57344
    s_add_u32 s22, s22, s90
    s_add_u32 s22, s22, 29573120
    s_mul_i32 s23, s3, 57344
    s_add_u32 s23, s23, s90
    s_add_u32 s23, s23, 29573120
    s_barrier
    ds_read_b128 a[224:227], v1 offset:0
    ds_read_b128 a[228:231], v1 offset:1024
    ds_read_b128 a[232:235], v1 offset:2048
    ds_read_b128 a[236:239], v1 offset:3072
    ds_read_b128 a[240:243], v1 offset:4096
    ds_read_b128 a[244:247], v1 offset:5120
    s_mov_b32 s45, 200000
L_poll_71:
    buffer_load_dword v35, v34, s[4:7], s99 offen sc1
    s_sub_u32 s45, s45, 1
    s_cbranch_scc1 L_got_72
    s_waitcnt vmcnt(0)
    v_cmp_gt_u32 vcc, 5, v35
    s_nop 0
    s_cbranch_vccnz L_poll_71
L_got_72:
    s_waitcnt vmcnt(0)
    s_add_u32 s42, s80, 0
    buffer_load_dwordx4 a[204:207], v1, s[4:7], s42 offen offset:0 sc1
    buffer_load_dwordx4 a[208:211], v1, s[4:7], s42 offen offset:1024 sc1
    buffer_load_dwordx4 a[212:215], v1, s[4:7], s42 offen offset:2048 sc1
    buffer_load_dwordx4 a[216:219], v1, s[4:7], s42 offen offset:3072 sc1
    s_add_u32 s42, s80, 4096
    buffer_load_dwordx4 a[220:223], v1, s[4:7], s42 offen offset:0 sc1
    buffer_load_dwordx4 v[116:119], v1, s[4:7], s42 offen offset:1024 sc1
    buffer_load_dwordx4 v[120:123], v1, s[4:7], s42 offen offset:2048 sc1
    buffer_load_dwordx4 v[124:127], v1, s[4:7], s42 offen offset:3072 sc1
    s_waitcnt vmcnt(7) lgkmcnt(0)
    v_mfma_f32_16x16x32_bf16 v[52:55], a[224:227], a[204:207], 0
    buffer_load_dword v37, v34, s[4:7], s99 offen sc1
    s_add_u32 s42, s80, 8192
    buffer_load_dwordx4 v[128:131], v1, s[4:7], s42 offen offset:0 sc1
    s_waitcnt vmcnt(8)
    v_mfma_f32_16x16x32_bf16 v[56:59], a[224:227], a[208:211], 0
    ds_read_b128 a[224:227], v1 offset:6144
    v_mfma_f32_16x16x32_bf16 v[60:63], a[228:231], a[204:207], 0
    v_mfma_f32_16x16x32_bf16 v[64:67], a[228:231], a[208:211], 0
    ds_read_b128 a[228:231], v1 offset:7168
    v_mfma_f32_16x16x32_bf16 v[68:71], a[232:235], a[204:207], 0
    buffer_load_dwordx4 v[132:135], v1, s[4:7], s42 offen offset:1024 sc1
    v_mfma_f32_16x16x32_bf16 v[72:75], a[232:235], a[208:211], 0
    ds_read_b128 a[232:235], v1 offset:8192
    v_mfma_f32_16x16x32_bf16 v[76:79], a[236:239], a[204:207], 0
    v_mfma_f32_16x16x32_bf16 v[80:83], a[236:239], a[208:211], 0
    s_waitcnt vmcnt(7)
    ds_read_b128 a[236:239], v1 offset:9216
    v_mfma_f32_16x16x32_bf16 v[52:55], a[240:243], a[212:215], v[52:55]
    buffer_load_dwordx4 v[136:139], v1, s[4:7], s42 offen offset:2048 sc1
    v_mfma_f32_16x16x32_bf16 v[56:59], a[240:243], a[216:219], v[56:59]
    s_waitcnt lgkmcnt(3)
    ds_read_b128 a[240:243], v1 offset:10240
    v_mfma_f32_16x16x32_bf16 v[60:63], a[244:247], a[212:215], v[60:63]
    buffer_load_dwordx4 v[140:143], v1, s[4:7], s42 offen offset:3072 sc1
    v_mfma_f32_16x16x32_bf16 v[64:67], a[244:247], a[216:219], v[64:67]
    ds_read_b128 a[244:247], v1 offset:11264
    v_mfma_f32_16x16x32_bf16 v[68:71], a[224:227], a[212:215], v[68:71]
    v_mfma_f32_16x16x32_bf16 v[72:75], a[224:227], a[216:219], v[72:75]
    s_waitcnt lgkmcnt(3)
    ds_read_b128 a[224:227], v2 offset:16384
    v_mfma_f32_16x16x32_bf16 v[76:79], a[228:231], a[212:215], v[76:79]
    s_add_u32 s42, s80, 12288
    buffer_load_dwordx4 v[144:147], v1, s[4:7], s42 offen offset:0 sc1
    v_mfma_f32_16x16x32_bf16 v[80:83], a[228:231], a[216:219], v[80:83]
    s_waitcnt vmcnt(8)
    ds_read_b128 a[228:231], v1 offset:12288
    v_mfma_f32_16x16x32_bf16 v[52:55], a[232:235], a[220:223], v[52:55]
    v_mfma_f32_16x16x32_bf16 v[56:59], a[232:235], v[116:119], v[56:59]
    s_waitcnt lgkmcnt(3)
    ds_read_b128 a[232:235], v1 offset:13312
    v_mfma_f32_16x16x32_bf16 v[60:63], a[236:239], a[220:223], v[60:63]
    buffer_load_dwordx4 v[148:151], v1, s[4:7], s42 offen offset:1024 sc1
    v_mfma_f32_16x16x32_bf16 v[64:67], a[236:239], v[116:119], v[64:67]
    ds_read_b128 a[236:239], v1 offset:14336
    v_mfma_f32_16x16x32_bf16 v[68:71], a[240:243], a[220:223], v[68:71]
    v_mfma_f32_16x16x32_bf16 v[72:75], a[240:243], v[116:119], v[72:75]
    s_waitcnt lgkmcnt(3)
    ds_read_b128 a[240:243], v1 offset:15360
    v_mfma_f32_16x16x32_bf16 v[76:79], a[244:247], a[220:223], v[76:79]
    buffer_load_dwordx4 v[152:155], v1, s[4:7], s42 offen offset:2048 sc1
    v_mfma_f32_16x16x32_bf16 v[80:83], a[244:247], v[116:119], v[80:83]
    ds_read_b128 a[244:247], v1 offset:16384
    v_mfma_f32_16x16x32_bf16 v[84:87], a[224:227], a[204:207], 0
    v_mfma_f32_16x16x32_bf16 v[88:91], a[224:227], a[208:211], 0
    s_waitcnt vmcnt(8) lgkmcnt(3)
    ds_read_b128 a[224:227], v1 offset:17408
    v_mfma_f32_16x16x32_bf16 v[52:55], a[228:231], v[120:123], v[52:55]
    buffer_load_dwordx4 v[156:159], v1, s[4:7], s42 offen offset:3072 sc1
    v_mfma_f32_16x16x32_bf16 v[56:59], a[228:231], v[124:127], v[56:59]
    ds_read_b128 a[228:231], v1 offset:18432
    v_mfma_f32_16x16x32_bf16 v[60:63], a[232:235], v[120:123], v[60:63]
    s_waitcnt vmcnt(8)
    v_cmp_gt_u32 vcc, 6, v37
    s_nop 0
    s_cbranch_vccnz L_sx_73
L_sx_73ed:
    buffer_load_dwordx2 v[26:27], v15, s[4:7], s81 offen offset:0 sc1
    v_mfma_f32_16x16x32_bf16 v[64:67], a[232:235], v[124:127], v[64:67]
    s_waitcnt lgkmcnt(3)
    ds_read_b128 a[232:235], v1 offset:19456
    v_mfma_f32_16x16x32_bf16 v[68:71], a[236:239], v[120:123], v[68:71]
    v_mfma_f32_16x16x32_bf16 v[72:75], a[236:239], v[124:127], v[72:75]
    ds_read_b128 a[236:239], v2 offset:17408
    v_mfma_f32_16x16x32_bf16 v[76:79], a[240:243], v[120:123], v[76:79]
    buffer_load_dwordx2 v[28:29], v15, s[4:7], s81 offen offset:512 sc1
    v_mfma_f32_16x16x32_bf16 v[80:83], a[240:243], v[124:127], v[80:83]
    s_waitcnt vmcnt(8) lgkmcnt(3)
    ds_read_b128 a[240:243], v1 offset:20480
    v_mfma_f32_16x16x32_bf16 v[52:55], a[244:247], v[128:131], v[52:55]
    v_mfma_f32_16x16x32_bf16 v[56:59], a[244:247], v[132:135], v[56:59]
    ds_read_b128 a[244:247], v1 offset:21504
    v_mfma_f32_16x16x32_bf16 v[60:63], a[224:227], v[128:131], v[60:63]
    buffer_load_dwordx2 v[30:31], v15, s[4:7], s81 offen offset:1024 sc1
    v_mfma_f32_16x16x32_bf16 v[64:67], a[224:227], v[132:135], v[64:67]
    s_waitcnt lgkmcnt(3)
    ds_read_b128 a[224:227], v1 offset:22528
    v_mfma_f32_16x16x32_bf16 v[68:71], a[228:231], v[128:131], v[68:71]
    v_mfma_f32_16x16x32_bf16 v[72:75], a[228:231], v[132:135], v[72:75]
    ds_read_b128 a[228:231], v1 offset:23552
    v_mfma_f32_16x16x32_bf16 v[76:79], a[232:235], v[128:131], v[76:79]
    buffer_load_dwordx2 v[32:33], v15, s[4:7], s81 offen offset:1536 sc1
    v_mfma_f32_16x16x32_bf16 v[80:83], a[232:235], v[132:135], v[80:83]
    s_waitcnt lgkmcnt(3)
    ds_read_b128 a[232:235], v1 offset:24576
    v_mfma_f32_16x16x32_bf16 v[92:95], a[236:239], a[204:207], 0
    v_mfma_f32_16x16x32_bf16 v[96:99], a[236:239], a[208:211], 0
    s_waitcnt vmcnt(8)
    ds_read_b128 a[236:239], v1 offset:25600
    v_mfma_f32_16x16x32_bf16 v[52:55], a[240:243], v[136:139], v[52:55]
    s_add_u32 s42, s80, 16384
    buffer_load_dwordx4 v[160:163], v1, s[4:7], s42 offen offset:0 sc1
    v_mfma_f32_16x16x32_bf16 v[56:59], a[240:243], v[140:143], v[56:59]
    s_waitcnt lgkmcnt(3)
    ds_read_b128 a[240:243], v1 offset:26624
    v_mfma_f32_16x16x32_bf16 v[60:63], a[244:247], v[136:139], v[60:63]
    buffer_load_dwordx4 v[164:167], v1, s[4:7], s42 offen offset:1024 sc1
    v_mfma_f32_16x16x32_bf16 v[64:67], a[244:247], v[140:143], v[64:67]
    ds_read_b128 a[244:247], v1 offset:27648
    v_mfma_f32_16x16x32_bf16 v[68:71], a[224:227], v[136:139], v[68:71]
    v_mfma_f32_16x16x32_bf16 v[72:75], a[224:227], v[140:143], v[72:75]
    s_waitcnt lgkmcnt(3)
    ds_read_b128 a[224:227], v1 offset:28672
    v_mfma_f32_16x16x32_bf16 v[76:79], a[228:231], v[136:139], v[76:79]
    buffer_load_dwordx4 v[168:171], v1, s[4:7], s42 offen offset:2048 sc1
    v_mfma_f32_16x16x32_bf16 v[80:83], a[228:231], v[140:143], v[80:83]
    s_waitcnt vmcnt(9)
    ds_read_b128 a[228:231], v1 offset:29696
    v_mfma_f32_16x16x32_bf16 v[52:55], a[232:235], v[144:147], v[52:55]
    v_mfma_f32_16x16x32_bf16 v[56:59], a[232:235], v[148:151], v[56:59]
    s_waitcnt lgkmcnt(3)
    ds_read_b128 a[232:235], v1 offset:30720
    v_mfma_f32_16x16x32_bf16 v[60:63], a[236:239], v[144:147], v[60:63]
    buffer_load_dwordx4 v[172:175], v1, s[4:7], s42 offen offset:3072 sc1
    v_mfma_f32_16x16x32_bf16 v[64:67], a[236:239], v[148:151], v[64:67]
    ds_read_b128 a[236:239], v1 offset:31744
    v_mfma_f32_16x16x32_bf16 v[68:71], a[240:243], v[144:147], v[68:71]
    v_mfma_f32_16x16x32_bf16 v[72:75], a[240:243], v[148:151], v[72:75]
    s_waitcnt lgkmcnt(3)
    ds_read_b128 a[240:243], v10 offset:0
    v_mfma_f32_16x16x32_bf16 v[76:79], a[244:247], v[144:147], v[76:79]
    s_add_u32 s42, s80, 20480
    buffer_load_dwordx4 v[176:179], v1, s[4:7], s42 offen offset:0 sc1
    v_mfma_f32_16x16x32_bf16 v[80:83], a[244:247], v[148:151], v[80:83]
    s_waitcnt vmcnt(9)
    ds_read_b128 a[244:247], v1 offset:32768
    v_mfma_f32_16x16x32_bf16 v[52:55], a[224:227], v[152:155], v[52:55]
    v_mfma_f32_16x16x32_bf16 v[56:59], a[224:227], v[156:159], v[56:59]
    s_waitcnt lgkmcnt(3)
    ds_read_b128 a[224:227], v1 offset:33792
    v_mfma_f32_16x16x32_bf16 v[60:63], a[228:231], v[152:155], v[60:63]
    buffer_load_dwordx4 v[180:183], v1, s[4:7], s42 offen offset:1024 sc1
    v_mfma_f32_16x16x32_bf16 v[64:67], a[228:231], v[156:159], v[64:67]
    ds_read_b128 a[228:231], v1 offset:34816
    v_mfma_f32_16x16x32_bf16 v[68:71], a[232:235], v[152:155], v[68:71]
    buffer_load_dwordx4 v[184:187], v1, s[4:7], s42 offen offset:2048 sc1
    v_mfma_f32_16x16x32_bf16 v[72:75], a[232:235], v[156:159], v[72:75]
    s_waitcnt lgkmcnt(3)
    ds_read_b128 a[232:235], v1 offset:35840
    v_mfma_f32_16x16x32_bf16 v[76:79], a[236:239], v[152:155], v[76:79]
    v_mfma_f32_16x16x32_bf16 v[80:83], a[236:239], v[156:159], v[80:83]
    ds_read_b128 a[236:239], v1 offset:36864
    v_mfma_f32_16x16x32_bf16 v[100:103], a[240:243], a[204:207], 0
    buffer_load_dwordx4 v[188:191], v1, s[4:7], s42 offen offset:3072 sc1
    v_mfma_f32_16x16x32_bf16 v[104:107], a[240:243], a[208:211], 0
    s_waitcnt vmcnt(6) lgkmcnt(3)
    ds_read_b128 a[240:243], v1 offset:37888
    v_mfma_f32_16x16x32_bf16 v[52:55], a[244:247], v[160:163], v[52:55]
    v_mfma_f32_16x16x32_bf16 v[56:59], a[244:247], v[164:167], v[56:59]
    ds_read_b128 a[244:247], v1 offset:38912
    v_mfma_f32_16x16x32_bf16 v[60:63], a[224:227], v[160:163], v[60:63]
    s_add_u32 s42, s80, 24576
    buffer_load_dwordx4 v[192:195], v1, s[4:7], s42 offen offset:0 sc1
    v_mfma_f32_16x16x32_bf16 v[64:67], a[224:227], v[164:167], v[64:67]
    s_waitcnt lgkmcnt(3)
    ds_read_b128 a[224:227], v1 offset:39936
    v_mfma_f32_16x16x32_bf16 v[68:71], a[228:231], v[160:163], v[68:71]
    v_mfma_f32_16x16x32_bf16 v[72:75], a[228:231], v[164:167], v[72:75]
    ds_read_b128 a[228:231], v2 offset:19200
    v_mfma_f32_16x16x32_bf16 v[76:79], a[232:235], v[160:163], v[76:79]
    buffer_load_dwordx4 v[196:199], v1, s[4:7], s42 offen offset:1024 sc1
    v_mfma_f32_16x16x32_bf16 v[80:83], a[232:235], v[164:167], v[80:83]
    s_waitcnt vmcnt(6) lgkmcnt(3)
    ds_read_b128 a[232:235], v1 offset:40960
    v_mfma_f32_16x16x32_bf16 v[52:55], a[236:239], v[168:171], v[52:55]
    v_mfma_f32_16x16x32_bf16 v[56:59], a[236:239], v[172:175], v[56:59]
    ds_read_b128 a[236:239], v1 offset:41984
    v_mfma_f32_16x16x32_bf16 v[60:63], a[240:243], v[168:171], v[60:63]
    buffer_load_dwordx4 v[200:203], v1, s[4:7], s42 offen offset:2048 sc1
    v_mfma_f32_16x16x32_bf16 v[64:67], a[240:243], v[172:175], v[64:67]
    s_waitcnt lgkmcnt(3)
    ds_read_b128 a[240:243], v1 offset:43008
    v_add_f32 v26, v26, v28
    v_mfma_f32_16x16x32_bf16 v[68:71], a[244:247], v[168:171], v[68:71]
    buffer_load_dwordx4 v[204:207], v1, s[4:7], s42 offen offset:3072 sc1
    v_mfma_f32_16x16x32_bf16 v[72:75], a[244:247], v[172:175], v[72:75]
    ds_read_b128 a[244:247], v1 offset:44032
    v_add_f32 v27, v27, v29
    v_mfma_f32_16x16x32_bf16 v[76:79], a[224:227], v[168:171], v[76:79]
    v_add_f32 v30, v30, v32
    v_add_f32 v31, v31, v33
    v_mfma_f32_16x16x32_bf16 v[80:83], a[224:227], v[172:175], v[80:83]
    s_waitcnt lgkmcnt(3)
    ds_read_b128 a[224:227], v1 offset:45056
    v_add_f32 v26, v26, v30
    v_mfma_f32_16x16x32_bf16 v[84:87], a[228:231], a[212:215], v[84:87]
    s_add_u32 s42, s80, 28672
    buffer_load_dwordx4 v[208:211], v1, s[4:7], s42 offen offset:0 sc1
    v_mfma_f32_16x16x32_bf16 v[88:91], a[228:231], a[216:219], v[88:91]
    s_waitcnt vmcnt(7)
    ds_read_b128 a[228:231], v1 offset:46080
    v_add_f32 v27, v27, v31
    v_mfma_f32_16x16x32_bf16 v[52:55], a[232:235], v[176:179], v[52:55]
    v_mov_b32 v28, v26
    v_mov_b32 v29, v27
    v_mfma_f32_16x16x32_bf16 v[56:59], a[232:235], v[180:183], v[56:59]
    s_waitcnt lgkmcnt(3)
    ds_read_b128 a[232:235], v1 offset:47104
    v_mfma_f32_16x16x32_bf16 v[60:63], a[236:239], v[176:179], v[60:63]
    buffer_load_dwordx4 v[212:215], v1, s[4:7], s42 offen offset:1024 sc1
    v_mfma_f32_16x16x32_bf16 v[64:67], a[236:239], v[180:183], v[64:67]
    ds_read_b128 a[236:239], v1 offset:48128
    v_mfma_f32_16x16x32_bf16 v[68:71], a[240:243], v[176:179], v[68:71]
    v_permlane32_swap_b32 v26, v28
    v_mfma_f32_16x16x32_bf16 v[72:75], a[240:243], v[180:183], v[72:75]
    s_waitcnt lgkmcnt(3)
    ds_read_b128 a[240:243], v1 offset:49152
    v_mfma_f32_16x16x32_bf16 v[76:79], a[244:247], v[176:179], v[76:79]
    buffer_load_dwordx4 v[216:219], v1, s[4:7], s42 offen offset:2048 sc1
    v_mfma_f32_16x16x32_bf16 v[80:83], a[244:247], v[180:183], v[80:83]
    s_waitcnt vmcnt(7)
    ds_read_b128 a[244:247], v1 offset:50176
    v_mfma_f32_16x16x32_bf16 v[52:55], a[224:227], v[184:187], v[52:55]
    v_permlane32_swap_b32 v27, v29
    v_mfma_f32_16x16x32_bf16 v[56:59], a[224:227], v[188:191], v[56:59]
    s_waitcnt lgkmcnt(3)
    ds_read_b128 a[224:227], v1 offset:51200
    v_add_f32 v26, v26, v28
    v_mfma_f32_16x16x32_bf16 v[60:63], a[228:231], v[184:187], v[60:63]
    buffer_load_dwordx4 v[220:223], v1, s[4:7], s42 offen offset:3072 sc1
    v_mfma_f32_16x16x32_bf16 v[64:67], a[228:231], v[188:191], v[64:67]
    ds_read_b128 a[228:231], v1 offset:52224
    v_add_f32 v27, v27, v29
    v_mfma_f32_16x16x32_bf16 v[68:71], a[232:235], v[184:187], v[68:71]
    s_add_u32 s42, s80, 32768
    buffer_load_dwordx4 v[224:227], v1, s[4:7], s42 offen offset:0 sc1
    v_mfma_f32_16x16x32_bf16 v[72:75], a[232:235], v[188:191], v[72:75]
    s_waitcnt lgkmcnt(3)
    ds_read_b128 a[232:235], v2 offset:20224
    v_mul_f32 v26, 0xbacccccd, v26
    v_mfma_f32_16x16x32_bf16 v[76:79], a[236:239], v[184:187], v[76:79]
    v_mul_f32 v27, 0x3acccccd, v27
    v_mov_b32 v28, v26
    v_mfma_f32_16x16x32_bf16 v[80:83], a[236:239], v[188:191], v[80:83]
    s_waitcnt vmcnt(7)
    ds_read_b128 a[236:239], v1 offset:53248
    v_fma_f32 v27, -v26, v26, v27
    v_mfma_f32_16x16x32_bf16 v[52:55], a[240:243], v[192:195], v[52:55]
    buffer_load_dwordx4 v[228:231], v1, s[4:7], s42 offen offset:1024 sc1
    v_mfma_f32_16x16x32_bf16 v[56:59], a[240:243], v[196:199], v[56:59]
    s_waitcnt lgkmcnt(3)
    ds_read_b128 a[240:243], v1 offset:54272
    v_max_f32 v27, 0, v27
    v_mfma_f32_16x16x32_bf16 v[60:63], a[244:247], v[192:195], v[60:63]
    v_add_f32 v27, 0x3727c5ac, v27
    v_mfma_f32_16x16x32_bf16 v[64:67], a[244:247], v[196:199], v[64:67]
    ds_read_b128 a[244:247], v1 offset:55296
    v_mfma_f32_16x16x32_bf16 v[68:71], a[224:227], v[192:195], v[68:71]
    buffer_load_dwordx4 v[232:235], v1, s[4:7], s42 offen offset:2048 sc1
    v_mfma_f32_16x16x32_bf16 v[72:75], a[224:227], v[196:199], v[72:75]
    s_waitcnt lgkmcnt(3)
    ds_read_b128 a[224:227], v1 offset:56320
    v_mfma_f32_16x16x32_bf16 v[76:79], a[228:231], v[192:195], v[76:79]
    v_permlane16_swap_b32 v26, v28
    v_mfma_f32_16x16x32_bf16 v[80:83], a[228:231], v[196:199], v[80:83]
    ds_read_b128 a[228:231], v1 offset:57344
    v_mfma_f32_16x16x32_bf16 v[92:95], a[232:235], a[212:215], v[92:95]
    buffer_load_dwordx4 v[236:239], v1, s[4:7], s42 offen offset:3072 sc1
    v_mfma_f32_16x16x32_bf16 v[96:99], a[232:235], a[216:219], v[96:99]
    s_waitcnt vmcnt(8) lgkmcnt(3)
    ds_read_b128 a[232:235], v1 offset:58368
    v_mfma_f32_16x16x32_bf16 v[52:55], a[236:239], v[200:203], v[52:55]
    v_rsq_f32 v38, v27
    v_mfma_f32_16x16x32_bf16 v[56:59], a[236:239], v[204:207], v[56:59]
    ds_read_b128 a[236:239], v1 offset:59392
    v_cvt_pk_bf16_f32 v42, v26, v26
    v_mfma_f32_16x16x32_bf16 v[60:63], a[240:243], v[200:203], v[60:63]
    s_add_u32 s42, s80, 36864
    buffer_load_dwordx4 v[240:243], v1, s[4:7], s42 offen offset:0 sc1
    v_mfma_f32_16x16x32_bf16 v[64:67], a[240:243], v[204:207], v[64:67]
    s_waitcnt lgkmcnt(3)
    ds_read_b128 a[240:243], v1 offset:60416
    v_and_b32 v43, 0xffff0000, v42
    v_mfma_f32_16x16x32_bf16 v[68:71], a[244:247], v[200:203], v[68:71]
    buffer_load_dwordx4 v[244:247], v1, s[4:7], s42 offen offset:1024 sc1
    v_mfma_f32_16x16x32_bf16 v[72:75], a[244:247], v[204:207], v[72:75]
    ds_read_b128 a[244:247], v10 offset:2816
    v_sub_f32 v43, v26, v43
    v_mfma_f32_16x16x32_bf16 v[76:79], a[224:227], v[200:203], v[76:79]
    v_cvt_pk_bf16_f32 v43, v43, v43
    v_cvt_pk_bf16_f32 v44, v28, v28
    v_mfma_f32_16x16x32_bf16 v[80:83], a[224:227], v[204:207], v[80:83]
    s_waitcnt vmcnt(8) lgkmcnt(3)
    ds_read_b128 a[224:227], v1 offset:61440
    v_and_b32 v45, 0xffff0000, v44
    v_mfma_f32_16x16x32_bf16 v[52:55], a[228:231], v[208:211], v[52:55]
    buffer_load_dwordx4 v[248:251], v1, s[4:7], s42 offen offset:2048 sc1
    v_mfma_f32_16x16x32_bf16 v[56:59], a[228:231], v[212:215], v[56:59]
    ds_read_b128 a[228:231], v1 offset:62464
    v_sub_f32 v45, v28, v45
    v_mfma_f32_16x16x32_bf16 v[60:63], a[232:235], v[208:211], v[60:63]
    v_cvt_pk_bf16_f32 v45, v45, v45
    v_mul_f32 v40, v27, v38
    v_mfma_f32_16x16x32_bf16 v[64:67], a[232:235], v[212:215], v[64:67]
    s_waitcnt lgkmcnt(3)
    ds_read_b128 a[232:235], v1 offset:63488
    v_mul_f32 v38, 0xbfb8aa3b, v38
    v_mov_b32 v41, v40
    v_mov_b32 v39, v38
    s_nop 0
    v_permlane16_swap_b32 v40, v41
    v_permlane16_swap_b32 v38, v39
    v_mfma_f32_16x16x32_bf16 v[68:71], a[236:239], v[208:211], v[68:71]
    s_bfm_b64 vcc, 16, 0
    v_cndmask_b32 v30, 0, v42, vcc
    v_cndmask_b32 v31, 0, v43, vcc
    buffer_load_dwordx4 v[252:255], v1, s[4:7], s42 offen offset:3072 sc1
    v_mfma_f32_16x16x32_bf16 v[72:75], a[236:239], v[212:215], v[72:75]
    ds_read_b128 a[236:239], v1 offset:64512
    v_mov_b32 v32, 0
    v_mov_b32 v33, 0
    v_mfma_f32_16x16x32_bf16 v[76:79], a[240:243], v[208:211], v[76:79]
    s_bfm_b64 vcc, 16, 0
    v_cndmask_b32 v34, 0, v44, vcc
    v_cndmask_b32 v35, 0, v45, vcc
    v_mfma_f32_16x16x32_bf16 v[80:83], a[240:243], v[212:215], v[80:83]
    s_waitcnt lgkmcnt(3)
    ds_read_b128 a[240:243], v2 offset:0
    v_mov_b32 v36, 0
    v_mov_b32 v37, 0
    v_mfma_f32_16x16x32_bf16 v[100:103], a[244:247], a[212:215], v[100:103]
    s_add_u32 m0, s74, 98304
    s_add_u32 s44, s52, 98304
    buffer_load_dwordx4 v1, s[4:7], s44 offen offset:0 sc1 lds
    v_mfma_f32_16x16x32_bf16 v[104:107], a[244:247], a[216:219], v[104:107]
    ds_read_b128 a[244:247], v2 offset:1024
    v_mfma_f32_16x16x32_bf16 v[52:55], a[252:255], v[30:33], v[52:55]
    v_mfma_f32_16x16x32_bf16 v[56:59], a[252:255], v[34:37], v[56:59]
    s_waitcnt vmcnt(9)
    buffer_load_dwordx4 v1, s[4:7], s44 offen offset:1024 sc1 lds
    v_mfma_f32_16x16x32_bf16 v[52:55], a[224:227], v[216:219], v[52:55]
    v_mfma_f32_16x16x32_bf16 v[56:59], a[224:227], v[220:223], v[56:59]
    s_waitcnt lgkmcnt(3)
    ds_read_b128 a[224:227], v2 offset:2048
    v_mfma_f32_16x16x32_bf16 v[60:63], a[228:231], v[216:219], v[60:63]
    s_bfm_b64 vcc, 16, 32
    v_cndmask_b32 v30, 0, v42, vcc
    v_cndmask_b32 v31, 0, v43, vcc
    v_mfma_f32_16x16x32_bf16 v[64:67], a[228:231], v[220:223], v[64:67]
    ds_read_b128 a[228:231], v2 offset:3072
    buffer_load_dwordx4 v1, s[4:7], s44 offen offset:2048 sc1 lds
    v_mfma_f32_16x16x32_bf16 v[68:71], a[232:235], v[216:219], v[68:71]
    s_bfm_b64 vcc, 16, 32
    v_cndmask_b32 v34, 0, v44, vcc
    v_cndmask_b32 v35, 0, v45, vcc
    v_mfma_f32_16x16x32_bf16 v[72:75], a[232:235], v[220:223], v[72:75]
    s_waitcnt lgkmcnt(3)
    ds_read_b128 a[232:235], v2 offset:4096
    v_mfma_f32_16x16x32_bf16 v[76:79], a[236:239], v[216:219], v[76:79]
    v_mfma_f32_16x16x32_bf16 v[80:83], a[236:239], v[220:223], v[80:83]
    ds_read_b128 a[236:239], v2 offset:5120
    v_mfma_f32_16x16x32_bf16 v[60:63], a[252:255], v[30:33], v[60:63]
    buffer_load_dwordx4 v1, s[4:7], s44 offen offset:3072 sc1 lds
    v_mfma_f32_16x16x32_bf16 v[64:67], a[252:255], v[34:37], v[64:67]
    s_waitcnt vmcnt(10)
    v_mfma_f32_16x16x32_bf16 v[52:55], a[240:243], v[224:227], v[52:55]
    v_mfma_f32_16x16x32_bf16 v[56:59], a[240:243], v[228:231], v[56:59]
    s_waitcnt lgkmcnt(3)
    ds_read_b128 a[240:243], v2 offset:6144
    s_add_u32 m0, s74, 114688
    s_add_u32 s44, s52, 114688
    buffer_load_dwordx4 v1, s[4:7], s44 offen offset:0 sc1 lds
    v_mfma_f32_16x16x32_bf16 v[60:63], a[244:247], v[224:227], v[60:63]
    s_bfm_b64 vcc, 16, 16
    v_cndmask_b32 v30, 0, v42, vcc
    v_cndmask_b32 v31, 0, v43, vcc
    v_mfma_f32_16x16x32_bf16 v[64:67], a[244:247], v[228:231], v[64:67]
    ds_read_b128 a[244:247], v2 offset:7168
    v_mfma_f32_16x16x32_bf16 v[68:71], a[224:227], v[224:227], v[68:71]
    s_bfm_b64 vcc, 16, 16
    v_cndmask_b32 v34, 0, v44, vcc
    v_cndmask_b32 v35, 0, v45, vcc
    v_mfma_f32_16x16x32_bf16 v[72:75], a[224:227], v[228:231], v[72:75]
    s_waitcnt lgkmcnt(3)
    ds_read_b128 a[224:227], v2 offset:22016
    v_mfma_f32_16x16x32_bf16 v[76:79], a[228:231], v[224:227], v[76:79]
    buffer_load_dwordx4 v1, s[4:7], s44 offen offset:1024 sc1 lds
    v_mfma_f32_16x16x32_bf16 v[80:83], a[228:231], v[228:231], v[80:83]
    ds_read_b128 a[228:231], v2 offset:8192
    v_mfma_f32_16x16x32_bf16 v[68:71], a[252:255], v[30:33], v[68:71]
    v_mfma_f32_16x16x32_bf16 v[72:75], a[252:255], v[34:37], v[72:75]
    s_waitcnt vmcnt(10)
    buffer_load_dwordx4 v1, s[4:7], s44 offen offset:2048 sc1 lds
    v_mfma_f32_16x16x32_bf16 v[52:55], a[232:235], v[232:235], v[52:55]
    v_mfma_f32_16x16x32_bf16 v[56:59], a[232:235], v[236:239], v[56:59]
    s_waitcnt lgkmcnt(3)
    ds_read_b128 a[232:235], v2 offset:9216
    v_mfma_f32_16x16x32_bf16 v[60:63], a[236:239], v[232:235], v[60:63]
    v_mfma_f32_16x16x32_bf16 v[64:67], a[236:239], v[236:239], v[64:67]
    ds_read_b128 a[236:239], v2 offset:10240
    buffer_load_dwordx4 v1, s[4:7], s44 offen offset:3072 sc1 lds
    v_mfma_f32_16x16x32_bf16 v[68:71], a[240:243], v[232:235], v[68:71]
    s_bfm_b64 vcc, 16, 48
    v_cndmask_b32 v30, 0, v42, vcc
    v_cndmask_b32 v31, 0, v43, vcc
    v_mfma_f32_16x16x32_bf16 v[72:75], a[240:243], v[236:239], v[72:75]
    s_waitcnt lgkmcnt(3)
    ds_read_b128 a[240:243], v2 offset:11264
    v_mfma_f32_16x16x32_bf16 v[76:79], a[244:247], v[232:235], v[76:79]
    s_bfm_b64 vcc, 16, 48
    v_cndmask_b32 v34, 0, v44, vcc
    v_cndmask_b32 v35, 0, v45, vcc
    v_mfma_f32_16x16x32_bf16 v[80:83], a[244:247], v[236:239], v[80:83]
    ds_read_b128 a[244:247], v2 offset:12288
    v_mfma_f32_16x16x32_bf16 v[84:87], a[224:227], a[220:223], v[84:87]
    s_add_u32 m0, s74, 131072
    s_add_u32 s44, s52, 131072
    s_mul_i32 s59, s3, 2048
    s_sub_u32 m0, m0, s59
    s_sub_u32 s44, s44, s59
    buffer_load_dwordx4 v1, s[4:7], s44 offen offset:0 sc1 lds
    v_mfma_f32_16x16x32_bf16 v[88:91], a[224:227], v[116:119], v[88:91]
    s_waitcnt lgkmcnt(3)
    ds_read_b128 a[224:227], v2 offset:13312
    v_mfma_f32_16x16x32_bf16 v[76:79], a[252:255], v[30:33], v[76:79]
    v_mfma_f32_16x16x32_bf16 v[80:83], a[252:255], v[34:37], v[80:83]
    s_waitcnt vmcnt(11)
    buffer_load_dwordx4 v1, s[4:7], s44 offen offset:1024 sc1 lds
    v_mfma_f32_16x16x32_bf16 v[52:55], a[228:231], v[240:243], v[52:55]
    v_mfma_f32_16x16x32_bf16 v[56:59], a[228:231], v[244:247], v[56:59]
    ds_read_b128 a[228:231], v2 offset:14336
    v_mfma_f32_16x16x32_bf16 v[60:63], a[232:235], v[240:243], v[60:63]
    v_mfma_f32_16x16x32_bf16 v[64:67], a[232:235], v[244:247], v[64:67]
    s_waitcnt lgkmcnt(3)
    ds_read_b128 a[232:235], v2 offset:15360
    v_mfma_f32_16x16x32_bf16 v[68:71], a[236:239], v[240:243], v[68:71]
    v_mfma_f32_16x16x32_bf16 v[72:75], a[236:239], v[244:247], v[72:75]
    ds_read_b128 a[236:239], v2 offset:23040
    v_mfma_f32_16x16x32_bf16 v[76:79], a[240:243], v[240:243], v[76:79]
    v_mfma_f32_16x16x32_bf16 v[80:83], a[240:243], v[244:247], v[80:83]
    s_waitcnt vmcnt(10) lgkmcnt(3)
    ds_read_b128 a[240:243], v10 offset:5632
    v_mfma_f32_16x16x32_bf16 v[52:55], a[244:247], v[248:251], v[52:55]
    v_mfma_f32_16x16x32_bf16 v[56:59], a[244:247], v[252:255], v[56:59]
    ds_read_b128 a[244:247], v2 offset:24832
    v_mfma_f32_16x16x32_bf16 v[60:63], a[224:227], v[248:251], v[60:63]
    v_mfma_f32_16x16x32_bf16 v[64:67], a[224:227], v[252:255], v[64:67]
    s_waitcnt lgkmcnt(3)
    ds_read_b128 a[224:227], v2 offset:25856
    v_mfma_f32_16x16x32_bf16 v[68:71], a[228:231], v[248:251], v[68:71]
    v_mfma_f32_16x16x32_bf16 v[72:75], a[228:231], v[252:255], v[72:75]
    ds_read_b128 a[228:231], v10 offset:8448
    v_mfma_f32_16x16x32_bf16 v[76:79], a[232:235], v[248:251], v[76:79]
    v_mfma_f32_16x16x32_bf16 v[80:83], a[232:235], v[252:255], v[80:83]
    s_waitcnt lgkmcnt(3)
    ds_read_b128 a[232:235], v2 offset:27648
    v_mfma_f32_16x16x32_bf16 v[92:95], a[236:239], a[220:223], v[92:95]
    v_mfma_f32_16x16x32_bf16 v[96:99], a[236:239], v[116:119], v[96:99]
    ds_read_b128 a[236:239], v2 offset:28672
    v_mfma_f32_16x16x32_bf16 v[100:103], a[240:243], a[220:223], v[100:103]
    v_mfma_f32_16x16x32_bf16 v[104:107], a[240:243], v[116:119], v[104:107]
    s_waitcnt lgkmcnt(3)
    ds_read_b128 a[240:243], v10 offset:11264
    s_add_u32 s43, s92, 49152
    buffer_load_dwordx4 a[204:207], v1, s[4:7], s43 offen offset:3072 sc1
    v_mul_f32 v26, v38, v52
    v_exp_f32 v26, v26
    v_mul_f32 v27, v38, v53
    v_mfma_f32_16x16x32_bf16 v[84:87], a[244:247], v[120:123], v[84:87]
    v_exp_f32 v27, v27
    v_fma_f32 v26, v26, v40, v40
    v_rcp_f32 v26, v26
    v_fma_f32 v27, v27, v40, v40
    v_mfma_f32_16x16x32_bf16 v[88:91], a[244:247], v[124:127], v[88:91]
    ds_read_b128 a[244:247], v2 offset:30464
    v_rcp_f32 v27, v27
    v_mul_f32 v28, v38, v54
    v_exp_f32 v28, v28
    v_mfma_f32_16x16x32_bf16 v[92:95], a[224:227], v[120:123], v[92:95]
    v_mul_f32 v52, v52, v26
    v_mul_f32 v53, v53, v27
    v_mul_f32 v29, v38, v55
    v_exp_f32 v29, v29
    v_cvt_pk_bf16_f32 v52, v52, v53
    v_mfma_f32_16x16x32_bf16 v[96:99], a[224:227], v[124:127], v[96:99]
    s_waitcnt lgkmcnt(3)
    ds_read_b128 a[224:227], v2 offset:31488
    v_fma_f32 v28, v28, v40, v40
    v_rcp_f32 v28, v28
    v_fma_f32 v29, v29, v40, v40
    v_mfma_f32_16x16x32_bf16 v[100:103], a[228:231], v[120:123], v[100:103]
    s_waitcnt vmcnt(7)
    s_barrier
    s_add_u32 s43, s92, 53248
    buffer_load_dwordx4 a[208:211], v1, s[4:7], s43 offen offset:0 sc1
    v_rcp_f32 v29, v29
    v_mul_f32 v54, v54, v28
    v_mul_f32 v55, v55, v29
    v_cvt_pk_bf16_f32 v53, v54, v55
    v_mfma_f32_16x16x32_bf16 v[104:107], a[228:231], v[124:127], v[104:107]
    ds_read_b128 a[228:231], v10 offset:14080
    v_mul_f32 v26, v38, v60
    v_exp_f32 v26, v26
    v_mul_f32 v27, v38, v61
    v_mfma_f32_16x16x32_bf16 v[84:87], a[232:235], v[128:131], v[84:87]
    v_exp_f32 v27, v27
    v_fma_f32 v26, v26, v40, v40
    v_rcp_f32 v26, v26
    v_fma_f32 v27, v27, v40, v40
    v_mfma_f32_16x16x32_bf16 v[88:91], a[232:235], v[132:135], v[88:91]
    s_waitcnt lgkmcnt(3)
    ds_read_b128 a[232:235], v2 offset:33280
    v_rcp_f32 v27, v27
    v_mul_f32 v28, v38, v62
    v_exp_f32 v28, v28
    v_mfma_f32_16x16x32_bf16 v[92:95], a[236:239], v[128:131], v[92:95]
    v_mul_f32 v60, v60, v26
    v_mul_f32 v61, v61, v27
    v_mul_f32 v29, v38, v63
    v_exp_f32 v29, v29
    v_cvt_pk_bf16_f32 v54, v60, v61
    v_mfma_f32_16x16x32_bf16 v[96:99], a[236:239], v[132:135], v[96:99]
    ds_read_b128 a[236:239], v2 offset:34304
    v_fma_f32 v28, v28, v40, v40
    v_rcp_f32 v28, v28
    v_fma_f32 v29, v29, v40, v40
    v_mfma_f32_16x16x32_bf16 v[100:103], a[240:243], v[128:131], v[100:103]
    buffer_load_dwordx4 a[212:215], v1, s[4:7], s43 offen offset:1024 sc1
    v_rcp_f32 v29, v29
    v_mul_f32 v62, v62, v28
    v_mul_f32 v63, v63, v29
    v_cvt_pk_bf16_f32 v55, v62, v63
    v_mfma_f32_16x16x32_bf16 v[104:107], a[240:243], v[132:135], v[104:107]
    s_waitcnt lgkmcnt(3)
    ds_read_b128 a[240:243], v10 offset:16896
    buffer_store_dwordx4 v[52:55], v1, s[4:7], s87 offen offset:0 sc1
    v_mul_f32 v26, v39, v56
    v_exp_f32 v26, v26
    v_mfma_f32_16x16x32_bf16 v[84:87], a[244:247], v[136:139], v[84:87]
    v_mul_f32 v27, v39, v57
    v_exp_f32 v27, v27
    v_fma_f32 v26, v26, v41, v41
    v_rcp_f32 v26, v26
    v_mfma_f32_16x16x32_bf16 v[88:91], a[244:247], v[140:143], v[88:91]
    ds_read_b128 a[244:247], v2 offset:36096
    v_fma_f32 v27, v27, v41, v41
    v_rcp_f32 v27, v27
    v_mul_f32 v28, v39, v58
    v_mfma_f32_16x16x32_bf16 v[92:95], a[224:227], v[136:139], v[92:95]
    v_exp_f32 v28, v28
    v_mul_f32 v56, v56, v26
    v_mul_f32 v57, v57, v27
    v_mul_f32 v29, v39, v59
    v_mfma_f32_16x16x32_bf16 v[96:99], a[224:227], v[140:143], v[96:99]
    s_waitcnt lgkmcnt(3)
    ds_read_b128 a[224:227], v2 offset:37120
    buffer_load_dwordx4 a[216:219], v1, s[4:7], s43 offen offset:2048 sc1
    v_exp_f32 v29, v29
    v_cvt_pk_bf16_f32 v56, v56, v57
    v_fma_f32 v28, v28, v41, v41
    v_mfma_f32_16x16x32_bf16 v[100:103], a[228:231], v[136:139], v[100:103]
    v_rcp_f32 v28, v28
    v_fma_f32 v29, v29, v41, v41
    v_rcp_f32 v29, v29
    v_mul_f32 v58, v58, v28
    v_mfma_f32_16x16x32_bf16 v[104:107], a[228:231], v[140:143], v[104:107]
    ds_read_b128 a[228:231], v10 offset:19712
    v_mul_f32 v59, v59, v29
    v_cvt_pk_bf16_f32 v57, v58, v59
    v_mul_f32 v26, v39, v64
    v_exp_f32 v26, v26
    v_mfma_f32_16x16x32_bf16 v[84:87], a[232:235], v[144:147], v[84:87]
    v_mul_f32 v27, v39, v65
    v_exp_f32 v27, v27
    v_fma_f32 v26, v26, v41, v41
    v_rcp_f32 v26, v26
    v_mfma_f32_16x16x32_bf16 v[88:91], a[232:235], v[148:151], v[88:91]
    s_waitcnt lgkmcnt(3)
    ds_read_b128 a[232:235], v2 offset:38912
    v_fma_f32 v27, v27, v41, v41
    v_rcp_f32 v27, v27
    v_mul_f32 v28, v39, v66
    v_mfma_f32_16x16x32_bf16 v[92:95], a[236:239], v[144:147], v[92:95]
    v_exp_f32 v28, v28
    v_mul_f32 v64, v64, v26
    v_mul_f32 v65, v65, v27
    v_mul_f32 v29, v39, v67
    v_mfma_f32_16x16x32_bf16 v[96:99], a[236:239], v[148:151], v[96:99]
    ds_read_b128 a[236:239], v2 offset:39936
    buffer_load_dwordx4 a[220:223], v1, s[4:7], s43 offen offset:3072 sc1
    v_exp_f32 v29, v29
    v_cvt_pk_bf16_f32 v58, v64, v65
    v_fma_f32 v28, v28, v41, v41
    v_mfma_f32_16x16x32_bf16 v[100:103], a[240:243], v[144:147], v[100:103]
    v_rcp_f32 v28, v28
    v_fma_f32 v29, v29, v41, v41
    v_rcp_f32 v29, v29
    v_mul_f32 v66, v66, v28
    v_mfma_f32_16x16x32_bf16 v[104:107], a[240:243], v[148:151], v[104:107]
    s_waitcnt lgkmcnt(3)
    ds_read_b128 a[240:243], v10 offset:22528
    v_mul_f32 v67, v67, v29
    v_cvt_pk_bf16_f32 v59, v66, v67
    v_mfma_f32_16x16x32_bf16 v[84:87], a[244:247], v[152:155], v[84:87]
    buffer_store_dwordx4 v[56:59], v6, s[4:7], s87 offen offset:0 sc1
    v_mul_f32 v26, v38, v68
    v_exp_f32 v26, v26
    v_mul_f32 v27, v38, v69
    v_mfma_f32_16x16x32_bf16 v[88:91], a[244:247], v[156:159], v[88:91]
    ds_read_b128 a[244:247], v2 offset:41728
    v_exp_f32 v27, v27
    v_fma_f32 v26, v26, v40, v40
    v_rcp_f32 v26, v26
    v_mfma_f32_16x16x32_bf16 v[92:95], a[224:227], v[152:155], v[92:95]
    v_fma_f32 v27, v27, v40, v40
    v_rcp_f32 v27, v27
    v_mul_f32 v28, v38, v70
    v_exp_f32 v28, v28
    v_mfma_f32_16x16x32_bf16 v[96:99], a[224:227], v[156:159], v[96:99]
    s_waitcnt lgkmcnt(3)
    ds_read_b128 a[224:227], v2 offset:42752
    s_add_u32 s43, s92, 57344
    buffer_load_dwordx4 v[116:119], v1, s[4:7], s43 offen offset:0 sc1
    v_mul_f32 v68, v68, v26
    v_mul_f32 v69, v69, v27
    v_mul_f32 v29, v38, v71
    v_exp_f32 v29, v29
    v_mfma_f32_16x16x32_bf16 v[100:103], a[228:231], v[152:155], v[100:103]
    v_cvt_pk_bf16_f32 v68, v68, v69
    v_fma_f32 v28, v28, v40, v40
    v_rcp_f32 v28, v28
    v_fma_f32 v29, v29, v40, v40
    v_mfma_f32_16x16x32_bf16 v[104:107], a[228:231], v[156:159], v[104:107]
    ds_read_b128 a[228:231], v10 offset:25344
    v_rcp_f32 v29, v29
    v_mul_f32 v70, v70, v28
    v_mul_f32 v71, v71, v29
    v_cvt_pk_bf16_f32 v69, v70, v71
    v_mfma_f32_16x16x32_bf16 v[84:87], a[232:235], v[160:163], v[84:87]
    v_mul_f32 v26, v38, v76
    v_exp_f32 v26, v26
    v_mul_f32 v27, v38, v77
    v_exp_f32 v27, v27
    v_mfma_f32_16x16x32_bf16 v[88:91], a[232:235], v[164:167], v[88:91]
    s_waitcnt lgkmcnt(3)
    ds_read_b128 a[232:235], v2 offset:44544
    v_fma_f32 v26, v26, v40, v40
    v_rcp_f32 v26, v26
    v_fma_f32 v27, v27, v40, v40
    v_mfma_f32_16x16x32_bf16 v[92:95], a[236:239], v[160:163], v[92:95]
    buffer_load_dwordx4 v[120:123], v1, s[4:7], s43 offen offset:1024 sc1
    v_rcp_f32 v27, v27
    v_mul_f32 v28, v38, v78
    v_exp_f32 v28, v28
    v_mul_f32 v76, v76, v26
    v_mfma_f32_16x16x32_bf16 v[96:99], a[236:239], v[164:167], v[96:99]
    ds_read_b128 a[236:239], v2 offset:45568
    v_mul_f32 v77, v77, v27
    v_mul_f32 v29, v38, v79
    v_exp_f32 v29, v29
    v_cvt_pk_bf16_f32 v70, v76, v77
    v_mfma_f32_16x16x32_bf16 v[100:103], a[240:243], v[160:163], v[100:103]
    v_fma_f32 v28, v28, v40, v40
    v_rcp_f32 v28, v28
    v_fma_f32 v29, v29, v40, v40
    v_rcp_f32 v29, v29
    v_mfma_f32_16x16x32_bf16 v[104:107], a[240:243], v[164:167], v[104:107]
    s_waitcnt lgkmcnt(3)
    ds_read_b128 a[240:243], v10 offset:28160
    v_mul_f32 v78, v78, v28
    v_mul_f32 v79, v79, v29
    v_cvt_pk_bf16_f32 v71, v78, v79
    v_mfma_f32_16x16x32_bf16 v[84:87], a[244:247], v[168:171], v[84:87]
    buffer_store_dwordx4 v[68:71], v1, s[4:7], s87 offen offset:1024 sc1
    v_mul_f32 v26, v39, v72
    v_exp_f32 v26, v26
    v_mul_f32 v27, v39, v73
    v_mfma_f32_16x16x32_bf16 v[88:91], a[244:247], v[172:175], v[88:91]
    ds_read_b128 a[244:247], v2 offset:47360
    v_exp_f32 v27, v27
    v_fma_f32 v26, v26, v41, v41
    v_rcp_f32 v26, v26
    v_mfma_f32_16x16x32_bf16 v[92:95], a[224:227], v[168:171], v[92:95]
    s_waitcnt vmcnt(12)
    s_barrier
    buffer_load_dwordx4 v[124:127], v1, s[4:7], s43 offen offset:2048 sc1
    v_fma_f32 v27, v27, v41, v41
    v_rcp_f32 v27, v27
    v_mul_f32 v28, v39, v74
    v_mfma_f32_16x16x32_bf16 v[96:99], a[224:227], v[172:175], v[96:99]
    s_waitcnt lgkmcnt(3)
    ds_read_b128 a[224:227], v2 offset:48384
    v_exp_f32 v28, v28
    v_mul_f32 v72, v72, v26
    v_mul_f32 v73, v73, v27
    v_mul_f32 v29, v39, v75
    v_mfma_f32_16x16x32_bf16 v[100:103], a[228:231], v[168:171], v[100:103]
    v_exp_f32 v29, v29
    v_cvt_pk_bf16_f32 v72, v72, v73
    v_fma_f32 v28, v28, v41, v41
    v_rcp_f32 v28, v28
    v_mfma_f32_16x16x32_bf16 v[104:107], a[228:231], v[172:175], v[104:107]
    ds_read_b128 a[228:231], v10 offset:30976
    v_fma_f32 v29, v29, v41, v41
    v_rcp_f32 v29, v29
    v_mul_f32 v74, v74, v28
    v_mul_f32 v75, v75, v29
    v_mfma_f32_16x16x32_bf16 v[84:87], a[232:235], v[176:179], v[84:87]
    v_cvt_pk_bf16_f32 v73, v74, v75
    v_mul_f32 v26, v39, v80
    v_exp_f32 v26, v26
    v_mul_f32 v27, v39, v81
    v_mfma_f32_16x16x32_bf16 v[88:91], a[232:235], v[180:183], v[88:91]
    s_waitcnt lgkmcnt(3)
    ds_read_b128 a[232:235], v2 offset:50176
    buffer_load_dwordx4 v[128:131], v1, s[4:7], s43 offen offset:3072 sc1
    v_exp_f32 v27, v27
    v_fma_f32 v26, v26, v41, v41
    v_rcp_f32 v26, v26
    v_mfma_f32_16x16x32_bf16 v[92:95], a[236:239], v[176:179], v[92:95]
    v_fma_f32 v27, v27, v41, v41
    v_rcp_f32 v27, v27
    v_mul_f32 v28, v39, v82
    v_exp_f32 v28, v28
    v_mfma_f32_16x16x32_bf16 v[96:99], a[236:239], v[180:183], v[96:99]
    ds_read_b128 a[236:239], v2 offset:51200
    v_mul_f32 v80, v80, v26
    v_mul_f32 v81, v81, v27
    v_mul_f32 v29, v39, v83
    v_exp_f32 v29, v29
    v_mfma_f32_16x16x32_bf16 v[100:103], a[240:243], v[176:179], v[100:103]
    v_cvt_pk_bf16_f32 v74, v80, v81
    v_fma_f32 v28, v28, v41, v41
    v_rcp_f32 v28, v28
    v_fma_f32 v29, v29, v41, v41
    v_mfma_f32_16x16x32_bf16 v[104:107], a[240:243], v[180:183], v[104:107]
    s_waitcnt lgkmcnt(3)
    ds_read_b128 a[240:243], v10 offset:33792
    v_rcp_f32 v29, v29
    v_mul_f32 v82, v82, v28
    v_mul_f32 v83, v83, v29
    v_cvt_pk_bf16_f32 v75, v82, v83
    v_mfma_f32_16x16x32_bf16 v[84:87], a[244:247], v[184:187], v[84:87]
    buffer_store_dwordx4 v[72:75], v6, s[4:7], s87 offen offset:1024 sc1
    v_mfma_f32_16x16x32_bf16 v[88:91], a[244:247], v[188:191], v[88:91]
    ds_read_b128 a[244:247], v2 offset:52992
    v_mfma_f32_16x16x32_bf16 v[92:95], a[224:227], v[184:187], v[92:95]
    s_add_u32 s43, s92, 61440
    buffer_load_dwordx4 v[132:135], v1, s[4:7], s43 offen offset:0 sc1
    v_mfma_f32_16x16x32_bf16 v[96:99], a[224:227], v[188:191], v[96:99]
    s_waitcnt lgkmcnt(3)
    ds_read_b128 a[224:227], v2 offset:54016
    v_mfma_f32_16x16x32_bf16 v[100:103], a[228:231], v[184:187], v[100:103]
    v_mfma_f32_16x16x32_bf16 v[104:107], a[228:231], v[188:191], v[104:107]
    ds_read_b128 a[228:231], v10 offset:36608
    v_mfma_f32_16x16x32_bf16 v[84:87], a[232:235], v[192:195], v[84:87]
    v_mfma_f32_16x16x32_bf16 v[88:91], a[232:235], v[196:199], v[88:91]
    s_waitcnt lgkmcnt(3)
    ds_read_b128 a[232:235], v2 offset:55808
    v_mfma_f32_16x16x32_bf16 v[92:95], a[236:239], v[192:195], v[92:95]
    buffer_load_dwordx4 v[136:139], v1, s[4:7], s43 offen offset:1024 sc1
    v_mfma_f32_16x16x32_bf16 v[96:99], a[236:239], v[196:199], v[96:99]
    ds_read_b128 a[236:239], v2 offset:56832
    v_mfma_f32_16x16x32_bf16 v[100:103], a[240:243], v[192:195], v[100:103]
    v_mfma_f32_16x16x32_bf16 v[104:107], a[240:243], v[196:199], v[104:107]
    s_waitcnt lgkmcnt(3)
    ds_read_b128 a[240:243], v10 offset:39424
    v_mfma_f32_16x16x32_bf16 v[84:87], a[244:247], v[200:203], v[84:87]
    s_bfm_b64 vcc, 16, 0
    v_cndmask_b32 v32, 0, v42, vcc
    v_cndmask_b32 v33, 0, v43, vcc
    buffer_load_dwordx4 v[140:143], v1, s[4:7], s43 offen offset:2048 sc1
    v_mfma_f32_16x16x32_bf16 v[88:91], a[244:247], v[204:207], v[88:91]
    ds_read_b128 a[244:247], v2 offset:58624
    v_mov_b32 v30, 0
    v_mov_b32 v31, 0
    v_mfma_f32_16x16x32_bf16 v[92:95], a[224:227], v[200:203], v[92:95]
    s_bfm_b64 vcc, 16, 0
    v_cndmask_b32 v36, 0, v44, vcc
    v_cndmask_b32 v37, 0, v45, vcc
    v_mfma_f32_16x16x32_bf16 v[96:99], a[224:227], v[204:207], v[96:99]
    s_waitcnt lgkmcnt(3)
    ds_read_b128 a[224:227], v2 offset:59648
    v_mov_b32 v34, 0
    v_mov_b32 v35, 0
    v_mfma_f32_16x16x32_bf16 v[100:103], a[228:231], v[200:203], v[100:103]
    v_mfma_f32_16x16x32_bf16 v[104:107], a[228:231], v[204:207], v[104:107]
    ds_read_b128 a[228:231], v10 offset:42240
    v_mfma_f32_16x16x32_bf16 v[84:87], a[252:255], v[30:33], v[84:87]
    buffer_load_dwordx4 v[144:147], v1, s[4:7], s43 offen offset:3072 sc1
    v_mfma_f32_16x16x32_bf16 v[88:91], a[252:255], v[34:37], v[88:91]
    v_mfma_f32_16x16x32_bf16 v[84:87], a[232:235], v[208:211], v[84:87]
    v_mfma_f32_16x16x32_bf16 v[88:91], a[232:235], v[212:215], v[88:91]
    s_waitcnt lgkmcnt(3)
    ds_read_b128 a[232:235], v2 offset:61440
    v_mfma_f32_16x16x32_bf16 v[92:95], a[236:239], v[208:211], v[92:95]
    v_mfma_f32_16x16x32_bf16 v[96:99], a[236:239], v[212:215], v[96:99]
    ds_read_b128 a[236:239], v2 offset:62464
    v_mfma_f32_16x16x32_bf16 v[100:103], a[240:243], v[208:211], v[100:103]
    s_add_u32 s43, s92, 65536
    buffer_load_dwordx4 v[148:151], v1, s[4:7], s43 offen offset:0 sc1
    v_mfma_f32_16x16x32_bf16 v[104:107], a[240:243], v[212:215], v[104:107]
    s_waitcnt lgkmcnt(3)
    ds_read_b128 a[240:243], v10 offset:45056
    v_mfma_f32_16x16x32_bf16 v[84:87], a[244:247], v[216:219], v[84:87]
    s_bfm_b64 vcc, 16, 32
    v_cndmask_b32 v32, 0, v42, vcc
    v_cndmask_b32 v33, 0, v43, vcc
    v_mfma_f32_16x16x32_bf16 v[88:91], a[244:247], v[220:223], v[88:91]
    ds_read_b128 a[244:247], v2 offset:64256
    v_mfma_f32_16x16x32_bf16 v[92:95], a[224:227], v[216:219], v[92:95]
    s_waitcnt vmcnt(18)
    s_barrier
    s_bfm_b64 vcc, 16, 32
    v_cndmask_b32 v36, 0, v44, vcc
    v_cndmask_b32 v37, 0, v45, vcc
    v_mfma_f32_16x16x32_bf16 v[96:99], a[224:227], v[220:223], v[96:99]
    s_waitcnt lgkmcnt(3)
    ds_read_b128 a[224:227], v2 offset:65280
    v_mfma_f32_16x16x32_bf16 v[100:103], a[228:231], v[216:219], v[100:103]
    buffer_load_dwordx4 v[152:155], v1, s[4:7], s43 offen offset:1024 sc1
    v_mfma_f32_16x16x32_bf16 v[104:107], a[228:231], v[220:223], v[104:107]
    ds_read_b128 a[228:231], v10 offset:47872
    v_mfma_f32_16x16x32_bf16 v[92:95], a[252:255], v[30:33], v[92:95]
    v_mov_b32 v50, 7
    s_waitcnt vmcnt(6)
    s_mov_b64 exec, 1
    s_cmp_lg_u32 s50, 0
    s_cbranch_scc1 L_wt_74
    buffer_store_dword v50, v0, s[4:7], s101 offen offset:0
L_bk_75:
    s_mov_b64 exec, -1
    v_mfma_f32_16x16x32_bf16 v[96:99], a[252:255], v[34:37], v[96:99]
    v_mfma_f32_16x16x32_bf16 v[84:87], a[232:235], v[224:227], v[84:87]
    v_mfma_f32_16x16x32_bf16 v[88:91], a[232:235], v[228:231], v[88:91]
    s_waitcnt lgkmcnt(3)
    ds_read_b128 a[232:235], v3 offset:1536
    v_mfma_f32_16x16x32_bf16 v[92:95], a[236:239], v[224:227], v[92:95]
    buffer_load_dwordx4 v[156:159], v1, s[4:7], s43 offen offset:2048 sc1
    v_mfma_f32_16x16x32_bf16 v[96:99], a[236:239], v[228:231], v[96:99]
    ds_read_b128 a[236:239], v3 offset:2560
    v_mfma_f32_16x16x32_bf16 v[100:103], a[240:243], v[224:227], v[100:103]
    v_mfma_f32_16x16x32_bf16 v[104:107], a[240:243], v[228:231], v[104:107]
    s_waitcnt lgkmcnt(3)
    ds_read_b128 a[240:243], v10 offset:50688
    v_mfma_f32_16x16x32_bf16 v[84:87], a[244:247], v[232:235], v[84:87]
    s_bfm_b64 vcc, 16, 16
    v_cndmask_b32 v32, 0, v42, vcc
    v_cndmask_b32 v33, 0, v43, vcc
    buffer_load_dwordx4 v[160:163], v1, s[4:7], s43 offen offset:3072 sc1
    v_mfma_f32_16x16x32_bf16 v[88:91], a[244:247], v[236:239], v[88:91]
    ds_read_b128 a[244:247], v3 offset:4352
    v_mfma_f32_16x16x32_bf16 v[92:95], a[224:227], v[232:235], v[92:95]
    s_bfm_b64 vcc, 16, 16
    v_cndmask_b32 v36, 0, v44, vcc
    v_cndmask_b32 v37, 0, v45, vcc
    v_mfma_f32_16x16x32_bf16 v[96:99], a[224:227], v[236:239], v[96:99]
    s_waitcnt lgkmcnt(3)
    ds_read_b128 a[224:227], v3 offset:5376
    v_mfma_f32_16x16x32_bf16 v[100:103], a[228:231], v[232:235], v[100:103]
    v_mfma_f32_16x16x32_bf16 v[104:107], a[228:231], v[236:239], v[104:107]
    ds_read_b128 a[228:231], v10 offset:53504
    v_mfma_f32_16x16x32_bf16 v[100:103], a[252:255], v[30:33], v[100:103]
    s_add_u32 s43, s92, 69632
    buffer_load_dwordx4 v[164:167], v1, s[4:7], s43 offen offset:0 sc1
    v_mfma_f32_16x16x32_bf16 v[104:107], a[252:255], v[34:37], v[104:107]
    v_mfma_f32_16x16x32_bf16 v[84:87], a[232:235], v[240:243], v[84:87]
    v_mfma_f32_16x16x32_bf16 v[88:91], a[232:235], v[244:247], v[88:91]
    s_waitcnt lgkmcnt(3)
    v_mfma_f32_16x16x32_bf16 v[92:95], a[236:239], v[240:243], v[92:95]
    v_mfma_f32_16x16x32_bf16 v[96:99], a[236:239], v[244:247], v[96:99]
    buffer_load_dwordx4 v[168:171], v1, s[4:7], s43 offen offset:1024 sc1
    v_mfma_f32_16x16x32_bf16 v[100:103], a[240:243], v[240:243], v[100:103]
    v_mfma_f32_16x16x32_bf16 v[104:107], a[240:243], v[244:247], v[104:107]
    s_waitcnt lgkmcnt(1)
    v_mfma_f32_16x16x32_bf16 v[84:87], a[244:247], v[248:251], v[84:87]
    v_mfma_f32_16x16x32_bf16 v[88:91], a[244:247], v[252:255], v[88:91]
    v_mfma_f32_16x16x32_bf16 v[92:95], a[224:227], v[248:251], v[92:95]
    v_mfma_f32_16x16x32_bf16 v[96:99], a[224:227], v[252:255], v[96:99]
    s_waitcnt lgkmcnt(0)
    v_mfma_f32_16x16x32_bf16 v[100:103], a[228:231], v[248:251], v[100:103]
    v_mfma_f32_16x16x32_bf16 v[104:107], a[228:231], v[252:255], v[104:107]
    buffer_load_dword v47, v48, s[4:7], 0 offen sc1
    s_nop 0
    v_pk_mul_f32 v[26:27], v[84:85], v[38:39] op_sel:[0,0] op_sel_hi:[1,0]
    v_exp_f32 v26, v26
    v_exp_f32 v27, v27
    v_pk_mul_f32 v[28:29], v[86:87], v[38:39] op_sel:[0,0] op_sel_hi:[1,0]
    v_exp_f32 v28, v28
    v_exp_f32 v29, v29
    v_pk_fma_f32 v[26:27], v[26:27], v[40:41], v[40:41] op_sel:[0,0,0] op_sel_hi:[1,0,0]
    v_rcp_f32 v26, v26
    v_rcp_f32 v27, v27
    v_pk_fma_f32 v[28:29], v[28:29], v[40:41], v[40:41] op_sel:[0,0,0] op_sel_hi:[1,0,0]
    v_rcp_f32 v28, v28
    v_rcp_f32 v29, v29
    v_pk_mul_f32 v[84:85], v[84:85], v[26:27]
    v_cvt_pk_bf16_f32 v84, v84, v85
    v_pk_mul_f32 v[86:87], v[86:87], v[28:29]
    v_cvt_pk_bf16_f32 v85, v86, v87
    v_pk_mul_f32 v[26:27], v[92:93], v[38:39] op_sel:[0,0] op_sel_hi:[1,0]
    v_exp_f32 v26, v26
    v_exp_f32 v27, v27
    v_pk_mul_f32 v[28:29], v[94:95], v[38:39] op_sel:[0,0] op_sel_hi:[1,0]
    v_exp_f32 v28, v28
    v_exp_f32 v29, v29
    v_pk_fma_f32 v[26:27], v[26:27], v[40:41], v[40:41] op_sel:[0,0,0] op_sel_hi:[1,0,0]
    v_rcp_f32 v26, v26
    v_rcp_f32 v27, v27
    v_pk_fma_f32 v[28:29], v[28:29], v[40:41], v[40:41] op_sel:[0,0,0] op_sel_hi:[1,0,0]
    v_rcp_f32 v28, v28
    v_rcp_f32 v29, v29
    v_pk_mul_f32 v[92:93], v[92:93], v[26:27]
    v_cvt_pk_bf16_f32 v86, v92, v93
    v_pk_mul_f32 v[94:95], v[94:95], v[28:29]
    v_cvt_pk_bf16_f32 v87, v94, v95
    buffer_store_dwordx4 v[84:87], v1, s[4:7], s88 offen offset:0 sc1
    v_pk_mul_f32 v[26:27], v[88:89], v[38:39] op_sel:[0,1] op_sel_hi:[1,1]
    v_exp_f32 v26, v26
    v_exp_f32 v27, v27
    v_pk_mul_f32 v[28:29], v[90:91], v[38:39] op_sel:[0,1] op_sel_hi:[1,1]
    v_exp_f32 v28, v28
    v_exp_f32 v29, v29
    v_pk_fma_f32 v[26:27], v[26:27], v[40:41], v[40:41] op_sel:[0,1,1] op_sel_hi:[1,1,1]
    v_rcp_f32 v26, v26
    v_rcp_f32 v27, v27
    v_pk_fma_f32 v[28:29], v[28:29], v[40:41], v[40:41] op_sel:[0,1,1] op_sel_hi:[1,1,1]
    v_rcp_f32 v28, v28
    v_rcp_f32 v29, v29
    v_pk_mul_f32 v[88:89], v[88:89], v[26:27]
    v_cvt_pk_bf16_f32 v88, v88, v89
    v_pk_mul_f32 v[90:91], v[90:91], v[28:29]
    v_cvt_pk_bf16_f32 v89, v90, v91
    v_pk_mul_f32 v[26:27], v[96:97], v[38:39] op_sel:[0,1] op_sel_hi:[1,1]
    s_waitcnt vmcnt(1)
    v_cmp_gt_u32 vcc, 7, v47
    s_nop 0
    s_cbranch_vccz L_ck_76ed
L_ck_76:
    s_mov_b32 s45, 200000
L_ck_76_b:
    buffer_load_dword v47, v48, s[4:7], 0 offen sc1
    s_sub_u32 s45, s45, 1
    s_cbranch_scc1 L_ck_76_c
    s_waitcnt vmcnt(0)
    v_cmp_gt_u32 vcc, 7, v47
    s_nop 0
    s_cbranch_vccnz L_ck_76_b
L_ck_76_c:
    s_waitcnt vmcnt(0)
    s_branch L_ck_76ed
L_ck_76ed:
    s_add_u32 s42, s20, 0
    buffer_load_dwordx4 v[172:175], v1, s[4:7], s42 offen offset:0 sc1
    buffer_load_dwordx4 v[176:179], v1, s[4:7], s42 offen offset:1024 sc1
    buffer_load_dwordx4 v[180:183], v1, s[4:7], s42 offen offset:2048 sc1
    buffer_load_dwordx4 v[184:187], v1, s[4:7], s42 offen offset:3072 sc1
    s_add_u32 s42, s20, 4096
    buffer_load_dwordx4 v[188:191], v1, s[4:7], s42 offen offset:0 sc1
    buffer_load_dwordx4 v[192:195], v1, s[4:7], s42 offen offset:1024 sc1
    buffer_load_dwordx4 v[196:199], v1, s[4:7], s42 offen offset:2048 sc1
    buffer_load_dwordx4 v[200:203], v1, s[4:7], s42 offen offset:3072 sc1
    v_exp_f32 v26, v26
    v_exp_f32 v27, v27
    v_pk_mul_f32 v[28:29], v[98:99], v[38:39] op_sel:[0,1] op_sel_hi:[1,1]
    v_exp_f32 v28, v28
    v_exp_f32 v29, v29
    v_pk_fma_f32 v[26:27], v[26:27], v[40:41], v[40:41] op_sel:[0,1,1] op_sel_hi:[1,1,1]
    v_rcp_f32 v26, v26
    v_rcp_f32 v27, v27
    v_pk_fma_f32 v[28:29], v[28:29], v[40:41], v[40:41] op_sel:[0,1,1] op_sel_hi:[1,1,1]
    v_rcp_f32 v28, v28
    v_rcp_f32 v29, v29
    v_pk_mul_f32 v[96:97], v[96:97], v[26:27]
    v_cvt_pk_bf16_f32 v90, v96, v97
    v_pk_mul_f32 v[98:99], v[98:99], v[28:29]
    v_cvt_pk_bf16_f32 v91, v98, v99
    buffer_store_dwordx4 v[88:91], v6, s[4:7], s88 offen offset:0 sc1
    v_pk_mul_f32 v[26:27], v[100:101], v[38:39] op_sel:[0,0] op_sel_hi:[1,0]
    v_exp_f32 v26, v26
    v_exp_f32 v27, v27
    v_pk_mul_f32 v[28:29], v[102:103], v[38:39] op_sel:[0,0] op_sel_hi:[1,0]
    v_exp_f32 v28, v28
    v_exp_f32 v29, v29
    v_pk_fma_f32 v[26:27], v[26:27], v[40:41], v[40:41] op_sel:[0,0,0] op_sel_hi:[1,0,0]
    v_rcp_f32 v26, v26
    v_rcp_f32 v27, v27
    v_pk_fma_f32 v[28:29], v[28:29], v[40:41], v[40:41] op_sel:[0,0,0] op_sel_hi:[1,0,0]
    v_rcp_f32 v28, v28
    v_rcp_f32 v29, v29
    v_pk_mul_f32 v[100:101], v[100:101], v[26:27]
    v_cvt_pk_bf16_f32 v100, v100, v101
    v_pk_mul_f32 v[102:103], v[102:103], v[28:29]
    v_cvt_pk_bf16_f32 v101, v102, v103
    v_pk_mul_f32 v[26:27], v[104:105], v[38:39] op_sel:[0,1] op_sel_hi:[1,1]
    v_exp_f32 v26, v26
    v_exp_f32 v27, v27
    v_pk_mul_f32 v[28:29], v[106:107], v[38:39] op_sel:[0,1] op_sel_hi:[1,1]
    v_exp_f32 v28, v28
    v_exp_f32 v29, v29
    v_pk_fma_f32 v[26:27], v[26:27], v[40:41], v[40:41] op_sel:[0,1,1] op_sel_hi:[1,1,1]
    v_rcp_f32 v26, v26
    v_rcp_f32 v27, v27
    v_pk_fma_f32 v[28:29], v[28:29], v[40:41], v[40:41] op_sel:[0,1,1] op_sel_hi:[1,1,1]
    v_rcp_f32 v28, v28
    v_rcp_f32 v29, v29
    v_pk_mul_f32 v[104:105], v[104:105], v[26:27]
    v_cvt_pk_bf16_f32 v102, v104, v105
    v_pk_mul_f32 v[106:107], v[106:107], v[28:29]
    v_cvt_pk_bf16_f32 v103, v106, v107
    v_permlane16_swap_b32 v100, v102
    s_nop 0
    v_permlane16_swap_b32 v101, v103
    buffer_store_dwordx4 v[100:103], v5, s[4:7], s89 offen sc1
L_p5_1:
    s_waitcnt vmcnt(9)
    v_mfma_f32_16x16x32_bf16 v[52:55], a[0:3], v[172:175], 0
    s_add_u32 s42, s21, 0
    buffer_load_dwordx4 v[204:207], v1, s[4:7], s42 offen offset:0 sc1
    v_mfma_f32_16x16x32_bf16 v[56:59], a[4:7], v[172:175], 0
    v_and_b32 v26, 15, v0
    v_lshrrev_b32 v27, 4, v0
    v_mfma_f32_16x16x32_bf16 v[60:63], a[8:11], v[172:175], 0
    v_mul_u32_u24 v26, 1280, v26
    v_lshl_add_u32 v5, v27, 4, v26
    v_mfma_f32_16x16x32_bf16 v[64:67], a[12:15], v[172:175], 0
    v_lshl_add_u32 v6, v27, 3, v26
    v_lshl_add_u32 v5, s63, 5, v5
    v_mfma_f32_16x16x32_bf16 v[68:71], a[16:19], v[172:175], 0
    buffer_load_dwordx4 v[208:211], v1, s[4:7], s42 offen offset:1024 sc1
    s_waitcnt vmcnt(10)
    v_mfma_f32_16x16x32_bf16 v[52:55], a[20:23], v[176:179], v[52:55]
    v_mov_b32 v27, s63
    v_xor_b32 v27, 1, v27
    v_mfma_f32_16x16x32_bf16 v[56:59], a[24:27], v[176:179], v[56:59]
    v_lshl_add_u32 v6, v27, 7, v6
    v_mfma_f32_16x16x32_bf16 v[60:63], a[28:31], v[176:179], v[60:63]
    v_mov_b32 v9, s3
    v_mul_u32_u24 v9, 15360, v9
    v_mfma_f32_16x16x32_bf16 v[64:67], a[32:35], v[176:179], v[64:67]
    v_add_u32 v9, 102400, v9
    v_add_u32 v9, v9, v1
    v_mfma_f32_16x16x32_bf16 v[68:71], a[36:39], v[176:179], v[68:71]
    buffer_load_dwordx4 v[212:215], v1, s[4:7], s42 offen offset:2048 sc1
    s_waitcnt vmcnt(10)
    v_mfma_f32_16x16x32_bf16 v[52:55], a[40:43], v[180:183], v[52:55]
    v_lshlrev_b32 v26, 16, v16
    v_and_b32 v27, 0xffff0000, v16
    v_mfma_f32_16x16x32_bf16 v[56:59], a[44:47], v[180:183], v[56:59]
    v_lshlrev_b32 v28, 16, v17
    v_and_b32 v29, 0xffff0000, v17
    v_mfma_f32_16x16x32_bf16 v[60:63], a[48:51], v[180:183], v[60:63]
    v_lshlrev_b32 v30, 16, v18
    v_and_b32 v31, 0xffff0000, v18
    v_mfma_f32_16x16x32_bf16 v[64:67], a[52:55], v[180:183], v[64:67]
    buffer_load_dwordx4 v[216:219], v1, s[4:7], s42 offen offset:3072 sc1
    v_mfma_f32_16x16x32_bf16 v[68:71], a[56:59], v[180:183], v[68:71]
    v_lshlrev_b32 v32, 16, v19
    v_and_b32 v33, 0xffff0000, v19
    s_waitcnt vmcnt(10)
    v_mfma_f32_16x16x32_bf16 v[52:55], a[60:63], v[184:187], v[52:55]
    v_lshlrev_b32 v34, 16, v20
    v_and_b32 v35, 0xffff0000, v20
    v_mfma_f32_16x16x32_bf16 v[56:59], a[64:67], v[184:187], v[56:59]
    v_lshlrev_b32 v36, 16, v21
    v_and_b32 v37, 0xffff0000, v21
    v_mfma_f32_16x16x32_bf16 v[60:63], a[68:71], v[184:187], v[60:63]
    v_lshlrev_b32 v38, 16, v22
    v_and_b32 v39, 0xffff0000, v22
    v_mfma_f32_16x16x32_bf16 v[64:67], a[72:75], v[184:187], v[64:67]
    s_add_u32 s42, s21, 4096
    buffer_load_dwordx4 v[220:223], v1, s[4:7], s42 offen offset:0 sc1
    v_mfma_f32_16x16x32_bf16 v[68:71], a[76:79], v[184:187], v[68:71]
    v_lshlrev_b32 v40, 16, v23
    v_and_b32 v41, 0xffff0000, v23
    s_waitcnt vmcnt(10)
    v_mfma_f32_16x16x32_bf16 v[52:55], a[80:83], v[188:191], v[52:55]
    v_lshlrev_b32 v42, 16, v24
    v_and_b32 v43, 0xffff0000, v24
    v_mfma_f32_16x16x32_bf16 v[56:59], a[84:87], v[188:191], v[56:59]
    v_lshlrev_b32 v44, 16, v25
    v_and_b32 v45, 0xffff0000, v25
    v_mfma_f32_16x16x32_bf16 v[60:63], a[88:91], v[188:191], v[60:63]
    buffer_load_dwordx4 v[224:227], v1, s[4:7], s42 offen offset:1024 sc1
    v_mfma_f32_16x16x32_bf16 v[64:67], a[92:95], v[188:191], v[64:67]
    v_mfma_f32_16x16x32_bf16 v[68:71], a[96:99], v[188:191], v[68:71]
    s_waitcnt vmcnt(10)
    v_mfma_f32_16x16x32_bf16 v[52:55], a[100:103], v[192:195], v[52:55]
    v_mfma_f32_16x16x32_bf16 v[56:59], a[104:107], v[192:195], v[56:59]
    v_mfma_f32_16x16x32_bf16 v[60:63], a[108:111], v[192:195], v[60:63]
    buffer_load_dwordx4 v[228:231], v1, s[4:7], s42 offen offset:2048 sc1
    v_mfma_f32_16x16x32_bf16 v[64:67], a[112:115], v[192:195], v[64:67]
    v_mfma_f32_16x16x32_bf16 v[68:71], a[116:119], v[192:195], v[68:71]
    s_waitcnt vmcnt(10)
    v_mfma_f32_16x16x32_bf16 v[52:55], a[120:123], v[196:199], v[52:55]
    v_mov_b32 v50, 8
    s_waitcnt vmcnt(7)
    s_mov_b64 exec, 1
    s_cmp_lg_u32 s50, 0
    s_cbranch_scc1 L_wt_77
    buffer_store_dword v50, v0, s[4:7], s101 offen offset:0
L_bk_78:
    s_mov_b64 exec, -1
    v_mfma_f32_16x16x32_bf16 v[56:59], a[124:127], v[196:199], v[56:59]
    s_barrier
    buffer_load_dwordx4 v[232:235], v1, s[4:7], s42 offen offset:3072 sc1
    v_mfma_f32_16x16x32_bf16 v[60:63], a[128:131], v[196:199], v[60:63]
    v_mfma_f32_16x16x32_bf16 v[64:67], a[132:135], v[196:199], v[64:67]
    v_mfma_f32_16x16x32_bf16 v[68:71], a[136:139], v[196:199], v[68:71]
    v_mfma_f32_16x16x32_bf16 v[52:55], a[140:143], v[200:203], v[52:55]
    v_mfma_f32_16x16x32_bf16 v[56:59], a[144:147], v[200:203], v[56:59]
    s_add_u32 s42, s22, 0
    buffer_load_dwordx4 v[236:239], v1, s[4:7], s42 offen offset:0 sc1
    v_mfma_f32_16x16x32_bf16 v[60:63], a[148:151], v[200:203], v[60:63]
    v_mfma_f32_16x16x32_bf16 v[64:67], a[152:155], v[200:203], v[64:67]
    v_mfma_f32_16x16x32_bf16 v[68:71], a[156:159], v[200:203], v[68:71]
    s_waitcnt vmcnt(9)
    v_mfma_f32_16x16x32_bf16 v[72:75], a[0:3], v[204:207], 0
    buffer_load_dwordx4 v[240:243], v1, s[4:7], s42 offen offset:1024 sc1
    v_mfma_f32_16x16x32_bf16 v[76:79], a[4:7], v[204:207], 0
    v_mfma_f32_16x16x32_bf16 v[80:83], a[8:11], v[204:207], 0
    v_mfma_f32_16x16x32_bf16 v[84:87], a[12:15], v[204:207], 0
    v_mfma_f32_16x16x32_bf16 v[88:91], a[16:19], v[204:207], 0
    s_waitcnt vmcnt(9)
    v_mfma_f32_16x16x32_bf16 v[72:75], a[20:23], v[208:211], v[72:75]
    buffer_load_dwordx4 v[244:247], v1, s[4:7], s42 offen offset:2048 sc1
    v_mfma_f32_16x16x32_bf16 v[76:79], a[24:27], v[208:211], v[76:79]
    v_mfma_f32_16x16x32_bf16 v[80:83], a[28:31], v[208:211], v[80:83]
    v_mfma_f32_16x16x32_bf16 v[84:87], a[32:35], v[208:211], v[84:87]
    v_mfma_f32_16x16x32_bf16 v[88:91], a[36:39], v[208:211], v[88:91]
    buffer_load_dwordx4 v[248:251], v1, s[4:7], s42 offen offset:3072 sc1
    s_waitcnt vmcnt(10)
    v_mfma_f32_16x16x32_bf16 v[72:75], a[40:43], v[212:215], v[72:75]
    v_mfma_f32_16x16x32_bf16 v[76:79], a[44:47], v[212:215], v[76:79]
    v_mfma_f32_16x16x32_bf16 v[80:83], a[48:51], v[212:215], v[80:83]
    v_mfma_f32_16x16x32_bf16 v[84:87], a[52:55], v[212:215], v[84:87]
    v_mfma_f32_16x16x32_bf16 v[88:91], a[56:59], v[212:215], v[88:91]
    s_add_u32 s42, s22, 4096
    buffer_load_dwordx4 v[252:255], v1, s[4:7], s42 offen offset:0 sc1
    s_waitcnt vmcnt(10)
    v_mfma_f32_16x16x32_bf16 v[72:75], a[60:63], v[216:219], v[72:75]
    v_mfma_f32_16x16x32_bf16 v[76:79], a[64:67], v[216:219], v[76:79]
    v_mfma_f32_16x16x32_bf16 v[80:83], a[68:71], v[216:219], v[80:83]
    v_mfma_f32_16x16x32_bf16 v[84:87], a[72:75], v[216:219], v[84:87]
    buffer_load_dwordx4 a[224:227], v1, s[4:7], s42 offen offset:1024 sc1
    v_mfma_f32_16x16x32_bf16 v[88:91], a[76:79], v[216:219], v[88:91]
    s_waitcnt vmcnt(10)
    v_mfma_f32_16x16x32_bf16 v[72:75], a[80:83], v[220:223], v[72:75]
    buffer_load_dword v47, v48, s[4:7], 0 offen sc1
    v_mfma_f32_16x16x32_bf16 v[76:79], a[84:87], v[220:223], v[76:79]
    v_mfma_f32_16x16x32_bf16 v[80:83], a[88:91], v[220:223], v[80:83]
    v_mfma_f32_16x16x32_bf16 v[84:87], a[92:95], v[220:223], v[84:87]
    buffer_load_dwordx4 a[228:231], v1, s[4:7], s42 offen offset:2048 sc1
    v_mfma_f32_16x16x32_bf16 v[88:91], a[96:99], v[220:223], v[88:91]
    s_waitcnt vmcnt(11)
    v_mfma_f32_16x16x32_bf16 v[72:75], a[100:103], v[224:227], v[72:75]
    v_mfma_f32_16x16x32_bf16 v[76:79], a[104:107], v[224:227], v[76:79]
    v_mfma_f32_16x16x32_bf16 v[80:83], a[108:111], v[224:227], v[80:83]
    buffer_load_dwordx4 a[232:235], v1, s[4:7], s42 offen offset:3072 sc1
    v_mfma_f32_16x16x32_bf16 v[84:87], a[112:115], v[224:227], v[84:87]
    v_mfma_f32_16x16x32_bf16 v[88:91], a[116:119], v[224:227], v[88:91]
    s_waitcnt vmcnt(11)
    v_mfma_f32_16x16x32_bf16 v[72:75], a[120:123], v[228:231], v[72:75]
    v_mfma_f32_16x16x32_bf16 v[76:79], a[124:127], v[228:231], v[76:79]
    v_mfma_f32_16x16x32_bf16 v[80:83], a[128:131], v[228:231], v[80:83]
    v_mfma_f32_16x16x32_bf16 v[84:87], a[132:135], v[228:231], v[84:87]
    v_mfma_f32_16x16x32_bf16 v[88:91], a[136:139], v[228:231], v[88:91]
    s_waitcnt vmcnt(9)
    v_mfma_f32_16x16x32_bf16 v[72:75], a[140:143], v[232:235], v[72:75]
    v_mfma_f32_16x16x32_bf16 v[76:79], a[144:147], v[232:235], v[76:79]
    v_mfma_f32_16x16x32_bf16 v[80:83], a[148:151], v[232:235], v[80:83]
    v_mfma_f32_16x16x32_bf16 v[84:87], a[152:155], v[232:235], v[84:87]
    v_mfma_f32_16x16x32_bf16 v[88:91], a[156:159], v[232:235], v[88:91]
    s_waitcnt vmcnt(8)
    v_mfma_f32_16x16x32_bf16 v[92:95], a[0:3], v[236:239], 0
    v_mfma_f32_16x16x32_bf16 v[96:99], a[4:7], v[236:239], 0
    v_mfma_f32_16x16x32_bf16 v[100:103], a[8:11], v[236:239], 0
    v_mfma_f32_16x16x32_bf16 v[104:107], a[12:15], v[236:239], 0
    v_mfma_f32_16x16x32_bf16 v[108:111], a[16:19], v[236:239], 0
    s_waitcnt vmcnt(7)
    v_mfma_f32_16x16x32_bf16 v[92:95], a[20:23], v[240:243], v[92:95]
    v_mfma_f32_16x16x32_bf16 v[96:99], a[24:27], v[240:243], v[96:99]
    v_mfma_f32_16x16x32_bf16 v[100:103], a[28:31], v[240:243], v[100:103]
    v_mfma_f32_16x16x32_bf16 v[104:107], a[32:35], v[240:243], v[104:107]
    v_mfma_f32_16x16x32_bf16 v[108:111], a[36:39], v[240:243], v[108:111]
    s_waitcnt vmcnt(6)
    v_mfma_f32_16x16x32_bf16 v[92:95], a[40:43], v[244:247], v[92:95]
    v_mfma_f32_16x16x32_bf16 v[96:99], a[44:47], v[244:247], v[96:99]
    v_mfma_f32_16x16x32_bf16 v[100:103], a[48:51], v[244:247], v[100:103]
    s_waitcnt vmcnt(2)
    v_cmp_gt_u32 vcc, 8, v47
    s_nop 0
    s_cbranch_vccz L_ck_79ed
L_ck_79:
    s_mov_b32 s45, 200000
L_ck_79_b:
    buffer_load_dword v47, v48, s[4:7], 0 offen sc1
    s_sub_u32 s45, s45, 1
    s_cbranch_scc1 L_ck_79_c
    s_waitcnt vmcnt(0)
    v_cmp_gt_u32 vcc, 8, v47
    s_nop 0
    s_cbranch_vccnz L_ck_79_b
L_ck_79_c:
    s_waitcnt vmcnt(0)
    s_branch L_ck_79ed
L_ck_79ed:
    s_add_u32 s42, s20, 8192
    buffer_load_dwordx4 a[236:239], v1, s[4:7], s42 offen offset:0 sc1
    buffer_load_dwordx4 a[240:243], v1, s[4:7], s42 offen offset:1024 sc1
    buffer_load_dwordx4 a[244:247], v1, s[4:7], s42 offen offset:2048 sc1
    v_mfma_f32_16x16x32_bf16 v[104:107], a[52:55], v[244:247], v[104:107]
    v_mfma_f32_16x16x32_bf16 v[108:111], a[56:59], v[244:247], v[108:111]
    v_mfma_f32_16x16x32_bf16 v[92:95], a[60:63], v[248:251], v[92:95]
    v_mfma_f32_16x16x32_bf16 v[96:99], a[64:67], v[248:251], v[96:99]
    buffer_load_dwordx4 v[172:175], v1, s[4:7], s42 offen offset:3072 sc1
    v_mfma_f32_16x16x32_bf16 v[100:103], a[68:71], v[248:251], v[100:103]
    v_mfma_f32_16x16x32_bf16 v[104:107], a[72:75], v[248:251], v[104:107]
    v_mfma_f32_16x16x32_bf16 v[108:111], a[76:79], v[248:251], v[108:111]
    v_mfma_f32_16x16x32_bf16 v[92:95], a[80:83], v[252:255], v[92:95]
    v_mfma_f32_16x16x32_bf16 v[96:99], a[84:87], v[252:255], v[96:99]
    s_add_u32 s42, s20, 12288
    buffer_load_dwordx4 v[176:179], v1, s[4:7], s42 offen offset:0 sc1
    v_mfma_f32_16x16x32_bf16 v[100:103], a[88:91], v[252:255], v[100:103]
    v_mfma_f32_16x16x32_bf16 v[104:107], a[92:95], v[252:255], v[104:107]
    v_mfma_f32_16x16x32_bf16 v[108:111], a[96:99], v[252:255], v[108:111]
    v_mfma_f32_16x16x32_bf16 v[92:95], a[100:103], a[224:227], v[92:95]
    buffer_load_dwordx4 v[180:183], v1, s[4:7], s42 offen offset:1024 sc1
    v_mfma_f32_16x16x32_bf16 v[96:99], a[104:107], a[224:227], v[96:99]
    v_mfma_f32_16x16x32_bf16 v[100:103], a[108:111], a[224:227], v[100:103]
    v_mfma_f32_16x16x32_bf16 v[104:107], a[112:115], a[224:227], v[104:107]
    v_mfma_f32_16x16x32_bf16 v[108:111], a[116:119], a[224:227], v[108:111]
    s_waitcnt vmcnt(7)
    v_mfma_f32_16x16x32_bf16 v[92:95], a[120:123], a[228:231], v[92:95]
    s_add_u32 s42, s21, 8192
    buffer_load_dwordx4 v[184:187], v1, s[4:7], s42 offen offset:0 sc1
    v_mfma_f32_16x16x32_bf16 v[96:99], a[124:127], a[228:231], v[96:99]
    v_mfma_f32_16x16x32_bf16 v[100:103], a[128:131], a[228:231], v[100:103]
    v_mfma_f32_16x16x32_bf16 v[104:107], a[132:135], a[228:231], v[104:107]
    v_mfma_f32_16x16x32_bf16 v[108:111], a[136:139], a[228:231], v[108:111]
    buffer_load_dwordx4 v[188:191], v1, s[4:7], s42 offen offset:1024 sc1
    s_waitcnt vmcnt(8)
    v_mfma_f32_16x16x32_bf16 v[92:95], a[140:143], a[232:235], v[92:95]
    v_mfma_f32_16x16x32_bf16 v[96:99], a[144:147], a[232:235], v[96:99]
    v_mfma_f32_16x16x32_bf16 v[100:103], a[148:151], a[232:235], v[100:103]
    v_mfma_f32_16x16x32_bf16 v[104:107], a[152:155], a[232:235], v[104:107]
    v_mfma_f32_16x16x32_bf16 v[108:111], a[156:159], a[232:235], v[108:111]
    buffer_load_dwordx4 v[192:195], v1, s[4:7], s42 offen offset:2048 sc1
    s_waitcnt vmcnt(8)
    v_mfma_f32_16x16x32_bf16 v[52:55], a[160:163], a[236:239], v[52:55]
    v_mfma_f32_16x16x32_bf16 v[56:59], a[164:167], a[236:239], v[56:59]
    v_mfma_f32_16x16x32_bf16 v[60:63], a[168:171], a[236:239], v[60:63]
    v_mfma_f32_16x16x32_bf16 v[64:67], a[172:175], a[236:239], v[64:67]
    buffer_load_dwordx4 v[196:199], v1, s[4:7], s42 offen offset:3072 sc1
    v_mfma_f32_16x16x32_bf16 v[68:71], a[176:179], a[236:239], v[68:71]
    s_waitcnt vmcnt(8)
    v_mfma_f32_16x16x32_bf16 v[52:55], a[180:183], a[240:243], v[52:55]
    v_mfma_f32_16x16x32_bf16 v[56:59], a[184:187], a[240:243], v[56:59]
    v_mfma_f32_16x16x32_bf16 v[60:63], a[188:191], a[240:243], v[60:63]
    v_mfma_f32_16x16x32_bf16 v[64:67], a[192:195], a[240:243], v[64:67]
    s_add_u32 s42, s21, 12288
    buffer_load_dwordx4 v[200:203], v1, s[4:7], s42 offen offset:0 sc1
    v_mfma_f32_16x16x32_bf16 v[68:71], a[196:199], a[240:243], v[68:71]
    s_waitcnt vmcnt(8)
    v_mfma_f32_16x16x32_bf16 v[52:55], a[200:203], a[244:247], v[52:55]
    v_mfma_f32_16x16x32_bf16 v[56:59], a[204:207], a[244:247], v[56:59]
    v_mfma_f32_16x16x32_bf16 v[60:63], a[208:211], a[244:247], v[60:63]
    buffer_load_dwordx4 v[204:207], v1, s[4:7], s42 offen offset:1024 sc1
    v_mfma_f32_16x16x32_bf16 v[64:67], a[212:215], a[244:247], v[64:67]
    v_mfma_f32_16x16x32_bf16 v[68:71], a[216:219], a[244:247], v[68:71]
    s_waitcnt vmcnt(8)
    v_mfma_f32_16x16x32_bf16 v[52:55], a[220:223], v[172:175], v[52:55]
    v_mfma_f32_16x16x32_bf16 v[56:59], v[116:119], v[172:175], v[56:59]
    v_mfma_f32_16x16x32_bf16 v[60:63], v[120:123], v[172:175], v[60:63]
    s_add_u32 s42, s22, 8192
    buffer_load_dwordx4 v[208:211], v1, s[4:7], s42 offen offset:0 sc1
    v_mfma_f32_16x16x32_bf16 v[64:67], v[124:127], v[172:175], v[64:67]
    v_mfma_f32_16x16x32_bf16 v[68:71], v[128:131], v[172:175], v[68:71]
    s_waitcnt vmcnt(8)
    v_mfma_f32_16x16x32_bf16 v[52:55], v[132:135], v[176:179], v[52:55]
    v_mfma_f32_16x16x32_bf16 v[56:59], v[136:139], v[176:179], v[56:59]
    buffer_load_dwordx4 v[212:215], v1, s[4:7], s42 offen offset:1024 sc1
    v_mfma_f32_16x16x32_bf16 v[60:63], v[140:143], v[176:179], v[60:63]
    v_mfma_f32_16x16x32_bf16 v[64:67], v[144:147], v[176:179], v[64:67]
    v_mfma_f32_16x16x32_bf16 v[68:71], v[148:151], v[176:179], v[68:71]
    s_waitcnt vmcnt(8)
    v_mfma_f32_16x16x32_bf16 v[52:55], v[152:155], v[180:183], v[52:55]
    v_mfma_f32_16x16x32_bf16 v[56:59], v[156:159], v[180:183], v[56:59]
    buffer_load_dwordx4 v[216:219], v1, s[4:7], s42 offen offset:2048 sc1
    v_mfma_f32_16x16x32_bf16 v[60:63], v[160:163], v[180:183], v[60:63]
    v_mfma_f32_16x16x32_bf16 v[64:67], v[164:167], v[180:183], v[64:67]
    v_mfma_f32_16x16x32_bf16 v[68:71], v[168:171], v[180:183], v[68:71]
    s_waitcnt vmcnt(8)
    v_mfma_f32_16x16x32_bf16 v[72:75], a[160:163], v[184:187], v[72:75]
    buffer_load_dwordx4 v[220:223], v1, s[4:7], s42 offen offset:3072 sc1
    s_mul_i32 s41, s16, 15360
    s_add_u32 s41, s41, 102400
    v_mfma_f32_16x16x32_bf16 v[76:79], a[164:167], v[184:187], v[76:79]
    v_add_u32 v8, s41, v1
    v_mfma_f32_16x16x32_bf16 v[80:83], a[168:171], v[184:187], v[80:83]
    ds_write_b128 v8, v[52:55] offset:0
    v_mfma_f32_16x16x32_bf16 v[84:87], a[172:175], v[184:187], v[84:87]
    v_mfma_f32_16x16x32_bf16 v[88:91], a[176:179], v[184:187], v[88:91]
    s_waitcnt vmcnt(8)
    v_mfma_f32_16x16x32_bf16 v[72:75], a[180:183], v[188:191], v[72:75]
    s_add_u32 s42, s22, 12288
    buffer_load_dwordx4 v[224:227], v1, s[4:7], s42 offen offset:0 sc1
    v_mfma_f32_16x16x32_bf16 v[76:79], a[184:187], v[188:191], v[76:79]
    ds_write_b128 v8, v[56:59] offset:1024
    v_mfma_f32_16x16x32_bf16 v[80:83], a[188:191], v[188:191], v[80:83]
    v_mfma_f32_16x16x32_bf16 v[84:87], a[192:195], v[188:191], v[84:87]
    v_mfma_f32_16x16x32_bf16 v[88:91], a[196:199], v[188:191], v[88:91]
    buffer_load_dwordx4 v[228:231], v1, s[4:7], s42 offen offset:1024 sc1
    s_waitcnt vmcnt(9)
    v_mfma_f32_16x16x32_bf16 v[72:75], a[200:203], v[192:195], v[72:75]
    ds_write_b128 v8, v[60:63] offset:2048
    v_mfma_f32_16x16x32_bf16 v[76:79], a[204:207], v[192:195], v[76:79]
    v_mfma_f32_16x16x32_bf16 v[80:83], a[208:211], v[192:195], v[80:83]
    v_mfma_f32_16x16x32_bf16 v[84:87], a[212:215], v[192:195], v[84:87]
    v_mfma_f32_16x16x32_bf16 v[88:91], a[216:219], v[192:195], v[88:91]
    s_add_u32 s42, s23, 0
    buffer_load_dwordx4 v[232:235], v1, s[4:7], s42 offen offset:0 sc1
    ds_write_b128 v8, v[64:67] offset:3072
    s_waitcnt vmcnt(9)
    v_mfma_f32_16x16x32_bf16 v[72:75], a[220:223], v[196:199], v[72:75]
    v_mfma_f32_16x16x32_bf16 v[76:79], v[116:119], v[196:199], v[76:79]
    v_mfma_f32_16x16x32_bf16 v[80:83], v[120:123], v[196:199], v[80:83]
    v_mfma_f32_16x16x32_bf16 v[84:87], v[124:127], v[196:199], v[84:87]
    buffer_load_dwordx4 v[236:239], v1, s[4:7], s42 offen offset:1024 sc1
    ds_write_b128 v8, v[68:71] offset:4096
    v_mfma_f32_16x16x32_bf16 v[88:91], v[128:131], v[196:199], v[88:91]
    s_waitcnt vmcnt(9)
    v_mfma_f32_16x16x32_bf16 v[72:75], v[132:135], v[200:203], v[72:75]
    v_mfma_f32_16x16x32_bf16 v[76:79], v[136:139], v[200:203], v[76:79]
    v_mfma_f32_16x16x32_bf16 v[80:83], v[140:143], v[200:203], v[80:83]
    v_mfma_f32_16x16x32_bf16 v[84:87], v[144:147], v[200:203], v[84:87]
    buffer_load_dwordx4 v[240:243], v1, s[4:7], s42 offen offset:2048 sc1
    v_mfma_f32_16x16x32_bf16 v[88:91], v[148:151], v[200:203], v[88:91]
    s_waitcnt vmcnt(9)
    v_mfma_f32_16x16x32_bf16 v[72:75], v[152:155], v[204:207], v[72:75]
    v_mfma_f32_16x16x32_bf16 v[76:79], v[156:159], v[204:207], v[76:79]
    v_mfma_f32_16x16x32_bf16 v[80:83], v[160:163], v[204:207], v[80:83]
    buffer_load_dwordx4 v[244:247], v1, s[4:7], s42 offen offset:3072 sc1
    v_mfma_f32_16x16x32_bf16 v[84:87], v[164:167], v[204:207], v[84:87]
    v_mfma_f32_16x16x32_bf16 v[88:91], v[168:171], v[204:207], v[88:91]
    s_waitcnt vmcnt(9)
    v_mfma_f32_16x16x32_bf16 v[92:95], a[160:163], v[208:211], v[92:95]
    s_mul_i32 s41, s17, 15360
    s_add_u32 s41, s41, 107520
    v_mfma_f32_16x16x32_bf16 v[96:99], a[164:167], v[208:211], v[96:99]
    v_add_u32 v8, s41, v1
    v_mfma_f32_16x16x32_bf16 v[100:103], a[168:171], v[208:211], v[100:103]
    s_add_u32 s42, s23, 4096
    buffer_load_dwordx4 v[248:251], v1, s[4:7], s42 offen offset:0 sc1
    ds_write_b128 v8, v[72:75] offset:0
    v_mfma_f32_16x16x32_bf16 v[104:107], a[172:175], v[208:211], v[104:107]
    v_mfma_f32_16x16x32_bf16 v[108:111], a[176:179], v[208:211], v[108:111]
    s_waitcnt vmcnt(9)
    v_mfma_f32_16x16x32_bf16 v[92:95], a[180:183], v[212:215], v[92:95]
    v_mfma_f32_16x16x32_bf16 v[96:99], a[184:187], v[212:215], v[96:99]
    buffer_load_dwordx4 v[252:255], v1, s[4:7], s42 offen offset:1024 sc1
    ds_write_b128 v8, v[76:79] offset:1024
    v_mfma_f32_16x16x32_bf16 v[100:103], a[188:191], v[212:215], v[100:103]
    v_mfma_f32_16x16x32_bf16 v[104:107], a[192:195], v[212:215], v[104:107]
    v_mfma_f32_16x16x32_bf16 v[108:111], a[196:199], v[212:215], v[108:111]
    s_waitcnt vmcnt(9)
    v_mfma_f32_16x16x32_bf16 v[92:95], a[200:203], v[216:219], v[92:95]
    ds_write_b128 v8, v[80:83] offset:2048
    v_mfma_f32_16x16x32_bf16 v[96:99], a[204:207], v[216:219], v[96:99]
    buffer_load_dwordx4 a[224:227], v1, s[4:7], s42 offen offset:2048 sc1
    v_mfma_f32_16x16x32_bf16 v[100:103], a[208:211], v[216:219], v[100:103]
    v_mfma_f32_16x16x32_bf16 v[104:107], a[212:215], v[216:219], v[104:107]
    v_mfma_f32_16x16x32_bf16 v[108:111], a[216:219], v[216:219], v[108:111]
    ds_write_b128 v8, v[84:87] offset:3072
    s_waitcnt vmcnt(9)
    v_mfma_f32_16x16x32_bf16 v[92:95], a[220:223], v[220:223], v[92:95]
    buffer_load_dwordx4 a[228:231], v1, s[4:7], s42 offen offset:3072 sc1
    v_mfma_f32_16x16x32_bf16 v[96:99], v[116:119], v[220:223], v[96:99]
    v_mfma_f32_16x16x32_bf16 v[100:103], v[120:123], v[220:223], v[100:103]
    v_mfma_f32_16x16x32_bf16 v[104:107], v[124:127], v[220:223], v[104:107]
    ds_write_b128 v8, v[88:91] offset:4096
    v_mfma_f32_16x16x32_bf16 v[108:111], v[128:131], v[220:223], v[108:111]
    s_waitcnt vmcnt(9)
    v_mfma_f32_16x16x32_bf16 v[92:95], v[132:135], v[224:227], v[92:95]
    s_add_u32 s42, s23, 8192
    buffer_load_dwordx4 a[232:235], v1, s[4:7], s42 offen offset:0 sc1
    v_mfma_f32_16x16x32_bf16 v[96:99], v[136:139], v[224:227], v[96:99]
    v_mfma_f32_16x16x32_bf16 v[100:103], v[140:143], v[224:227], v[100:103]
    v_mfma_f32_16x16x32_bf16 v[104:107], v[144:147], v[224:227], v[104:107]
    v_mfma_f32_16x16x32_bf16 v[108:111], v[148:151], v[224:227], v[108:111]
    buffer_load_dwordx4 a[236:239], v1, s[4:7], s42 offen offset:1024 sc1
    s_waitcnt vmcnt(10)
    v_mfma_f32_16x16x32_bf16 v[92:95], v[152:155], v[228:231], v[92:95]
    v_mfma_f32_16x16x32_bf16 v[96:99], v[156:159], v[228:231], v[96:99]
    v_mfma_f32_16x16x32_bf16 v[100:103], v[160:163], v[228:231], v[100:103]
    v_mfma_f32_16x16x32_bf16 v[104:107], v[164:167], v[228:231], v[104:107]
    v_mfma_f32_16x16x32_bf16 v[108:111], v[168:171], v[228:231], v[108:111]
    buffer_load_dwordx4 a[240:243], v1, s[4:7], s42 offen offset:2048 sc1
    s_waitcnt vmcnt(10)
    v_mfma_f32_16x16x32_bf16 v[26:29], a[0:3], v[232:235], v[26:29]
    s_mul_i32 s41, s18, 15360
    s_add_u32 s41, s41, 112640
    v_mfma_f32_16x16x32_bf16 v[30:33], a[4:7], v[232:235], v[30:33]
    v_add_u32 v8, s41, v1
    v_mfma_f32_16x16x32_bf16 v[34:37], a[8:11], v[232:235], v[34:37]
    ds_write_b128 v8, v[92:95] offset:0
    v_mfma_f32_16x16x32_bf16 v[38:41], a[12:15], v[232:235], v[38:41]
    buffer_load_dwordx4 a[244:247], v1, s[4:7], s42 offen offset:3072 sc1
    v_mfma_f32_16x16x32_bf16 v[42:45], a[16:19], v[232:235], v[42:45]
    s_waitcnt vmcnt(10)
    v_mfma_f32_16x16x32_bf16 v[26:29], a[20:23], v[236:239], v[26:29]
    v_mfma_f32_16x16x32_bf16 v[30:33], a[24:27], v[236:239], v[30:33]
    ds_write_b128 v8, v[96:99] offset:1024
    v_mfma_f32_16x16x32_bf16 v[34:37], a[28:31], v[236:239], v[34:37]
    v_mfma_f32_16x16x32_bf16 v[38:41], a[32:35], v[236:239], v[38:41]
    s_add_u32 s42, s23, 12288
    buffer_load_dwordx4 v[172:175], v1, s[4:7], s42 offen offset:0 sc1
    v_mfma_f32_16x16x32_bf16 v[42:45], a[36:39], v[236:239], v[42:45]
    s_waitcnt vmcnt(10)
    v_mfma_f32_16x16x32_bf16 v[26:29], a[40:43], v[240:243], v[26:29]
    ds_write_b128 v8, v[100:103] offset:2048
    v_mfma_f32_16x16x32_bf16 v[30:33], a[44:47], v[240:243], v[30:33]
    v_mfma_f32_16x16x32_bf16 v[34:37], a[48:51], v[240:243], v[34:37]
    buffer_load_dwordx4 v[176:179], v1, s[4:7], s42 offen offset:1024 sc1
    v_mfma_f32_16x16x32_bf16 v[38:41], a[52:55], v[240:243], v[38:41]
    v_mfma_f32_16x16x32_bf16 v[42:45], a[56:59], v[240:243], v[42:45]
    ds_write_b128 v8, v[104:107] offset:3072
    s_waitcnt vmcnt(10)
    v_mfma_f32_16x16x32_bf16 v[26:29], a[60:63], v[244:247], v[26:29]
    v_mfma_f32_16x16x32_bf16 v[30:33], a[64:67], v[244:247], v[30:33]
    v_mfma_f32_16x16x32_bf16 v[34:37], a[68:71], v[244:247], v[34:37]
    v_mfma_f32_16x16x32_bf16 v[38:41], a[72:75], v[244:247], v[38:41]
    ds_write_b128 v8, v[108:111] offset:4096
    v_mfma_f32_16x16x32_bf16 v[42:45], a[76:79], v[244:247], v[42:45]
    s_waitcnt vmcnt(9)
    v_mfma_f32_16x16x32_bf16 v[26:29], a[80:83], v[248:251], v[26:29]
    v_mfma_f32_16x16x32_bf16 v[30:33], a[84:87], v[248:251], v[30:33]
    v_mfma_f32_16x16x32_bf16 v[34:37], a[88:91], v[248:251], v[34:37]
    s_waitcnt lgkmcnt(0)
    s_barrier
    ds_read_b128 v[52:55], v9 offset:0
    v_mfma_f32_16x16x32_bf16 v[38:41], a[92:95], v[248:251], v[38:41]
    ds_read_b128 v[56:59], v9 offset:1024
    v_mfma_f32_16x16x32_bf16 v[42:45], a[96:99], v[248:251], v[42:45]
    ds_read_b128 v[60:63], v9 offset:2048
    s_waitcnt vmcnt(8)
    v_mfma_f32_16x16x32_bf16 v[26:29], a[100:103], v[252:255], v[26:29]
    ds_read_b128 v[64:67], v9 offset:3072
    v_mfma_f32_16x16x32_bf16 v[30:33], a[104:107], v[252:255], v[30:33]
    ds_read_b128 v[68:71], v9 offset:4096
    v_mfma_f32_16x16x32_bf16 v[34:37], a[108:111], v[252:255], v[34:37]
    ds_read_b128 v[72:75], v9 offset:5120
    v_mfma_f32_16x16x32_bf16 v[38:41], a[112:115], v[252:255], v[38:41]
    ds_read_b128 v[76:79], v9 offset:6144
    v_mfma_f32_16x16x32_bf16 v[42:45], a[116:119], v[252:255], v[42:45]
    ds_read_b128 v[80:83], v9 offset:7168
    s_waitcnt vmcnt(7)
    v_mfma_f32_16x16x32_bf16 v[26:29], a[120:123], a[224:227], v[26:29]
    ds_read_b128 v[84:87], v9 offset:8192
    v_mfma_f32_16x16x32_bf16 v[30:33], a[124:127], a[224:227], v[30:33]
    ds_read_b128 v[88:91], v9 offset:9216
    v_mfma_f32_16x16x32_bf16 v[34:37], a[128:131], a[224:227], v[34:37]
    ds_read_b128 v[92:95], v9 offset:10240
    v_mfma_f32_16x16x32_bf16 v[38:41], a[132:135], a[224:227], v[38:41]
    ds_read_b128 v[96:99], v9 offset:11264
    v_mfma_f32_16x16x32_bf16 v[42:45], a[136:139], a[224:227], v[42:45]
    ds_read_b128 v[100:103], v9 offset:12288
    s_waitcnt vmcnt(6)
    v_mfma_f32_16x16x32_bf16 v[26:29], a[140:143], a[228:231], v[26:29]
    ds_read_b128 v[104:107], v9 offset:13312
    v_mfma_f32_16x16x32_bf16 v[30:33], a[144:147], a[228:231], v[30:33]
    ds_read_b128 v[108:111], v9 offset:14336
    v_mfma_f32_16x16x32_bf16 v[34:37], a[148:151], a[228:231], v[34:37]
    v_mfma_f32_16x16x32_bf16 v[38:41], a[152:155], a[228:231], v[38:41]
    s_waitcnt lgkmcnt(9)
    v_add_f32 v52, v52, v72
    v_add_f32 v53, v53, v73
    v_mfma_f32_16x16x32_bf16 v[42:45], a[156:159], a[228:231], v[42:45]
    v_add_f32 v54, v54, v74
    v_add_f32 v55, v55, v75
    s_waitcnt vmcnt(5)
    v_mfma_f32_16x16x32_bf16 v[26:29], a[160:163], a[232:235], v[26:29]
    s_waitcnt lgkmcnt(8)
    v_add_f32 v56, v56, v76
    v_add_f32 v57, v57, v77
    v_mfma_f32_16x16x32_bf16 v[30:33], a[164:167], a[232:235], v[30:33]
    v_add_f32 v58, v58, v78
    v_add_f32 v59, v59, v79
    v_mfma_f32_16x16x32_bf16 v[34:37], a[168:171], a[232:235], v[34:37]
    s_waitcnt lgkmcnt(7)
    v_add_f32 v60, v60, v80
    v_add_f32 v61, v61, v81
    v_mfma_f32_16x16x32_bf16 v[38:41], a[172:175], a[232:235], v[38:41]
    v_add_f32 v62, v62, v82
    v_add_f32 v63, v63, v83
    v_mfma_f32_16x16x32_bf16 v[42:45], a[176:179], a[232:235], v[42:45]
    s_waitcnt lgkmcnt(6)
    v_add_f32 v64, v64, v84
    v_add_f32 v65, v65, v85
    s_waitcnt vmcnt(4)
    v_mfma_f32_16x16x32_bf16 v[26:29], a[180:183], a[236:239], v[26:29]
    v_add_f32 v66, v66, v86
    v_add_f32 v67, v67, v87
    v_mfma_f32_16x16x32_bf16 v[30:33], a[184:187], a[236:239], v[30:33]
    s_waitcnt lgkmcnt(5)
    v_add_f32 v68, v68, v88
    v_add_f32 v69, v69, v89
    v_mfma_f32_16x16x32_bf16 v[34:37], a[188:191], a[236:239], v[34:37]
    v_add_f32 v70, v70, v90
    v_add_f32 v71, v71, v91
    v_mfma_f32_16x16x32_bf16 v[38:41], a[192:195], a[236:239], v[38:41]
    s_waitcnt lgkmcnt(4)
    v_add_f32 v52, v52, v92
    v_add_f32 v53, v53, v93
    v_mfma_f32_16x16x32_bf16 v[42:45], a[196:199], a[236:239], v[42:45]
    v_add_f32 v54, v54, v94
    v_add_f32 v55, v55, v95
    s_waitcnt vmcnt(3)
    v_mfma_f32_16x16x32_bf16 v[26:29], a[200:203], a[240:243], v[26:29]
    s_waitcnt lgkmcnt(3)
    v_add_f32 v56, v56, v96
    v_add_f32 v57, v57, v97
    v_mfma_f32_16x16x32_bf16 v[30:33], a[204:207], a[240:243], v[30:33]
    v_add_f32 v58, v58, v98
    v_add_f32 v59, v59, v99
    v_mfma_f32_16x16x32_bf16 v[34:37], a[208:211], a[240:243], v[34:37]
    s_waitcnt lgkmcnt(2)
    v_add_f32 v60, v60, v100
    v_add_f32 v61, v61, v101
    v_mfma_f32_16x16x32_bf16 v[38:41], a[212:215], a[240:243], v[38:41]
    v_add_f32 v62, v62, v102
    v_add_f32 v63, v63, v103
    v_mfma_f32_16x16x32_bf16 v[42:45], a[216:219], a[240:243], v[42:45]
    s_waitcnt lgkmcnt(1)
    v_add_f32 v64, v64, v104
    v_add_f32 v65, v65, v105
    s_waitcnt vmcnt(2)
    v_mfma_f32_16x16x32_bf16 v[26:29], a[220:223], a[244:247], v[26:29]
    v_add_f32 v66, v66, v106
    v_add_f32 v67, v67, v107
    v_mfma_f32_16x16x32_bf16 v[30:33], v[116:119], a[244:247], v[30:33]
    s_waitcnt lgkmcnt(0)
    v_add_f32 v68, v68, v108
    v_add_f32 v69, v69, v109
    v_mfma_f32_16x16x32_bf16 v[34:37], v[120:123], a[244:247], v[34:37]
    v_add_f32 v70, v70, v110
    v_add_f32 v71, v71, v111
    v_mfma_f32_16x16x32_bf16 v[38:41], v[124:127], a[244:247], v[38:41]
    v_mfma_f32_16x16x32_bf16 v[42:45], v[128:131], a[244:247], v[42:45]
    s_waitcnt vmcnt(1)
    v_mfma_f32_16x16x32_bf16 v[26:29], v[132:135], v[172:175], v[26:29]
    v_mfma_f32_16x16x32_bf16 v[30:33], v[136:139], v[172:175], v[30:33]
    v_mfma_f32_16x16x32_bf16 v[34:37], v[140:143], v[172:175], v[34:37]
    v_mfma_f32_16x16x32_bf16 v[38:41], v[144:147], v[172:175], v[38:41]
    v_mfma_f32_16x16x32_bf16 v[42:45], v[148:151], v[172:175], v[42:45]
    s_waitcnt vmcnt(0)
    v_mfma_f32_16x16x32_bf16 v[26:29], v[152:155], v[176:179], v[26:29]
    v_mfma_f32_16x16x32_bf16 v[30:33], v[156:159], v[176:179], v[30:33]
    v_mfma_f32_16x16x32_bf16 v[34:37], v[160:163], v[176:179], v[34:37]
    v_mfma_f32_16x16x32_bf16 v[38:41], v[164:167], v[176:179], v[38:41]
    v_mfma_f32_16x16x32_bf16 v[42:45], v[168:171], v[176:179], v[42:45]
    s_nop 3
    v_pk_add_f32 v[26:27], v[26:27], v[52:53]
    v_pk_add_f32 v[28:29], v[28:29], v[54:55]
    v_pk_add_f32 v[30:31], v[30:31], v[56:57]
    v_pk_add_f32 v[32:33], v[32:33], v[58:59]
    v_pk_add_f32 v[34:35], v[34:35], v[60:61]
    v_pk_add_f32 v[36:37], v[36:37], v[62:63]
    v_pk_add_f32 v[38:39], v[38:39], v[64:65]
    v_pk_add_f32 v[40:41], v[40:41], v[66:67]
    v_pk_add_f32 v[42:43], v[42:43], v[68:69]
    v_pk_add_f32 v[44:45], v[44:45], v[70:71]
    v_cvt_pk_bf16_f32 v16, v26, v27
    v_cvt_pk_bf16_f32 v17, v28, v29
    v_cvt_pk_bf16_f32 v18, v30, v31
    v_cvt_pk_bf16_f32 v19, v32, v33
    v_cvt_pk_bf16_f32 v20, v34, v35
    v_cvt_pk_bf16_f32 v21, v36, v37
    v_cvt_pk_bf16_f32 v22, v38, v39
    v_cvt_pk_bf16_f32 v23, v40, v41
    v_cvt_pk_bf16_f32 v24, v42, v43
    v_cvt_pk_bf16_f32 v25, v44, v45
    buffer_store_dwordx4 v[16:19], v5, s[8:11], s83 offen
    buffer_store_dwordx4 v[20:23], v5, s[8:11], s83 offen offset:64
    buffer_store_dwordx2 v[24:25], v6, s[8:11], s83 offen
L_fin:
L_end:
    s_endpgm
L_rest:
    s_mov_b32 s45, 200000
L_rest_b:
    buffer_load_dwordx4 v[26:29], v15, s[4:7], 0 offen sc1
    s_sub_u32 s45, s45, 1
    s_cbranch_scc1 L_rest_c
    s_waitcnt vmcnt(0)
    v_min3_u32 v26, v26, v27, v28
    v_min_u32 v26, v26, v29
    v_cmp_gt_u32 vcc, 1, v26
    s_nop 0
    s_cbranch_vccnz L_rest_b
L_rest_c:
    s_waitcnt vmcnt(0)
    s_branch L_rested
L_kb0:
    s_mov_b32 s45, 200000
L_kb0_b:
    buffer_load_dword v46, v49, s[4:7], 0 offen sc1
    s_sub_u32 s45, s45, 1
    s_cbranch_scc1 L_kb0_c
    s_waitcnt vmcnt(0)
    v_cmp_gt_u32 vcc, 2, v46
    s_nop 0
    s_cbranch_vccnz L_kb0_b
L_kb0_c:
    s_waitcnt vmcnt(0)
    s_branch L_kb0ed
L_wt_1:
    buffer_store_dwordx4 v[142:145], v12, s[4:7], s85 offen sc1
    s_branch L_bk_2
L_wt_3:
    buffer_store_dword v50, v0, s[4:7], s101 offen offset:0 sc1
    s_branch L_bk_4
L_wt_5:
    buffer_store_dwordx4 v[116:119], v12, s[4:7], s85 offen offset:2048 sc1
    buffer_store_dwordx2 v[146:147], v13, s[4:7], s86 offen sc1
    s_branch L_bk_6
L_wt_8:
    buffer_store_dword v50, v0, s[4:7], s101 offen offset:0 sc1
    s_branch L_bk_9
L_wt_11:
    buffer_store_dwordx4 v[16:19], v5, s[4:7], s82 offen sc1
    buffer_store_dwordx4 v[20:23], v5, s[4:7], s82 offen offset:2048 sc1
    buffer_store_dwordx2 v[24:25], v6, s[4:7], s82 offen sc1
    s_branch L_bk_12
L_wt_13:
    buffer_store_dword v26, v7, s[4:7], s84 offen sc1
    s_branch L_bk_14
L_wt_15:
    buffer_store_dword v50, v0, s[4:7], s98 offen offset:0 sc1
    s_branch L_bk_16
L_wt_17:
    buffer_store_dword v50, v0, s[4:7], s98 offen offset:0 sc1
    s_branch L_bk_18
L_sx_21:
    s_mov_b32 s45, 200000
L_sx_21_b:
    buffer_load_dword v37, v34, s[4:7], s99 offen sc1
    s_sub_u32 s45, s45, 1
    s_cbranch_scc1 L_sx_21_c
    s_waitcnt vmcnt(0)
    v_cmp_gt_u32 vcc, 2, v37
    s_nop 0
    s_cbranch_vccnz L_sx_21_b
L_sx_21_c:
    s_waitcnt vmcnt(0)
    s_branch L_sx_21ed
L_wt_22:
    buffer_store_dwordx4 v[52:55], v1, s[4:7], s87 offen offset:0 sc1
    s_branch L_bk_23
L_wt_24:
    buffer_store_dwordx4 v[56:59], v6, s[4:7], s87 offen offset:0 sc1
    s_branch L_bk_25
L_wt_26:
    buffer_store_dwordx4 v[68:71], v1, s[4:7], s87 offen offset:1024 sc1
    s_branch L_bk_27
L_wt_28:
    buffer_store_dwordx4 v[72:75], v6, s[4:7], s87 offen offset:1024 sc1
    s_branch L_bk_29
L_wt_30:
    buffer_store_dword v50, v0, s[4:7], s101 offen offset:0 sc1
    s_branch L_bk_31
L_wt_32:
    buffer_store_dwordx4 v[84:87], v1, s[4:7], s88 offen offset:0 sc1
    s_branch L_bk_33
L_wt_34:
    buffer_store_dwordx4 v[88:91], v6, s[4:7], s88 offen offset:0 sc1
    s_branch L_bk_35
L_wt_36:
    buffer_store_dwordx4 v[100:103], v5, s[4:7], s89 offen sc1
    s_branch L_bk_37
L_wt_39:
    buffer_store_dword v50, v0, s[4:7], s101 offen offset:0 sc1
    s_branch L_bk_40
L_wt_42:
    buffer_store_dwordx4 v[16:19], v5, s[4:7], s82 offen sc1
    buffer_store_dwordx4 v[20:23], v5, s[4:7], s82 offen offset:2048 sc1
    buffer_store_dwordx2 v[24:25], v6, s[4:7], s82 offen sc1
    s_branch L_bk_43
L_wt_44:
    buffer_store_dword v26, v7, s[4:7], s84 offen sc1
    s_branch L_bk_45
L_wt_46:
    buffer_store_dword v50, v0, s[4:7], s98 offen offset:0 sc1
    s_branch L_bk_47
L_wt_48:
    buffer_store_dword v50, v0, s[4:7], s98 offen offset:0 sc1
    s_branch L_bk_49
L_sx_52:
    s_mov_b32 s45, 200000
L_sx_52_b:
    buffer_load_dword v37, v34, s[4:7], s99 offen sc1
    s_sub_u32 s45, s45, 1
    s_cbranch_scc1 L_sx_52_c
    s_waitcnt vmcnt(0)
    v_cmp_gt_u32 vcc, 4, v37
    s_nop 0
    s_cbranch_vccnz L_sx_52_b
L_sx_52_c:
    s_waitcnt vmcnt(0)
    s_branch L_sx_52ed
L_kb1:
    s_mov_b32 s45, 200000
L_kb1_b:
    buffer_load_dword v46, v49, s[4:7], 0 offen sc1
    s_sub_u32 s45, s45, 1
    s_cbranch_scc1 L_kb1_c
    s_waitcnt vmcnt(0)
    v_cmp_gt_u32 vcc, 4, v46
    s_nop 0
    s_cbranch_vccnz L_kb1_b
L_kb1_c:
    s_waitcnt vmcnt(0)
    s_branch L_kb1ed
L_wt_53:
    buffer_store_dwordx4 v[142:145], v12, s[4:7], s85 offen sc1
    s_branch L_bk_54
L_wt_55:
    buffer_store_dword v50, v0, s[4:7], s101 offen offset:0 sc1
    s_branch L_bk_56
L_wt_57:
    buffer_store_dwordx4 v[116:119], v12, s[4:7], s85 offen offset:2048 sc1
    buffer_store_dwordx2 v[146:147], v13, s[4:7], s86 offen sc1
    s_branch L_bk_58
L_wt_60:
    buffer_store_dword v50, v0, s[4:7], s101 offen offset:0 sc1
    s_branch L_bk_61
L_wt_63:
    buffer_store_dwordx4 v[16:19], v5, s[4:7], s82 offen sc1
    buffer_store_dwordx4 v[20:23], v5, s[4:7], s82 offen offset:2048 sc1
    buffer_store_dwordx2 v[24:25], v6, s[4:7], s82 offen sc1
    s_branch L_bk_64
L_wt_65:
    buffer_store_dword v26, v7, s[4:7], s84 offen sc1
    s_branch L_bk_66
L_wt_67:
    buffer_store_dword v50, v0, s[4:7], s98 offen offset:0 sc1
    s_branch L_bk_68
L_wt_69:
    buffer_store_dword v50, v0, s[4:7], s98 offen offset:0 sc1
    s_branch L_bk_70
L_sx_73:
    s_mov_b32 s45, 200000
L_sx_73_b:
    buffer_load_dword v37, v34, s[4:7], s99 offen sc1
    s_sub_u32 s45, s45, 1
    s_cbranch_scc1 L_sx_73_c
    s_waitcnt vmcnt(0)
    v_cmp_gt_u32 vcc, 6, v37
    s_nop 0
    s_cbranch_vccnz L_sx_73_b
L_sx_73_c:
    s_waitcnt vmcnt(0)
    s_branch L_sx_73ed
L_wt_74:
    buffer_store_dword v50, v0, s[4:7], s101 offen offset:0 sc1
    s_branch L_bk_75
L_wt_77:
    buffer_store_dword v50, v0, s[4:7], s101 offen offset:0 sc1
    s_branch L_bk_78
L_wt_80:
    buffer_store_dword v50, v0, s[4:7], s101 offen offset:0 sc1
    s_branch L_bk_81
L_truemax:
    s_waitcnt vmcnt(0)
    s_nop 15
    s_lshl_b32 s34, s58, 2
    s_add_u32 s34, s34, s3
    s_add_u32 s34, s34, 1
    s_min_u32 s34, s34, 9
    s_cmp_lg_u32 s55, 0
    s_cbranch_scc1 L_tm_b
    s_mov_b32 s37, 0
    v_mov_b32 v124, v26
    v_mov_b32 v125, v27
    v_mov_b32 v126, v28
    v_mov_b32 v127, v29
    v_mov_b32 v128, v30
    v_mov_b32 v129, v31
L_tm_head:
    v_mov_b32 v46, s77
    s_mov_b32 s36, 0
    v_mov_b32 v68, 0
    v_mov_b32 v69, 0
    v_mov_b32 v70, 0
    v_mov_b32 v71, 0
    v_mov_b32 v72, 0
    v_mov_b32 v73, 0
    v_mov_b32 v74, 0
    v_mov_b32 v75, 0
    v_mov_b32 v76, 0
    v_mov_b32 v77, 0
    v_mov_b32 v78, 0
    v_mov_b32 v79, 0
    v_mov_b32 v80, 0
    v_mov_b32 v81, 0
    v_mov_b32 v82, 0
    v_mov_b32 v83, 0
L_tm_pass:
    s_mov_b32 s35, 0
    s_mov_b32 s41, 3072
    v_add_u32 v40, 24576, v5
    v_add_u32 v49, 27136, v6
    v_add_u32 v38, 25600, v8
    v_add_u32 v39, 25600, v9
    s_cmp_eq_u32 s37, 0
    s_cbranch_scc1 L_tm_tile
    s_mov_b32 s41, 2560
    v_add_u32 v40, 20480, v15
    v_add_u32 v38, 21504, v10
    v_add_u32 v39, 21504, v11
L_tm_tile:
    ds_read_b128 a[204:207], v40
    ds_read_b64 a[208:209], v49
    ds_read_b64_tr_b16 a[212:213], v38 offset:0
    ds_read_b64_tr_b16 a[214:215], v39 offset:0
    ds_read_b64_tr_b16 a[216:217], v38 offset:256
    ds_read_b64_tr_b16 a[218:219], v39 offset:256
    s_cmp_eq_u32 s35, 8
    s_cselect_b32 s38, -1, 0
    s_and_b32 s39, s35, 7
    s_cselect_b32 s39, 0, s77
    v_subrev_u32 v52, 0, v7
    v_xor_b32 v52, s38, v52
    v_and_b32 v52, s39, v52
    v_subrev_u32 v53, 1, v7
    v_xor_b32 v53, s38, v53
    v_and_b32 v53, s39, v53
    v_subrev_u32 v54, 2, v7
    v_xor_b32 v54, s38, v54
    v_and_b32 v54, s39, v54
    v_subrev_u32 v55, 3, v7
    v_xor_b32 v55, s38, v55
    v_and_b32 v55, s39, v55
    v_subrev_u32 v56, 8, v7
    v_xor_b32 v56, s38, v56
    v_and_b32 v56, s39, v56
    v_subrev_u32 v57, 9, v7
    v_xor_b32 v57, s38, v57
    v_and_b32 v57, s39, v57
    v_subrev_u32 v58, 10, v7
    v_xor_b32 v58, s38, v58
    v_and_b32 v58, s39, v58
    v_subrev_u32 v59, 11, v7
    v_xor_b32 v59, s38, v59
    v_and_b32 v59, s39, v59
    v_subrev_u32 v60, 16, v7
    v_xor_b32 v60, s38, v60
    v_and_b32 v60, s39, v60
    v_subrev_u32 v61, 17, v7
    v_xor_b32 v61, s38, v61
    v_and_b32 v61, s39, v61
    v_subrev_u32 v62, 18, v7
    v_xor_b32 v62, s38, v62
    v_and_b32 v62, s39, v62
    v_subrev_u32 v63, 19, v7
    v_xor_b32 v63, s38, v63
    v_and_b32 v63, s39, v63
    v_subrev_u32 v64, 24, v7
    v_xor_b32 v64, s38, v64
    v_and_b32 v64, s39, v64
    v_subrev_u32 v65, 25, v7
    v_xor_b32 v65, s38, v65
    v_and_b32 v65, s39, v65
    v_subrev_u32 v66, 26, v7
    v_xor_b32 v66, s38, v66
    v_and_b32 v66, s39, v66
    v_subrev_u32 v67, 27, v7
    v_xor_b32 v67, s38, v67
    v_and_b32 v67, s39, v67
    s_waitcnt lgkmcnt(5)
    s_nop 0
    v_mfma_f32_32x32x16_bf16 v[52:67], a[204:207], v[124:127], v[52:67]
    s_waitcnt lgkmcnt(4)
    v_mfma_f32_32x32x8_bf16 v[52:67], a[208:209], v[128:129], v[52:67]
    s_waitcnt lgkmcnt(0)
    s_nop 15
    s_cmp_lg_u32 s36, 0
    s_cbranch_scc1 L_tm_exp
    v_max3_f32 v46, v52, v53, v46
    v_max3_f32 v46, v54, v55, v46
    v_max3_f32 v46, v56, v57, v46
    v_max3_f32 v46, v58, v59, v46
    v_max3_f32 v46, v60, v61, v46
    v_max3_f32 v46, v62, v63, v46
    v_max3_f32 v46, v64, v65, v46
    v_max3_f32 v46, v66, v67, v46
    s_branch L_tm_next
L_tm_exp:
    v_sub_f32 v52, v52, v46
    v_sub_f32 v53, v53, v46
    v_sub_f32 v54, v54, v46
    v_sub_f32 v55, v55, v46
    v_sub_f32 v56, v56, v46
    v_sub_f32 v57, v57, v46
    v_sub_f32 v58, v58, v46
    v_sub_f32 v59, v59, v46
    v_sub_f32 v60, v60, v46
    v_sub_f32 v61, v61, v46
    v_sub_f32 v62, v62, v46
    v_sub_f32 v63, v63, v46
    v_sub_f32 v64, v64, v46
    v_sub_f32 v65, v65, v46
    v_sub_f32 v66, v66, v46
    v_sub_f32 v67, v67, v46
    v_exp_f32 v52, v52
    v_exp_f32 v53, v53
    v_exp_f32 v54, v54
    v_exp_f32 v55, v55
    v_exp_f32 v56, v56
    v_exp_f32 v57, v57
    v_exp_f32 v58, v58
    v_exp_f32 v59, v59
    v_exp_f32 v60, v60
    v_exp_f32 v61, v61
    v_exp_f32 v62, v62
    v_exp_f32 v63, v63
    v_exp_f32 v64, v64
    v_exp_f32 v65, v65
    v_exp_f32 v66, v66
    v_exp_f32 v67, v67
    v_cvt_pk_bf16_f32 v116, v52, v53
    v_cvt_pk_bf16_f32 v117, v54, v55
    v_cvt_pk_bf16_f32 v118, v56, v57
    v_cvt_pk_bf16_f32 v119, v58, v59
    v_cvt_pk_bf16_f32 v120, v60, v61
    v_cvt_pk_bf16_f32 v121, v62, v63
    v_cvt_pk_bf16_f32 v122, v64, v65
    v_cvt_pk_bf16_f32 v123, v66, v67
    v_mfma_f32_32x32x16_bf16 v[68:83], a[212:215], v[116:119], v[68:83]
    s_nop 0
    v_mfma_f32_32x32x16_bf16 v[68:83], a[216:219], v[120:123], v[68:83]
    s_nop 15
L_tm_next:
    v_subrev_u32 v40, s41, v40
    v_subrev_u32 v49, 3072, v49
    v_subrev_u32 v38, s41, v38
    v_subrev_u32 v39, s41, v39
    s_add_u32 s35, s35, 1
    s_cmp_lt_u32 s35, s34
    s_cbranch_scc1 L_tm_tile
    s_cmp_lg_u32 s36, 0
    s_cbranch_scc1 L_tm_done
    v_mov_b32 v47, v46
    s_nop 1
    v_permlane32_swap_b32 v46, v47
    v_max_f32 v46, v46, v47
    s_mov_b32 s36, 1
    s_branch L_tm_pass
L_tm_done:
    s_cmp_lg_u32 s37, 0
    s_cbranch_scc1 L_tm_last
    v_mov_b32 v84, v68
    v_mov_b32 v85, v69
    v_mov_b32 v86, v70
    v_mov_b32 v87, v71
    v_mov_b32 v88, v72
    v_mov_b32 v89, v73
    v_mov_b32 v90, v74
    v_mov_b32 v91, v75
    v_mov_b32 v92, v76
    v_mov_b32 v93, v77
    v_mov_b32 v94, v78
    v_mov_b32 v95, v79
    v_mov_b32 v96, v80
    v_mov_b32 v97, v81
    v_mov_b32 v98, v82
    v_mov_b32 v99, v83
    v_rcp_f32 v44, v96
    s_nop 0
    v_mul_f32 v84, v44, v84
    v_mul_f32 v85, v44, v85
    v_mul_f32 v86, v44, v86
    v_mul_f32 v87, v44, v87
    v_mul_f32 v88, v44, v88
    v_mul_f32 v89, v44, v89
    v_mul_f32 v90, v44, v90
    v_mul_f32 v91, v44, v91
    v_mul_f32 v92, v44, v92
    v_mul_f32 v93, v44, v93
    v_mul_f32 v94, v44, v94
    v_mul_f32 v95, v44, v95
    v_cvt_pk_bf16_f32 v142, v84, v85
    v_cvt_pk_bf16_f32 v143, v86, v87
    v_cvt_pk_bf16_f32 v144, v88, v89
    v_cvt_pk_bf16_f32 v145, v90, v91
    v_cvt_pk_bf16_f32 v146, v92, v93
    v_cvt_pk_bf16_f32 v147, v94, v95
    buffer_store_dwordx4 v[142:145], v12, s[4:7], s85 offen sc1
    s_lshl_b32 s35, s40, 2
    s_add_u32 s35, s35, 1
    v_mov_b32 v50, s35
    s_waitcnt vmcnt(0)
    s_mov_b64 exec, 1
    s_cmp_lg_u32 s50, 0
    s_cbranch_scc1 L_wt_80
    buffer_store_dword v50, v0, s[4:7], s101 offen offset:0
L_bk_81:
    s_mov_b64 exec, -1
L_tm_b:
    v_mov_b32 v124, v34
    v_mov_b32 v125, v35
    v_mov_b32 v126, v36
    v_mov_b32 v127, v37
    v_mov_b32 v128, v32
    v_mov_b32 v129, v33
    s_mov_b32 s37, 1
    s_branch L_tm_head
L_tm_last:
    v_mov_b32 v100, v68
    v_mov_b32 v101, v69
    v_mov_b32 v102, v70
    v_mov_b32 v103, v71
    v_mov_b32 v104, v72
    v_mov_b32 v105, v73
    v_mov_b32 v106, v74
    v_mov_b32 v107, v75
    v_mov_b32 v108, v76
    v_mov_b32 v109, v77
    v_mov_b32 v110, v78
    v_mov_b32 v111, v79
    v_mov_b32 v112, v80
    v_mov_b32 v113, v81
    v_mov_b32 v114, v82
    v_mov_b32 v115, v83
    v_mov_b32 v47, 0
    s_cmp_eq_u32 s40, 0
    s_cbranch_scc1 L_norm0
    s_branch L_norm1
L_code_end:
.section .rodata,"a"
.p2align 6
.amdhsa_kernel interleave_layers__sliding_block__dense_activation_silu__prompt_kernel
  .amdhsa_next_free_vgpr 512
  .amdhsa_next_free_sgpr 102
  .amdhsa_accum_offset 256
  .amdhsa_group_segment_fixed_size 0
  .amdhsa_kernarg_size 72
  .amdhsa_user_sgpr_count 2
  .amdhsa_user_sgpr_kernarg_segment_ptr 1
  .amdhsa_system_sgpr_workgroup_id_x 1
.end_amdhsa_kernel
```
